```python
import torch

def _softmax(x, axis=-1):
    return torch.softmax(x, dim=axis)
def _gelu(x):
    return torch.nn.functional.gelu(x, approximate="tanh")
def _silu(x):
    return torch.nn.functional.silu(x)
def _sigmoid(x):
    return torch.sigmoid(x)
def _layernorm(x, axis=-1, eps=1e-5):
    m = x.mean(dim=axis, keepdim=True)
    v = x.var(dim=axis, keepdim=True, unbiased=False)
    return (x - m) / torch.sqrt(v + eps)
def _scatter_add(tgt, idx, src, axis=0):
    return tgt.clone().index_add_(axis, idx, src)
def _segment_sum(src, seg, n):
    out = torch.zeros((n,) + src.shape[1:], dtype=src.dtype)
    return out.index_add_(0, seg, src)
def _pad(x, pw):
    flat = tuple(v for pair in reversed(pw) for v in pair)
    return torch.nn.functional.pad(x, flat)

kernel_name = 'gated_mix__grouped_kv_mqa__mha_block__prompt'

def setup_inputs():

    _w = (lambda a: (lambda t: t.to(torch.bfloat16) if t.is_floating_point() else t)(torch.as_tensor(a)))
    def _A_setup():
        B, S, D, H = 1, 2048, 640, 32
        Dh = D // H
        return {
            "x": _w((lambda *s: torch.randn(*s, dtype=torch.bfloat16) * 0.1)(B, S, D)),
            "wq": _w((lambda *s: torch.randn(*s, dtype=torch.bfloat16) * 0.4)(D, H * Dh)),
            "wk": _w((lambda *s: torch.randn(*s, dtype=torch.bfloat16) * 0.4)(D, Dh)),
            "wv": _w((lambda *s: torch.randn(*s, dtype=torch.bfloat16) * 0.4)(D, Dh)),
            "wo": _w((lambda *s: torch.randn(*s, dtype=torch.bfloat16) * 0.4)(H * Dh, D)),
        }
    _A_in = _A_setup()

    def _B_setup():
        B, S, D, H = 1, 2048, 640, 32
        return {
            "x": _w((lambda *s: torch.randn(*s, dtype=torch.bfloat16) * 0.1)(B, S, D)),
            "wqkv": _w((lambda *s: torch.randn(*s, dtype=torch.bfloat16) * 0.4)(D, 3 * D)),
            "wo": _w((lambda *s: torch.randn(*s, dtype=torch.bfloat16) * 0.2)(D, D)),
        }
    _B_in = _B_setup()

    return {
        "A_x": _A_in["x"],
        "A_wq": _A_in["wq"],
        "A_wk": _A_in["wk"],
        "A_wv": _A_in["wv"],
        "A_wo": _A_in["wo"],
        "B_x": _B_in["x"],
        "B_wqkv": _B_in["wqkv"],
        "B_wo": _B_in["wo"],
        "gate_w": _w((lambda *s: torch.randn(*s, dtype=torch.bfloat16) * 0.1)(640) * 16.0),
    }

def reference(A_x, A_wq, A_wk, A_wv, A_wo, B_x, B_wqkv, B_wo, gate_w):
    def _A_ref(x, wq, wk, wv, wo):
        B, S, D = x.shape
        H = 32
        Dh = D // H
        q = (lambda x, *d: x.permute(*d))((x @ wq).reshape(B, S, H, Dh), 0, 2, 1, 3)
        k = x @ wk
        v = x @ wv
        scores = torch.einsum("bhqd,bkd->bhqk", q, k) * (Dh ** -0.5)
        p = _softmax(scores, axis=-1)
        o = torch.einsum("bhqk,bkd->bhqd", p, v)
        return (lambda x, *d: x.permute(*d))(o, 0, 2, 1, 3).reshape(B, S, H * Dh) @ wo

    def _B_ref(x, wqkv, wo):
        B, S, D = x.shape
        H = 32
        Dh = D // H
        qkv = (lambda x, *d: x.permute(*d))((x @ wqkv).reshape(B, S, 3, H, Dh), 2, 0, 3, 1, 4)
        q, k, v = qkv[0], qkv[1], qkv[2]
        scores = torch.einsum("bhqd,bhkd->bhqk", q, k) * (Dh ** -0.5)
        p = _softmax(scores, axis=-1)
        o = torch.einsum("bhqk,bhkd->bhqd", p, v)
        return (lambda x, *d: x.permute(*d))(o, 0, 2, 1, 3).reshape(B, S, D) @ wo

    x = A_x
    g = _sigmoid((x * gate_w).sum(-1, keepdims=True))
    a = _A_ref(x, A_wq, A_wk, A_wv, A_wo)
    b = _B_ref(x, B_wqkv, B_wo)
    return g * a + (1 - g) * b
```

```asm
; @launch grid=(256,1,1) block=(512,1,1) lds=163840
.amdgcn_target "amdgcn-amd-amdhsa--gfx950"
.text
.globl gated_mix__grouped_kv_mqa__mha_block__prompt_kernel
.p2align 8
.type gated_mix__grouped_kv_mqa__mha_block__prompt_kernel,@function
gated_mix__grouped_kv_mqa__mha_block__prompt_kernel:
    s_cmp_ge_u32 s2, 256
    s_cbranch_scc1 L_mk_end
    s_load_dwordx4 s[12:15], s[0:1], 0
    s_load_dwordx4 s[20:23], s[0:1], 16
    s_load_dwordx2 s[16:17], s[0:1], 48
    s_load_dwordx2 s[40:41], s[0:1], 64
    s_load_dwordx4 s[60:63], s[0:1], 80
    v_lshrrev_b32 v1, 6, v0
    s_and_b32 s25, s2, 7
    s_lshr_b32 s26, s2, 3
    v_readfirstlane_b32 s53, v1
    s_lshr_b32 s27, s25, 1
    s_lshl_b32 s27, s27, 2
    s_and_b32 s28, s26, 3
    s_add_u32 s9, s27, s28
    s_and_b32 s27, s25, 1
    s_lshl_b32 s27, s27, 2
    s_lshr_b32 s29, s26, 2
    s_and_b32 s10, s29, 3
    s_add_u32 s10, s10, s27
    s_lshr_b32 s27, s26, 4
    s_lshl_b32 s27, s27, 3
    s_add_u32 s10, s10, s27
    s_mov_b32 s52, s26
    s_mul_i32 s28, s28, 5
    s_add_u32 s28, s28, 1
    s_lshr_b32 s28, s28, 1
    s_add_u32 s11, s28, s29
    s_sub_u32 s29, s11, 10
    s_cmp_ge_u32 s11, 10
    s_cselect_b32 s11, s29, s11
    s_and_b32 s8, s53, 3
    s_lshr_b32 s57, s53, 2
    s_mov_b32 s55, s9
    s_mov_b32 s58, s10
    s_lshl_b32 s46, s9, 2
    s_add_u32 s46, s46, s8
    s_lshl_b32 s54, s10, 2
    s_add_u32 s54, s54, s8
    s_sub_u32 s56, s54, 31
    s_cmp_lt_u32 s54, 32
    s_cselect_b32 s56, 0, s56
    s_mul_i32 s59, s56, 163840
    s_add_u32 s59, s59, 5242880
    s_mul_i32 s25, s57, 81920
    s_add_u32 s59, s59, s25
    s_mul_i32 s27, s10, 160
    s_add_u32 s27, s27, 1280
    s_and_b32 s30, s10, 7
    s_mul_i32 s30, s30, 160
    s_and_b32 s25, s10, 6
    s_cmp_eq_u32 s25, 0
    s_cselect_b32 s34, -1, 0
    s_cselect_b32 s35, -1, 0
    s_cselect_b32 s38, 0xffff, 0
    s_mov_b32 s39, 0
    s_mov_b32 s24, 1280
    v_and_b32 v4, 63, v0
    v_lshrrev_b32 v5, 3, v4
    v_mul_u32_u24 v5, 1280, v5
    v_and_b32 v6, 7, v4
    v_lshrrev_b32 v7, 4, v4
    v_xor_b32 v6, v6, v7
    v_lshl_add_u32 v16, v6, 4, v5
    v_xor_b32 v6, 4, v6
    v_lshl_add_u32 v17, v6, 4, v5
    s_lshl_b32 s25, s8, 1
    s_mul_i32 s36, s8, 6
    s_sub_u32 s36, s36, 8
    s_cmp_lt_u32 s8, 2
    s_cselect_b32 s25, s25, s36
    s_mul_i32 s26, s9, 163840
    s_mul_i32 s36, s25, 10240
    s_add_u32 s26, s26, s36
    s_lshl_b32 s31, s25, 10
    s_waitcnt lgkmcnt(0)
    s_mov_b32 s48, s14
    s_mov_b32 s49, s15
    s_and_b32 s13, s13, 0xffff
    s_mov_b32 s14, 2621440
    s_mov_b32 s15, 0x20000
    s_cmp_lt_u32 s53, 4
    s_cbranch_scc1 L_mk_compute
    s_cmp_ge_u32 s53, 6
    s_cbranch_scc1 L_mk_ld1
    s_add_u32 s3, s11, 0
    s_sub_u32 s36, s3, 10
    s_cmp_ge_u32 s3, 10
    s_cselect_b32 s3, s36, s3
    s_lshl_b32 s36, s3, 7
    s_add_u32 s36, s36, s26
    s_add_u32 m0, s31, 0
    s_add_u32 s37, s36, 0
    buffer_load_dwordx4 v16, s[12:15], s37 offen lds
    s_add_u32 m0, s31, 1024
    s_add_u32 s37, s36, 10240
    buffer_load_dwordx4 v17, s[12:15], s37 offen lds
    s_mov_b32 s4, s62
    s_and_b32 s5, s63, 0xffff
    s_mov_b32 s6, 268435456
    s_mov_b32 s7, 0x20000
    s_and_b32 s61, s61, 0xffff
    s_mov_b32 s62, 256
    s_mov_b32 s63, 0x20000
    s_and_b32 s17, s17, 0xffff
    s_cmp_lt_u32 s10, 8
    s_cselect_b32 s48, s48, s16
    s_cselect_b32 s49, s49, s17
    s_cselect_b32 s24, s24, 3840
    s_cselect_b32 s20, s20, s22
    s_cselect_b32 s21, s21, s23
    s_and_b32 s41, s41, 0xffff
    s_and_b32 s49, s49, 0xffff
    s_mul_i32 s50, s24, 640
    s_mov_b32 s51, 0x20000
    s_and_b32 s21, s21, 0xffff
    s_mov_b32 s22, 25600
    s_mov_b32 s23, 0x20000
    s_mov_b32 s18, 2457600
    s_mov_b32 s19, 0x20000
    s_lshl_b32 s36, s2, 3
    s_add_u32 s36, s36, s53
    s_cmp_lg_u32 s36, 4
    s_cbranch_scc1 L_mk_mt1
    s_memrealtime s[36:37]
    s_waitcnt lgkmcnt(0)
    s_or_b32 s36, s36, 1
    s_xor_b32 s37, s37, 0x5bd1e995
    v_mov_b32 v2, s36
    v_mov_b32 v3, s37
    v_mov_b32 v1, 0
    s_mov_b64 exec, 1
    buffer_store_dwordx2 v[2:3], v1, s[60:63], 0 offen sc1
    s_mov_b64 exec, -1
L_mk_mt1:
    s_and_b32 s36, s8, 1
    s_mul_i32 s44, s36, 320
    s_mul_i32 s32, s36, 5120
    s_mov_b32 s43, 3840
    v_add_u32 v5, s44, v4
    v_mul_u32_u24 v6, 6554, v5
    v_lshrrev_b32 v6, 16, v6
    v_mul_u32_u24 v7, 10, v6
    v_sub_u32 v5, v5, v7
    v_mul_lo_u32 v18, v6, s43
    v_lshl_add_u32 v18, v5, 4, v18
    v_add_u32 v5, s44, v4
    v_add_u32 v5, 64, v5
    v_mul_u32_u24 v6, 6554, v5
    v_lshrrev_b32 v6, 16, v6
    v_mul_u32_u24 v7, 10, v6
    v_sub_u32 v5, v5, v7
    v_mul_lo_u32 v19, v6, s43
    v_lshl_add_u32 v19, v5, 4, v19
    v_add_u32 v5, s44, v4
    v_add_u32 v5, 128, v5
    v_mul_u32_u24 v6, 6554, v5
    v_lshrrev_b32 v6, 16, v6
    v_mul_u32_u24 v7, 10, v6
    v_sub_u32 v5, v5, v7
    v_mul_lo_u32 v20, v6, s43
    v_lshl_add_u32 v20, v5, 4, v20
    v_add_u32 v5, s44, v4
    v_add_u32 v5, 192, v5
    v_mul_u32_u24 v6, 6554, v5
    v_lshrrev_b32 v6, 16, v6
    v_mul_u32_u24 v7, 10, v6
    v_sub_u32 v5, v5, v7
    v_mul_lo_u32 v21, v6, s43
    v_lshl_add_u32 v21, v5, 4, v21
    v_add_u32 v5, s44, v4
    v_add_u32 v5, 256, v5
    v_mul_u32_u24 v6, 6554, v5
    v_lshrrev_b32 v6, 16, v6
    v_mul_u32_u24 v7, 10, v6
    v_sub_u32 v5, v5, v7
    v_mul_lo_u32 v22, v6, s43
    v_lshl_add_u32 v22, v5, 4, v22
    s_mul_i32 s36, s3, 245760
    s_add_u32 s36, s36, s27
    s_add_u32 m0, s32, 16384
    s_nop 0
    buffer_load_dwordx4 v18, s[16:19], s36 offen lds
    s_add_u32 m0, s32, 17408
    s_nop 0
    buffer_load_dwordx4 v19, s[16:19], s36 offen lds
    s_add_u32 m0, s32, 18432
    s_nop 0
    buffer_load_dwordx4 v20, s[16:19], s36 offen lds
    s_add_u32 m0, s32, 19456
    s_nop 0
    buffer_load_dwordx4 v21, s[16:19], s36 offen lds
    s_add_u32 m0, s32, 20480
    s_nop 0
    buffer_load_dwordx4 v22, s[16:19], s36 offen lds
    s_add_u32 s3, s11, 1
    s_sub_u32 s36, s3, 10
    s_cmp_ge_u32 s3, 10
    s_cselect_b32 s3, s36, s3
    s_lshl_b32 s36, s3, 7
    s_add_u32 s36, s36, s26
    s_add_u32 m0, s31, 29696
    s_add_u32 s37, s36, 0
    buffer_load_dwordx4 v16, s[12:15], s37 offen lds
    s_add_u32 m0, s31, 30720
    s_add_u32 s37, s36, 10240
    buffer_load_dwordx4 v17, s[12:15], s37 offen lds
    s_mul_i32 s36, s3, 245760
    s_add_u32 s36, s36, s27
    s_add_u32 m0, s32, 46080
    s_nop 0
    buffer_load_dwordx4 v18, s[16:19], s36 offen lds
    s_add_u32 m0, s32, 47104
    s_nop 0
    buffer_load_dwordx4 v19, s[16:19], s36 offen lds
    s_add_u32 m0, s32, 48128
    s_nop 0
    buffer_load_dwordx4 v20, s[16:19], s36 offen lds
    s_add_u32 m0, s32, 49152
    s_nop 0
    buffer_load_dwordx4 v21, s[16:19], s36 offen lds
    s_add_u32 m0, s32, 50176
    s_nop 0
    buffer_load_dwordx4 v22, s[16:19], s36 offen lds
    v_add_u32 v5, s44, v4
    v_mul_u32_u24 v6, 6554, v5
    v_lshrrev_b32 v6, 16, v6
    v_mul_u32_u24 v7, 10, v6
    v_sub_u32 v5, v5, v7
    v_mul_lo_u32 v24, v6, s24
    v_lshl_add_u32 v24, v5, 4, v24
    v_add_u32 v5, s44, v4
    v_add_u32 v5, 64, v5
    v_mul_u32_u24 v6, 6554, v5
    v_lshrrev_b32 v6, 16, v6
    v_mul_u32_u24 v7, 10, v6
    v_sub_u32 v5, v5, v7
    v_mul_lo_u32 v25, v6, s24
    v_lshl_add_u32 v25, v5, 4, v25
    v_add_u32 v5, s44, v4
    v_add_u32 v5, 128, v5
    v_mul_u32_u24 v6, 6554, v5
    v_lshrrev_b32 v6, 16, v6
    v_mul_u32_u24 v7, 10, v6
    v_sub_u32 v5, v5, v7
    v_mul_lo_u32 v26, v6, s24
    v_lshl_add_u32 v26, v5, 4, v26
    v_add_u32 v5, s44, v4
    v_add_u32 v5, 192, v5
    v_mul_u32_u24 v6, 6554, v5
    v_lshrrev_b32 v6, 16, v6
    v_mul_u32_u24 v7, 10, v6
    v_sub_u32 v5, v5, v7
    v_mul_lo_u32 v27, v6, s24
    v_lshl_add_u32 v27, v5, 4, v27
    v_add_u32 v5, s44, v4
    v_add_u32 v5, 256, v5
    v_mul_u32_u24 v6, 6554, v5
    v_lshrrev_b32 v6, 16, v6
    v_mul_u32_u24 v7, 10, v6
    v_sub_u32 v5, v5, v7
    v_mul_lo_u32 v28, v6, s24
    v_lshl_add_u32 v28, v5, 4, v28
    s_lshl_b32 s29, s24, 6
    s_mul_i32 s33, s8, 5120
    s_waitcnt vmcnt(7)
    s_barrier
    s_add_u32 s3, s11, 2
    s_sub_u32 s36, s3, 10
    s_cmp_ge_u32 s3, 10
    s_cselect_b32 s3, s36, s3
    s_lshl_b32 s36, s3, 7
    s_add_u32 s36, s36, s26
    s_add_u32 m0, s31, 59392
    s_add_u32 s37, s36, 0
    buffer_load_dwordx4 v16, s[12:15], s37 offen lds
    s_add_u32 m0, s31, 60416
    s_add_u32 s37, s36, 10240
    buffer_load_dwordx4 v17, s[12:15], s37 offen lds
    s_mul_i32 s36, s3, 245760
    s_add_u32 s36, s36, s27
    s_add_u32 m0, s32, 75776
    s_nop 0
    buffer_load_dwordx4 v18, s[16:19], s36 offen lds
    s_add_u32 m0, s32, 76800
    s_nop 0
    buffer_load_dwordx4 v19, s[16:19], s36 offen lds
    s_add_u32 m0, s32, 77824
    s_nop 0
    buffer_load_dwordx4 v20, s[16:19], s36 offen lds
    s_add_u32 m0, s32, 78848
    s_nop 0
    buffer_load_dwordx4 v21, s[16:19], s36 offen lds
    s_add_u32 m0, s32, 79872
    s_nop 0
    buffer_load_dwordx4 v22, s[16:19], s36 offen lds
    s_waitcnt vmcnt(7)
    s_barrier
    s_add_u32 s3, s11, 3
    s_sub_u32 s36, s3, 10
    s_cmp_ge_u32 s3, 10
    s_cselect_b32 s3, s36, s3
    s_lshl_b32 s36, s3, 7
    s_add_u32 s36, s36, s26
    s_add_u32 m0, s31, 89088
    s_add_u32 s37, s36, 0
    buffer_load_dwordx4 v16, s[12:15], s37 offen lds
    s_add_u32 m0, s31, 90112
    s_add_u32 s37, s36, 10240
    buffer_load_dwordx4 v17, s[12:15], s37 offen lds
    s_mul_i32 s36, s3, 245760
    s_add_u32 s36, s36, s27
    s_add_u32 m0, s32, 105472
    s_nop 0
    buffer_load_dwordx4 v18, s[16:19], s36 offen lds
    s_add_u32 m0, s32, 106496
    s_nop 0
    buffer_load_dwordx4 v19, s[16:19], s36 offen lds
    s_add_u32 m0, s32, 107520
    s_nop 0
    buffer_load_dwordx4 v20, s[16:19], s36 offen lds
    s_add_u32 m0, s32, 108544
    s_nop 0
    buffer_load_dwordx4 v21, s[16:19], s36 offen lds
    s_add_u32 m0, s32, 109568
    s_nop 0
    buffer_load_dwordx4 v22, s[16:19], s36 offen lds
    s_waitcnt vmcnt(7)
    s_barrier
    s_add_u32 s3, s11, 4
    s_sub_u32 s36, s3, 10
    s_cmp_ge_u32 s3, 10
    s_cselect_b32 s3, s36, s3
    s_lshl_b32 s36, s3, 7
    s_add_u32 s36, s36, s26
    s_add_u32 m0, s31, 118784
    s_add_u32 s37, s36, 0
    buffer_load_dwordx4 v16, s[12:15], s37 offen lds
    s_add_u32 m0, s31, 119808
    s_add_u32 s37, s36, 10240
    buffer_load_dwordx4 v17, s[12:15], s37 offen lds
    s_mul_i32 s36, s3, 245760
    s_add_u32 s36, s36, s27
    s_add_u32 m0, s32, 135168
    s_nop 0
    buffer_load_dwordx4 v18, s[16:19], s36 offen lds
    s_add_u32 m0, s32, 136192
    s_nop 0
    buffer_load_dwordx4 v19, s[16:19], s36 offen lds
    s_add_u32 m0, s32, 137216
    s_nop 0
    buffer_load_dwordx4 v20, s[16:19], s36 offen lds
    s_add_u32 m0, s32, 138240
    s_nop 0
    buffer_load_dwordx4 v21, s[16:19], s36 offen lds
    s_add_u32 m0, s32, 139264
    s_nop 0
    buffer_load_dwordx4 v22, s[16:19], s36 offen lds
    s_waitcnt vmcnt(7)
    s_barrier
    s_add_u32 s3, s11, 5
    s_sub_u32 s36, s3, 10
    s_cmp_ge_u32 s3, 10
    s_cselect_b32 s3, s36, s3
    s_lshl_b32 s36, s3, 7
    s_add_u32 s36, s36, s26
    s_add_u32 m0, s31, 0
    s_add_u32 s37, s36, 0
    buffer_load_dwordx4 v16, s[12:15], s37 offen lds
    s_add_u32 m0, s31, 1024
    s_add_u32 s37, s36, 10240
    buffer_load_dwordx4 v17, s[12:15], s37 offen lds
    s_mul_i32 s36, s3, 245760
    s_add_u32 s36, s36, s27
    s_add_u32 m0, s32, 16384
    s_nop 0
    buffer_load_dwordx4 v18, s[16:19], s36 offen lds
    s_add_u32 m0, s32, 17408
    s_nop 0
    buffer_load_dwordx4 v19, s[16:19], s36 offen lds
    s_add_u32 m0, s32, 18432
    s_nop 0
    buffer_load_dwordx4 v20, s[16:19], s36 offen lds
    s_add_u32 m0, s32, 19456
    s_nop 0
    buffer_load_dwordx4 v21, s[16:19], s36 offen lds
    s_add_u32 m0, s32, 20480
    s_nop 0
    buffer_load_dwordx4 v22, s[16:19], s36 offen lds
    s_waitcnt vmcnt(7)
    s_barrier
    s_add_u32 s3, s11, 6
    s_sub_u32 s36, s3, 10
    s_cmp_ge_u32 s3, 10
    s_cselect_b32 s3, s36, s3
    s_lshl_b32 s36, s3, 7
    s_add_u32 s36, s36, s26
    s_add_u32 m0, s31, 29696
    s_add_u32 s37, s36, 0
    buffer_load_dwordx4 v16, s[12:15], s37 offen lds
    s_add_u32 m0, s31, 30720
    s_add_u32 s37, s36, 10240
    buffer_load_dwordx4 v17, s[12:15], s37 offen lds
    s_mul_i32 s36, s3, 245760
    s_add_u32 s36, s36, s27
    s_add_u32 m0, s32, 46080
    s_nop 0
    buffer_load_dwordx4 v18, s[16:19], s36 offen lds
    s_add_u32 m0, s32, 47104
    s_nop 0
    buffer_load_dwordx4 v19, s[16:19], s36 offen lds
    s_add_u32 m0, s32, 48128
    s_nop 0
    buffer_load_dwordx4 v20, s[16:19], s36 offen lds
    s_add_u32 m0, s32, 49152
    s_nop 0
    buffer_load_dwordx4 v21, s[16:19], s36 offen lds
    s_add_u32 m0, s32, 50176
    s_nop 0
    buffer_load_dwordx4 v22, s[16:19], s36 offen lds
    s_waitcnt vmcnt(7)
    s_barrier
    s_add_u32 s3, s11, 7
    s_sub_u32 s36, s3, 10
    s_cmp_ge_u32 s3, 10
    s_cselect_b32 s3, s36, s3
    s_lshl_b32 s36, s3, 7
    s_add_u32 s36, s36, s26
    s_add_u32 m0, s31, 59392
    s_add_u32 s37, s36, 0
    buffer_load_dwordx4 v16, s[12:15], s37 offen lds
    s_add_u32 m0, s31, 60416
    s_add_u32 s37, s36, 10240
    buffer_load_dwordx4 v17, s[12:15], s37 offen lds
    s_mul_i32 s36, s3, 245760
    s_add_u32 s36, s36, s27
    s_add_u32 m0, s32, 75776
    s_nop 0
    buffer_load_dwordx4 v18, s[16:19], s36 offen lds
    s_add_u32 m0, s32, 76800
    s_nop 0
    buffer_load_dwordx4 v19, s[16:19], s36 offen lds
    s_add_u32 m0, s32, 77824
    s_nop 0
    buffer_load_dwordx4 v20, s[16:19], s36 offen lds
    s_add_u32 m0, s32, 78848
    s_nop 0
    buffer_load_dwordx4 v21, s[16:19], s36 offen lds
    s_add_u32 m0, s32, 79872
    s_nop 0
    buffer_load_dwordx4 v22, s[16:19], s36 offen lds
    s_waitcnt vmcnt(7)
    s_barrier
    s_add_u32 s3, s11, 8
    s_sub_u32 s36, s3, 10
    s_cmp_ge_u32 s3, 10
    s_cselect_b32 s3, s36, s3
    s_lshl_b32 s36, s3, 7
    s_add_u32 s36, s36, s26
    s_add_u32 m0, s31, 89088
    s_add_u32 s37, s36, 0
    buffer_load_dwordx4 v16, s[12:15], s37 offen lds
    s_add_u32 m0, s31, 90112
    s_add_u32 s37, s36, 10240
    buffer_load_dwordx4 v17, s[12:15], s37 offen lds
    s_mul_i32 s36, s3, 245760
    s_add_u32 s36, s36, s27
    s_add_u32 m0, s32, 105472
    s_nop 0
    buffer_load_dwordx4 v18, s[16:19], s36 offen lds
    s_add_u32 m0, s32, 106496
    s_nop 0
    buffer_load_dwordx4 v19, s[16:19], s36 offen lds
    s_add_u32 m0, s32, 107520
    s_nop 0
    buffer_load_dwordx4 v20, s[16:19], s36 offen lds
    s_add_u32 m0, s32, 108544
    s_nop 0
    buffer_load_dwordx4 v21, s[16:19], s36 offen lds
    s_add_u32 m0, s32, 109568
    s_nop 0
    buffer_load_dwordx4 v22, s[16:19], s36 offen lds
    s_waitcnt vmcnt(7)
    s_barrier
    s_add_u32 s3, s11, 9
    s_sub_u32 s36, s3, 10
    s_cmp_ge_u32 s3, 10
    s_cselect_b32 s3, s36, s3
    s_lshl_b32 s36, s3, 7
    s_add_u32 s36, s36, s26
    s_add_u32 m0, s31, 118784
    s_add_u32 s37, s36, 0
    buffer_load_dwordx4 v16, s[12:15], s37 offen lds
    s_add_u32 m0, s31, 119808
    s_add_u32 s37, s36, 10240
    buffer_load_dwordx4 v17, s[12:15], s37 offen lds
    s_mul_i32 s36, s3, 245760
    s_add_u32 s36, s36, s27
    s_add_u32 m0, s32, 135168
    s_nop 0
    buffer_load_dwordx4 v18, s[16:19], s36 offen lds
    s_add_u32 m0, s32, 136192
    s_nop 0
    buffer_load_dwordx4 v19, s[16:19], s36 offen lds
    s_add_u32 m0, s32, 137216
    s_nop 0
    buffer_load_dwordx4 v20, s[16:19], s36 offen lds
    s_add_u32 m0, s32, 138240
    s_nop 0
    buffer_load_dwordx4 v21, s[16:19], s36 offen lds
    s_add_u32 m0, s32, 139264
    s_nop 0
    buffer_load_dwordx4 v22, s[16:19], s36 offen lds
    s_waitcnt vmcnt(7)
    s_barrier
    s_cmp_lg_u32 s53, 4
    s_cbranch_scc1 L_mk_td2
    v_mov_b32 v253, 0
    s_mov_b32 s36, 0
L_mk_tl2:
    buffer_load_dwordx2 v[254:255], v253, s[60:63], 0 offen sc1
    s_waitcnt vmcnt(0)
    v_readfirstlane_b32 s37, v254
    s_add_u32 s36, s36, 1
    s_nop 2
    s_cmp_lg_u32 s37, 0
    s_cbranch_scc1 L_mk_td2
    s_sleep 2
    s_cmp_lt_u32 s36, 100000
    s_cbranch_scc1 L_mk_tl2
L_mk_td2:
    s_add_u32 s3, s11, 0
    s_sub_u32 s36, s3, 10
    s_cmp_ge_u32 s3, 10
    s_cselect_b32 s3, s36, s3
    s_mul_i32 s36, s3, s29
    s_add_u32 s36, s36, s30
    s_add_u32 m0, s33, 0
    s_nop 0
    buffer_load_dwordx4 v24, s[48:51], s36 offen lds
    s_add_u32 m0, s33, 1024
    s_nop 0
    buffer_load_dwordx4 v25, s[48:51], s36 offen lds
    s_add_u32 m0, s33, 2048
    s_nop 0
    buffer_load_dwordx4 v26, s[48:51], s36 offen lds
    s_add_u32 m0, s33, 3072
    s_nop 0
    buffer_load_dwordx4 v27, s[48:51], s36 offen lds
    s_add_u32 m0, s33, 4096
    s_nop 0
    buffer_load_dwordx4 v28, s[48:51], s36 offen lds
    s_waitcnt vmcnt(5)
    s_barrier
    s_add_u32 s3, s11, 2
    s_sub_u32 s36, s3, 10
    s_cmp_ge_u32 s3, 10
    s_cselect_b32 s3, s36, s3
    s_mul_i32 s36, s3, s29
    s_add_u32 s36, s36, s30
    s_add_u32 m0, s33, 29696
    s_nop 0
    buffer_load_dwordx4 v24, s[48:51], s36 offen lds
    s_add_u32 m0, s33, 30720
    s_nop 0
    buffer_load_dwordx4 v25, s[48:51], s36 offen lds
    s_add_u32 m0, s33, 31744
    s_nop 0
    buffer_load_dwordx4 v26, s[48:51], s36 offen lds
    s_add_u32 m0, s33, 32768
    s_nop 0
    buffer_load_dwordx4 v27, s[48:51], s36 offen lds
    s_add_u32 m0, s33, 33792
    s_nop 0
    buffer_load_dwordx4 v28, s[48:51], s36 offen lds
    s_waitcnt vmcnt(5)
    s_barrier
    s_add_u32 s3, s11, 4
    s_sub_u32 s36, s3, 10
    s_cmp_ge_u32 s3, 10
    s_cselect_b32 s3, s36, s3
    s_mul_i32 s36, s3, s29
    s_add_u32 s36, s36, s30
    s_add_u32 m0, s33, 59392
    s_nop 0
    buffer_load_dwordx4 v24, s[48:51], s36 offen lds
    s_add_u32 m0, s33, 60416
    s_nop 0
    buffer_load_dwordx4 v25, s[48:51], s36 offen lds
    s_add_u32 m0, s33, 61440
    s_nop 0
    buffer_load_dwordx4 v26, s[48:51], s36 offen lds
    s_add_u32 m0, s33, 62464
    s_nop 0
    buffer_load_dwordx4 v27, s[48:51], s36 offen lds
    s_add_u32 m0, s33, 63488
    s_nop 0
    buffer_load_dwordx4 v28, s[48:51], s36 offen lds
    s_waitcnt vmcnt(5)
    s_barrier
    s_add_u32 s3, s11, 6
    s_sub_u32 s36, s3, 10
    s_cmp_ge_u32 s3, 10
    s_cselect_b32 s3, s36, s3
    s_mul_i32 s36, s3, s29
    s_add_u32 s36, s36, s30
    s_add_u32 m0, s33, 89088
    s_nop 0
    buffer_load_dwordx4 v24, s[48:51], s36 offen lds
    s_add_u32 m0, s33, 90112
    s_nop 0
    buffer_load_dwordx4 v25, s[48:51], s36 offen lds
    s_add_u32 m0, s33, 91136
    s_nop 0
    buffer_load_dwordx4 v26, s[48:51], s36 offen lds
    s_add_u32 m0, s33, 92160
    s_nop 0
    buffer_load_dwordx4 v27, s[48:51], s36 offen lds
    s_add_u32 m0, s33, 93184
    s_nop 0
    buffer_load_dwordx4 v28, s[48:51], s36 offen lds
    s_waitcnt vmcnt(5)
    s_barrier
    s_cmp_lg_u32 s53, 4
    s_cbranch_scc1 L_mk_sig0_3
    v_and_b32 v253, 63, v0
    v_lshlrev_b32 v253, 3, v253
    s_lshl_b32 s36, s55, 4
    s_add_u32 s36, s36, s58
    s_lshl_b32 s36, s36, 7
    s_add_u32 s36, s36, 15941632
    s_mov_b64 exec, 0xffff
    buffer_store_dwordx2 v[254:255], v253, s[4:7], s36 offen sc1
    s_mov_b64 exec, -1
    s_waitcnt vmcnt(0)
L_mk_sig0_3:
    s_add_u32 s3, s11, 8
    s_sub_u32 s36, s3, 10
    s_cmp_ge_u32 s3, 10
    s_cselect_b32 s3, s36, s3
    s_mul_i32 s36, s3, s29
    s_add_u32 s36, s36, s30
    s_add_u32 m0, s33, 118784
    s_nop 0
    buffer_load_dwordx4 v24, s[48:51], s36 offen lds
    s_add_u32 m0, s33, 119808
    s_nop 0
    buffer_load_dwordx4 v25, s[48:51], s36 offen lds
    s_add_u32 m0, s33, 120832
    s_nop 0
    buffer_load_dwordx4 v26, s[48:51], s36 offen lds
    s_add_u32 m0, s33, 121856
    s_nop 0
    buffer_load_dwordx4 v27, s[48:51], s36 offen lds
    s_add_u32 m0, s33, 122880
    s_nop 0
    buffer_load_dwordx4 v28, s[48:51], s36 offen lds
    s_waitcnt vmcnt(5)
    s_barrier
    s_waitcnt vmcnt(0)
    s_barrier
    v_and_b32 v168, 63, v0
    v_lshlrev_b32 v1, 4, v168
    v_and_b32 v169, 31, v0
    v_bfe_u32 v170, v0, 5, 1
    v_lshlrev_b32 v2, 3, v169
    v_lshl_add_u32 v2, v170, 2, v2
    v_add_u32 v2, 1024, v2
    v_mul_u32_u24 v3, 320, v170
    v_lshl_add_u32 v3, v169, 4, v3
    v_add_u32 v3, 1280, v3
    s_mov_b32 s14, 0x000fffff
    s_mov_b32 s15, 0x000fffff
    s_mov_b32 s16, 0
    s_mov_b32 s17, -1
    s_mov_b32 s20, 0
    s_mov_b32 s18, 0x00100000
    s_mov_b32 s19, 0x00100000
    v_mov_b32 v37, 0x3f803f80
    v_mov_b32 v40, 0
    v_mov_b32 v41, 0
    v_mov_b32 v42, 0
    v_mov_b32 v43, 0
    v_mov_b32 v44, 0
    v_mov_b32 v45, 0
    v_mov_b32 v46, 0
    v_mov_b32 v47, 0
    v_mov_b32 v39, 0x3f803f80
    v_mov_b32 v48, 0
    v_mov_b32 v49, 0
    v_mov_b32 v50, 0
    v_mov_b32 v51, 0
    v_mov_b32 v52, 0
    v_mov_b32 v53, 0
    v_mov_b32 v54, 0
    v_mov_b32 v55, 0
    s_mov_b64 exec, s[18:19]
    v_mov_b32 v40, 0x3f803f80
    v_mov_b32 v41, 0x3f803f80
    v_mov_b32 v42, 0x3f803f80
    v_mov_b32 v43, 0x3f803f80
    v_mov_b32 v44, 0x3f803f80
    v_mov_b32 v45, 0x3f803f80
    v_mov_b32 v46, 0x3f803f80
    v_mov_b32 v47, 0x3f803f80
    v_mov_b32 v48, 0x3f803f80
    v_mov_b32 v49, 0x3f803f80
    v_mov_b32 v50, 0x3f803f80
    v_mov_b32 v51, 0x3f803f80
    v_mov_b32 v52, 0x3f803f80
    v_mov_b32 v53, 0x3f803f80
    v_mov_b32 v54, 0x3f803f80
    v_mov_b32 v55, 0x3f803f80
    s_mov_b64 exec, -1
    s_mov_b32 s9, s54
    s_mov_b32 s10, s55
    s_mov_b32 s11, s56
    s_mov_b32 s13, s57
    s_mov_b32 s22, s59
    s_lshl_b32 s28, s56, 8
    s_add_u32 s28, s28, 10649600
    s_add_u32 s29, s28, 8448
    s_mul_i32 s25, s8, 5120
    s_add_u32 s25, s25, 49152
    s_mul_i32 s26, s57, 2560
    s_add_u32 s27, s25, s26
    s_sub_u32 s25, s25, s26
    s_add_u32 s25, s25, 2560
    s_load_dwordx2 s[40:41], s[0:1], 32
    s_load_dwordx2 s[42:43], s[0:1], 56
    s_and_b32 s48, s53, 1
    s_bfe_u32 s49, s53, 0x10001
    s_lshr_b32 s50, s53, 2
    s_and_b32 s51, s58, 3
    s_lshr_b32 s36, s58, 3
    s_lshl_b32 s36, s36, 2
    s_add_u32 s51, s51, s36
    s_mov_b32 s99, s51
    s_add_u32 s98, s99, s48
    s_mul_i32 s51, s51, 160
    s_mul_i32 s44, s48, 20480
    s_mul_i32 s36, s49, 10240
    s_add_u32 s44, s44, s36
    s_mul_i32 s36, s50, 5120
    s_add_u32 s44, s44, s36
    s_lshl_b32 s36, s48, 1
    s_add_u32 s36, s36, s50
    s_mul_i32 s45, s50, 51200
    s_add_u32 s45, s45, s51
    s_mul_i32 s46, s36, 204800
    s_add_u32 s46, s46, s51
    s_waitcnt lgkmcnt(0)
    s_cmp_eq_u32 s48, 0
    s_cselect_b32 s100, s40, s42
    s_cselect_b32 s101, s41, s43
    s_cmp_eq_u32 s49, 0
    s_cselect_b32 s40, s40, s42
    s_cselect_b32 s41, s41, s43
    s_and_b32 s41, s41, 0xffff
    s_mov_b32 s42, 819200
    s_mov_b32 s43, 0x20000
    s_lshl_b32 s36, s52, 3
    s_add_u32 s36, s36, s53
    s_lshr_b32 s37, s36, 1
    s_mul_i32 s47, s37, 6400
    s_add_u32 s52, s47, 6272
    s_cmp_lg_u32 s53, 4
    s_cbranch_scc1 L_mk_pd4
    v_and_b32 v250, 63, v0
    v_and_b32 v251, 15, v250
    v_lshlrev_b32 v251, 4, v251
    v_bfe_u32 v252, v250, 4, 1
    v_bfe_u32 v253, v250, 5, 1
    s_and_b32 s36, s58, 7
    s_cmp_lt_u32 s58, 8
    s_cselect_b32 s36, 0, s36
    s_cselect_b32 s37, 0, 3
    s_cselect_b32 s38, 3, 8
    v_lshlrev_b32 v252, s37, v252
    v_lshlrev_b32 v253, s38, v253
    v_and_b32 v253, 15, v253
    v_add3_u32 v251, v251, v252, v253
    v_add_u32 v251, s36, v251
    v_lshlrev_b32 v251, 7, v251
    s_mov_b32 s36, 0
    s_mov_b32 s37, 15941632
L_mk_pl4:
    buffer_load_dwordx2 v[252:253], v251, s[4:7], s37 offen sc1
    s_waitcnt vmcnt(0)
    v_cmp_ne_u64 vcc, v[252:253], v[254:255]
    s_add_u32 s36, s36, 1
    s_nop 3
    s_cmp_eq_u64 vcc, 0
    s_cbranch_scc1 L_mk_pd4
    s_mov_b64 exec, vcc
    s_sleep 2
    s_cmp_lt_u32 s36, 100000
    s_cbranch_scc1 L_mk_pl4
L_mk_pd4:
    s_mov_b64 exec, -1
    s_cmp_lg_u32 s53, 4
    s_cbranch_scc1 L_mk_wm
    s_cmp_eq_u32 s56, 0
    s_cselect_b32 s36, 0, 163840
    s_sub_u32 s37, s59, 81920
    buffer_load_dwordx4 v[232:235], v1, s[4:7], s28 offen
    buffer_load_dword v232, v1, s[4:7], s29 offen
    s_mov_b32 s38, s37
    s_add_u32 s39, s38, 0
    buffer_load_dwordx4 v[232:235], v1, s[4:7], s39 offen offset:0
    buffer_load_dwordx4 v[232:235], v1, s[4:7], s39 offen offset:1024
    s_add_u32 s39, s38, 81920
    buffer_load_dwordx4 v[232:235], v1, s[4:7], s39 offen offset:0
    buffer_load_dwordx4 v[232:235], v1, s[4:7], s39 offen offset:1024
    s_add_u32 s38, s38, s36
    s_add_u32 s39, s38, 0
    buffer_load_dwordx4 v[232:235], v1, s[4:7], s39 offen offset:0
    buffer_load_dwordx4 v[232:235], v1, s[4:7], s39 offen offset:1024
    s_add_u32 s39, s38, 81920
    buffer_load_dwordx4 v[232:235], v1, s[4:7], s39 offen offset:0
    buffer_load_dwordx4 v[232:235], v1, s[4:7], s39 offen offset:1024
    s_add_u32 s38, s38, s36
    s_add_u32 s39, s38, 0
    buffer_load_dwordx4 v[232:235], v1, s[4:7], s39 offen offset:0
    buffer_load_dwordx4 v[232:235], v1, s[4:7], s39 offen offset:1024
    s_add_u32 s39, s38, 81920
    buffer_load_dwordx4 v[232:235], v1, s[4:7], s39 offen offset:0
    buffer_load_dwordx4 v[232:235], v1, s[4:7], s39 offen offset:1024
    s_add_u32 s38, s38, s36
    s_add_u32 s39, s38, 0
    buffer_load_dwordx4 v[232:235], v1, s[4:7], s39 offen offset:0
    buffer_load_dwordx4 v[232:235], v1, s[4:7], s39 offen offset:1024
    s_add_u32 s39, s38, 81920
    buffer_load_dwordx4 v[232:235], v1, s[4:7], s39 offen offset:0
    buffer_load_dwordx4 v[232:235], v1, s[4:7], s39 offen offset:1024
    s_add_u32 s38, s38, s36
    s_mov_b32 s38, s37
    s_add_u32 s39, s38, 0
    buffer_load_dwordx4 v[232:235], v1, s[4:7], s39 offen offset:2048
    buffer_load_dwordx4 v[232:235], v1, s[4:7], s39 offen offset:3072
    s_add_u32 s39, s38, 81920
    buffer_load_dwordx4 v[232:235], v1, s[4:7], s39 offen offset:2048
    buffer_load_dwordx4 v[232:235], v1, s[4:7], s39 offen offset:3072
    s_add_u32 s38, s38, s36
    s_add_u32 s39, s38, 0
    buffer_load_dwordx4 v[232:235], v1, s[4:7], s39 offen offset:2048
    buffer_load_dwordx4 v[232:235], v1, s[4:7], s39 offen offset:3072
    s_add_u32 s39, s38, 81920
    buffer_load_dwordx4 v[232:235], v1, s[4:7], s39 offen offset:2048
    buffer_load_dwordx4 v[232:235], v1, s[4:7], s39 offen offset:3072
    s_add_u32 s38, s38, s36
    s_add_u32 s39, s38, 0
    buffer_load_dwordx4 v[232:235], v1, s[4:7], s39 offen offset:2048
    buffer_load_dwordx4 v[232:235], v1, s[4:7], s39 offen offset:3072
    s_add_u32 s39, s38, 81920
    buffer_load_dwordx4 v[232:235], v1, s[4:7], s39 offen offset:2048
    buffer_load_dwordx4 v[232:235], v1, s[4:7], s39 offen offset:3072
    s_add_u32 s38, s38, s36
    s_add_u32 s39, s38, 0
    buffer_load_dwordx4 v[232:235], v1, s[4:7], s39 offen offset:2048
    buffer_load_dwordx4 v[232:235], v1, s[4:7], s39 offen offset:3072
    s_add_u32 s39, s38, 81920
    buffer_load_dwordx4 v[232:235], v1, s[4:7], s39 offen offset:2048
    buffer_load_dwordx4 v[232:235], v1, s[4:7], s39 offen offset:3072
    s_add_u32 s38, s38, s36
L_mk_wm:
    s_barrier
    s_branch L_mk_join
L_mk_ld1:
    s_cmp_eq_u32 s34, 0
    s_cbranch_scc1 L_mk_ld1b
    s_add_u32 s3, s11, 0
    s_sub_u32 s36, s3, 10
    s_cmp_ge_u32 s3, 10
    s_cselect_b32 s3, s36, s3
    s_lshl_b32 s36, s3, 7
    s_add_u32 s36, s36, s26
    s_add_u32 m0, s31, 0
    s_add_u32 s37, s36, 0
    buffer_load_dwordx4 v16, s[12:15], s37 offen lds
    s_add_u32 m0, s31, 1024
    s_add_u32 s37, s36, 10240
    buffer_load_dwordx4 v17, s[12:15], s37 offen lds
    s_add_u32 m0, s31, 2048
    s_add_u32 s37, s36, 20480
    buffer_load_dwordx4 v16, s[12:15], s37 offen lds
    s_add_u32 m0, s31, 3072
    s_add_u32 s37, s36, 30720
    buffer_load_dwordx4 v17, s[12:15], s37 offen lds
    s_add_u32 m0, s31, 4096
    s_add_u32 s37, s36, 40960
    buffer_load_dwordx4 v16, s[12:15], s37 offen lds
    s_add_u32 m0, s31, 5120
    s_add_u32 s37, s36, 51200
    buffer_load_dwordx4 v17, s[12:15], s37 offen lds
    s_mov_b32 s4, s62
    s_and_b32 s5, s63, 0xffff
    s_mov_b32 s6, 268435456
    s_mov_b32 s7, 0x20000
    s_and_b32 s61, s61, 0xffff
    s_mov_b32 s62, 256
    s_mov_b32 s63, 0x20000
    s_and_b32 s17, s17, 0xffff
    s_cmp_lt_u32 s10, 8
    s_cselect_b32 s48, s48, s16
    s_cselect_b32 s49, s49, s17
    s_cselect_b32 s24, s24, 3840
    s_cselect_b32 s20, s20, s22
    s_cselect_b32 s21, s21, s23
    s_and_b32 s41, s41, 0xffff
    s_and_b32 s49, s49, 0xffff
    s_mul_i32 s50, s24, 640
    s_mov_b32 s51, 0x20000
    s_and_b32 s21, s21, 0xffff
    s_mov_b32 s22, 25600
    s_mov_b32 s23, 0x20000
    s_mov_b32 s18, 2457600
    s_mov_b32 s19, 0x20000
    s_and_b32 s36, s8, 1
    s_mul_i32 s44, s36, 320
    s_mul_i32 s32, s36, 5120
    s_mov_b32 s43, 3840
    v_lshlrev_b32 v23, 4, v4
    s_mul_i32 s28, s36, 1280
    s_mul_i32 s36, s3, 2560
    s_add_u32 s36, s36, s28
    s_add_u32 m0, s28, 26624
    s_mov_b64 exec, s[34:35]
    buffer_load_dwordx4 v23, s[20:23], s36 offen lds
    s_mov_b64 exec, s[38:39]
    buffer_load_dwordx4 v23, s[20:23], s36 offen offset:1024 lds
    s_mov_b64 exec, -1
    s_add_u32 s3, s11, 1
    s_sub_u32 s36, s3, 10
    s_cmp_ge_u32 s3, 10
    s_cselect_b32 s3, s36, s3
    s_lshl_b32 s36, s3, 7
    s_add_u32 s36, s36, s26
    s_add_u32 m0, s31, 29696
    s_add_u32 s37, s36, 0
    buffer_load_dwordx4 v16, s[12:15], s37 offen lds
    s_add_u32 m0, s31, 30720
    s_add_u32 s37, s36, 10240
    buffer_load_dwordx4 v17, s[12:15], s37 offen lds
    s_add_u32 m0, s31, 31744
    s_add_u32 s37, s36, 20480
    buffer_load_dwordx4 v16, s[12:15], s37 offen lds
    s_add_u32 m0, s31, 32768
    s_add_u32 s37, s36, 30720
    buffer_load_dwordx4 v17, s[12:15], s37 offen lds
    s_add_u32 m0, s31, 33792
    s_add_u32 s37, s36, 40960
    buffer_load_dwordx4 v16, s[12:15], s37 offen lds
    s_add_u32 m0, s31, 34816
    s_add_u32 s37, s36, 51200
    buffer_load_dwordx4 v17, s[12:15], s37 offen lds
    s_mul_i32 s36, s3, 2560
    s_add_u32 s36, s36, s28
    s_add_u32 m0, s28, 56320
    s_mov_b64 exec, s[34:35]
    buffer_load_dwordx4 v23, s[20:23], s36 offen lds
    s_mov_b64 exec, s[38:39]
    buffer_load_dwordx4 v23, s[20:23], s36 offen offset:1024 lds
    s_mov_b64 exec, -1
    v_add_u32 v5, s44, v4
    v_mul_u32_u24 v6, 6554, v5
    v_lshrrev_b32 v6, 16, v6
    v_mul_u32_u24 v7, 10, v6
    v_sub_u32 v5, v5, v7
    v_mul_lo_u32 v24, v6, s24
    v_lshl_add_u32 v24, v5, 4, v24
    v_add_u32 v5, s44, v4
    v_add_u32 v5, 64, v5
    v_mul_u32_u24 v6, 6554, v5
    v_lshrrev_b32 v6, 16, v6
    v_mul_u32_u24 v7, 10, v6
    v_sub_u32 v5, v5, v7
    v_mul_lo_u32 v25, v6, s24
    v_lshl_add_u32 v25, v5, 4, v25
    v_add_u32 v5, s44, v4
    v_add_u32 v5, 128, v5
    v_mul_u32_u24 v6, 6554, v5
    v_lshrrev_b32 v6, 16, v6
    v_mul_u32_u24 v7, 10, v6
    v_sub_u32 v5, v5, v7
    v_mul_lo_u32 v26, v6, s24
    v_lshl_add_u32 v26, v5, 4, v26
    v_add_u32 v5, s44, v4
    v_add_u32 v5, 192, v5
    v_mul_u32_u24 v6, 6554, v5
    v_lshrrev_b32 v6, 16, v6
    v_mul_u32_u24 v7, 10, v6
    v_sub_u32 v5, v5, v7
    v_mul_lo_u32 v27, v6, s24
    v_lshl_add_u32 v27, v5, 4, v27
    v_add_u32 v5, s44, v4
    v_add_u32 v5, 256, v5
    v_mul_u32_u24 v6, 6554, v5
    v_lshrrev_b32 v6, 16, v6
    v_mul_u32_u24 v7, 10, v6
    v_sub_u32 v5, v5, v7
    v_mul_lo_u32 v28, v6, s24
    v_lshl_add_u32 v28, v5, 4, v28
    s_lshl_b32 s29, s24, 6
    s_mul_i32 s33, s8, 5120
    s_waitcnt vmcnt(8)
    s_barrier
    s_add_u32 s3, s11, 2
    s_sub_u32 s36, s3, 10
    s_cmp_ge_u32 s3, 10
    s_cselect_b32 s3, s36, s3
    s_lshl_b32 s36, s3, 7
    s_add_u32 s36, s36, s26
    s_add_u32 m0, s31, 59392
    s_add_u32 s37, s36, 0
    buffer_load_dwordx4 v16, s[12:15], s37 offen lds
    s_add_u32 m0, s31, 60416
    s_add_u32 s37, s36, 10240
    buffer_load_dwordx4 v17, s[12:15], s37 offen lds
    s_add_u32 m0, s31, 61440
    s_add_u32 s37, s36, 20480
    buffer_load_dwordx4 v16, s[12:15], s37 offen lds
    s_add_u32 m0, s31, 62464
    s_add_u32 s37, s36, 30720
    buffer_load_dwordx4 v17, s[12:15], s37 offen lds
    s_add_u32 m0, s31, 63488
    s_add_u32 s37, s36, 40960
    buffer_load_dwordx4 v16, s[12:15], s37 offen lds
    s_add_u32 m0, s31, 64512
    s_add_u32 s37, s36, 51200
    buffer_load_dwordx4 v17, s[12:15], s37 offen lds
    s_mul_i32 s36, s3, 2560
    s_add_u32 s36, s36, s28
    s_add_u32 m0, s28, 86016
    s_mov_b64 exec, s[34:35]
    buffer_load_dwordx4 v23, s[20:23], s36 offen lds
    s_mov_b64 exec, s[38:39]
    buffer_load_dwordx4 v23, s[20:23], s36 offen offset:1024 lds
    s_mov_b64 exec, -1
    s_waitcnt vmcnt(8)
    s_barrier
    s_add_u32 s3, s11, 3
    s_sub_u32 s36, s3, 10
    s_cmp_ge_u32 s3, 10
    s_cselect_b32 s3, s36, s3
    s_lshl_b32 s36, s3, 7
    s_add_u32 s36, s36, s26
    s_add_u32 m0, s31, 89088
    s_add_u32 s37, s36, 0
    buffer_load_dwordx4 v16, s[12:15], s37 offen lds
    s_add_u32 m0, s31, 90112
    s_add_u32 s37, s36, 10240
    buffer_load_dwordx4 v17, s[12:15], s37 offen lds
    s_add_u32 m0, s31, 91136
    s_add_u32 s37, s36, 20480
    buffer_load_dwordx4 v16, s[12:15], s37 offen lds
    s_add_u32 m0, s31, 92160
    s_add_u32 s37, s36, 30720
    buffer_load_dwordx4 v17, s[12:15], s37 offen lds
    s_add_u32 m0, s31, 93184
    s_add_u32 s37, s36, 40960
    buffer_load_dwordx4 v16, s[12:15], s37 offen lds
    s_add_u32 m0, s31, 94208
    s_add_u32 s37, s36, 51200
    buffer_load_dwordx4 v17, s[12:15], s37 offen lds
    s_mul_i32 s36, s3, 2560
    s_add_u32 s36, s36, s28
    s_add_u32 m0, s28, 115712
    s_mov_b64 exec, s[34:35]
    buffer_load_dwordx4 v23, s[20:23], s36 offen lds
    s_mov_b64 exec, s[38:39]
    buffer_load_dwordx4 v23, s[20:23], s36 offen offset:1024 lds
    s_mov_b64 exec, -1
    s_waitcnt vmcnt(8)
    s_barrier
    s_add_u32 s3, s11, 4
    s_sub_u32 s36, s3, 10
    s_cmp_ge_u32 s3, 10
    s_cselect_b32 s3, s36, s3
    s_lshl_b32 s36, s3, 7
    s_add_u32 s36, s36, s26
    s_add_u32 m0, s31, 118784
    s_add_u32 s37, s36, 0
    buffer_load_dwordx4 v16, s[12:15], s37 offen lds
    s_add_u32 m0, s31, 119808
    s_add_u32 s37, s36, 10240
    buffer_load_dwordx4 v17, s[12:15], s37 offen lds
    s_add_u32 m0, s31, 120832
    s_add_u32 s37, s36, 20480
    buffer_load_dwordx4 v16, s[12:15], s37 offen lds
    s_add_u32 m0, s31, 121856
    s_add_u32 s37, s36, 30720
    buffer_load_dwordx4 v17, s[12:15], s37 offen lds
    s_add_u32 m0, s31, 122880
    s_add_u32 s37, s36, 40960
    buffer_load_dwordx4 v16, s[12:15], s37 offen lds
    s_add_u32 m0, s31, 123904
    s_add_u32 s37, s36, 51200
    buffer_load_dwordx4 v17, s[12:15], s37 offen lds
    s_mul_i32 s36, s3, 2560
    s_add_u32 s36, s36, s28
    s_add_u32 m0, s28, 145408
    s_mov_b64 exec, s[34:35]
    buffer_load_dwordx4 v23, s[20:23], s36 offen lds
    s_mov_b64 exec, s[38:39]
    buffer_load_dwordx4 v23, s[20:23], s36 offen offset:1024 lds
    s_mov_b64 exec, -1
    s_waitcnt vmcnt(8)
    s_barrier
    s_add_u32 s3, s11, 5
    s_sub_u32 s36, s3, 10
    s_cmp_ge_u32 s3, 10
    s_cselect_b32 s3, s36, s3
    s_lshl_b32 s36, s3, 7
    s_add_u32 s36, s36, s26
    s_add_u32 m0, s31, 0
    s_add_u32 s37, s36, 0
    buffer_load_dwordx4 v16, s[12:15], s37 offen lds
    s_add_u32 m0, s31, 1024
    s_add_u32 s37, s36, 10240
    buffer_load_dwordx4 v17, s[12:15], s37 offen lds
    s_add_u32 m0, s31, 2048
    s_add_u32 s37, s36, 20480
    buffer_load_dwordx4 v16, s[12:15], s37 offen lds
    s_add_u32 m0, s31, 3072
    s_add_u32 s37, s36, 30720
    buffer_load_dwordx4 v17, s[12:15], s37 offen lds
    s_add_u32 m0, s31, 4096
    s_add_u32 s37, s36, 40960
    buffer_load_dwordx4 v16, s[12:15], s37 offen lds
    s_add_u32 m0, s31, 5120
    s_add_u32 s37, s36, 51200
    buffer_load_dwordx4 v17, s[12:15], s37 offen lds
    s_mul_i32 s36, s3, 2560
    s_add_u32 s36, s36, s28
    s_add_u32 m0, s28, 26624
    s_mov_b64 exec, s[34:35]
    buffer_load_dwordx4 v23, s[20:23], s36 offen lds
    s_mov_b64 exec, s[38:39]
    buffer_load_dwordx4 v23, s[20:23], s36 offen offset:1024 lds
    s_mov_b64 exec, -1
    s_waitcnt vmcnt(8)
    s_barrier
    s_add_u32 s3, s11, 6
    s_sub_u32 s36, s3, 10
    s_cmp_ge_u32 s3, 10
    s_cselect_b32 s3, s36, s3
    s_lshl_b32 s36, s3, 7
    s_add_u32 s36, s36, s26
    s_add_u32 m0, s31, 29696
    s_add_u32 s37, s36, 0
    buffer_load_dwordx4 v16, s[12:15], s37 offen lds
    s_add_u32 m0, s31, 30720
    s_add_u32 s37, s36, 10240
    buffer_load_dwordx4 v17, s[12:15], s37 offen lds
    s_add_u32 m0, s31, 31744
    s_add_u32 s37, s36, 20480
    buffer_load_dwordx4 v16, s[12:15], s37 offen lds
    s_add_u32 m0, s31, 32768
    s_add_u32 s37, s36, 30720
    buffer_load_dwordx4 v17, s[12:15], s37 offen lds
    s_add_u32 m0, s31, 33792
    s_add_u32 s37, s36, 40960
    buffer_load_dwordx4 v16, s[12:15], s37 offen lds
    s_add_u32 m0, s31, 34816
    s_add_u32 s37, s36, 51200
    buffer_load_dwordx4 v17, s[12:15], s37 offen lds
    s_mul_i32 s36, s3, 2560
    s_add_u32 s36, s36, s28
    s_add_u32 m0, s28, 56320
    s_mov_b64 exec, s[34:35]
    buffer_load_dwordx4 v23, s[20:23], s36 offen lds
    s_mov_b64 exec, s[38:39]
    buffer_load_dwordx4 v23, s[20:23], s36 offen offset:1024 lds
    s_mov_b64 exec, -1
    s_waitcnt vmcnt(8)
    s_barrier
    s_add_u32 s3, s11, 7
    s_sub_u32 s36, s3, 10
    s_cmp_ge_u32 s3, 10
    s_cselect_b32 s3, s36, s3
    s_lshl_b32 s36, s3, 7
    s_add_u32 s36, s36, s26
    s_add_u32 m0, s31, 59392
    s_add_u32 s37, s36, 0
    buffer_load_dwordx4 v16, s[12:15], s37 offen lds
    s_add_u32 m0, s31, 60416
    s_add_u32 s37, s36, 10240
    buffer_load_dwordx4 v17, s[12:15], s37 offen lds
    s_add_u32 m0, s31, 61440
    s_add_u32 s37, s36, 20480
    buffer_load_dwordx4 v16, s[12:15], s37 offen lds
    s_add_u32 m0, s31, 62464
    s_add_u32 s37, s36, 30720
    buffer_load_dwordx4 v17, s[12:15], s37 offen lds
    s_add_u32 m0, s31, 63488
    s_add_u32 s37, s36, 40960
    buffer_load_dwordx4 v16, s[12:15], s37 offen lds
    s_add_u32 m0, s31, 64512
    s_add_u32 s37, s36, 51200
    buffer_load_dwordx4 v17, s[12:15], s37 offen lds
    s_mul_i32 s36, s3, 2560
    s_add_u32 s36, s36, s28
    s_add_u32 m0, s28, 86016
    s_mov_b64 exec, s[34:35]
    buffer_load_dwordx4 v23, s[20:23], s36 offen lds
    s_mov_b64 exec, s[38:39]
    buffer_load_dwordx4 v23, s[20:23], s36 offen offset:1024 lds
    s_mov_b64 exec, -1
    s_waitcnt vmcnt(8)
    s_barrier
    s_add_u32 s3, s11, 8
    s_sub_u32 s36, s3, 10
    s_cmp_ge_u32 s3, 10
    s_cselect_b32 s3, s36, s3
    s_lshl_b32 s36, s3, 7
    s_add_u32 s36, s36, s26
    s_add_u32 m0, s31, 89088
    s_add_u32 s37, s36, 0
    buffer_load_dwordx4 v16, s[12:15], s37 offen lds
    s_add_u32 m0, s31, 90112
    s_add_u32 s37, s36, 10240
    buffer_load_dwordx4 v17, s[12:15], s37 offen lds
    s_add_u32 m0, s31, 91136
    s_add_u32 s37, s36, 20480
    buffer_load_dwordx4 v16, s[12:15], s37 offen lds
    s_add_u32 m0, s31, 92160
    s_add_u32 s37, s36, 30720
    buffer_load_dwordx4 v17, s[12:15], s37 offen lds
    s_add_u32 m0, s31, 93184
    s_add_u32 s37, s36, 40960
    buffer_load_dwordx4 v16, s[12:15], s37 offen lds
    s_add_u32 m0, s31, 94208
    s_add_u32 s37, s36, 51200
    buffer_load_dwordx4 v17, s[12:15], s37 offen lds
    s_mul_i32 s36, s3, 2560
    s_add_u32 s36, s36, s28
    s_add_u32 m0, s28, 115712
    s_mov_b64 exec, s[34:35]
    buffer_load_dwordx4 v23, s[20:23], s36 offen lds
    s_mov_b64 exec, s[38:39]
    buffer_load_dwordx4 v23, s[20:23], s36 offen offset:1024 lds
    s_mov_b64 exec, -1
    s_waitcnt vmcnt(8)
    s_barrier
    s_add_u32 s3, s11, 9
    s_sub_u32 s36, s3, 10
    s_cmp_ge_u32 s3, 10
    s_cselect_b32 s3, s36, s3
    s_lshl_b32 s36, s3, 7
    s_add_u32 s36, s36, s26
    s_add_u32 m0, s31, 118784
    s_add_u32 s37, s36, 0
    buffer_load_dwordx4 v16, s[12:15], s37 offen lds
    s_add_u32 m0, s31, 119808
    s_add_u32 s37, s36, 10240
    buffer_load_dwordx4 v17, s[12:15], s37 offen lds
    s_add_u32 m0, s31, 120832
    s_add_u32 s37, s36, 20480
    buffer_load_dwordx4 v16, s[12:15], s37 offen lds
    s_add_u32 m0, s31, 121856
    s_add_u32 s37, s36, 30720
    buffer_load_dwordx4 v17, s[12:15], s37 offen lds
    s_add_u32 m0, s31, 122880
    s_add_u32 s37, s36, 40960
    buffer_load_dwordx4 v16, s[12:15], s37 offen lds
    s_add_u32 m0, s31, 123904
    s_add_u32 s37, s36, 51200
    buffer_load_dwordx4 v17, s[12:15], s37 offen lds
    s_mul_i32 s36, s3, 2560
    s_add_u32 s36, s36, s28
    s_add_u32 m0, s28, 145408
    s_mov_b64 exec, s[34:35]
    buffer_load_dwordx4 v23, s[20:23], s36 offen lds
    s_mov_b64 exec, s[38:39]
    buffer_load_dwordx4 v23, s[20:23], s36 offen offset:1024 lds
    s_mov_b64 exec, -1
    s_waitcnt vmcnt(8)
    s_barrier
    s_add_u32 s3, s11, 1
    s_sub_u32 s36, s3, 10
    s_cmp_ge_u32 s3, 10
    s_cselect_b32 s3, s36, s3
    s_mul_i32 s36, s3, s29
    s_add_u32 s36, s36, s30
    s_add_u32 m0, s33, 0
    s_nop 0
    buffer_load_dwordx4 v24, s[48:51], s36 offen lds
    s_add_u32 m0, s33, 1024
    s_nop 0
    buffer_load_dwordx4 v25, s[48:51], s36 offen lds
    s_add_u32 m0, s33, 2048
    s_nop 0
    buffer_load_dwordx4 v26, s[48:51], s36 offen lds
    s_add_u32 m0, s33, 3072
    s_nop 0
    buffer_load_dwordx4 v27, s[48:51], s36 offen lds
    s_add_u32 m0, s33, 4096
    s_nop 0
    buffer_load_dwordx4 v28, s[48:51], s36 offen lds
    s_waitcnt vmcnt(5)
    s_barrier
    s_add_u32 s3, s11, 3
    s_sub_u32 s36, s3, 10
    s_cmp_ge_u32 s3, 10
    s_cselect_b32 s3, s36, s3
    s_mul_i32 s36, s3, s29
    s_add_u32 s36, s36, s30
    s_add_u32 m0, s33, 29696
    s_nop 0
    buffer_load_dwordx4 v24, s[48:51], s36 offen lds
    s_add_u32 m0, s33, 30720
    s_nop 0
    buffer_load_dwordx4 v25, s[48:51], s36 offen lds
    s_add_u32 m0, s33, 31744
    s_nop 0
    buffer_load_dwordx4 v26, s[48:51], s36 offen lds
    s_add_u32 m0, s33, 32768
    s_nop 0
    buffer_load_dwordx4 v27, s[48:51], s36 offen lds
    s_add_u32 m0, s33, 33792
    s_nop 0
    buffer_load_dwordx4 v28, s[48:51], s36 offen lds
    s_waitcnt vmcnt(5)
    s_barrier
    s_add_u32 s3, s11, 5
    s_sub_u32 s36, s3, 10
    s_cmp_ge_u32 s3, 10
    s_cselect_b32 s3, s36, s3
    s_mul_i32 s36, s3, s29
    s_add_u32 s36, s36, s30
    s_add_u32 m0, s33, 59392
    s_nop 0
    buffer_load_dwordx4 v24, s[48:51], s36 offen lds
    s_add_u32 m0, s33, 60416
    s_nop 0
    buffer_load_dwordx4 v25, s[48:51], s36 offen lds
    s_add_u32 m0, s33, 61440
    s_nop 0
    buffer_load_dwordx4 v26, s[48:51], s36 offen lds
    s_add_u32 m0, s33, 62464
    s_nop 0
    buffer_load_dwordx4 v27, s[48:51], s36 offen lds
    s_add_u32 m0, s33, 63488
    s_nop 0
    buffer_load_dwordx4 v28, s[48:51], s36 offen lds
    s_waitcnt vmcnt(5)
    s_barrier
    s_add_u32 s3, s11, 7
    s_sub_u32 s36, s3, 10
    s_cmp_ge_u32 s3, 10
    s_cselect_b32 s3, s36, s3
    s_mul_i32 s36, s3, s29
    s_add_u32 s36, s36, s30
    s_add_u32 m0, s33, 89088
    s_nop 0
    buffer_load_dwordx4 v24, s[48:51], s36 offen lds
    s_add_u32 m0, s33, 90112
    s_nop 0
    buffer_load_dwordx4 v25, s[48:51], s36 offen lds
    s_add_u32 m0, s33, 91136
    s_nop 0
    buffer_load_dwordx4 v26, s[48:51], s36 offen lds
    s_add_u32 m0, s33, 92160
    s_nop 0
    buffer_load_dwordx4 v27, s[48:51], s36 offen lds
    s_add_u32 m0, s33, 93184
    s_nop 0
    buffer_load_dwordx4 v28, s[48:51], s36 offen lds
    s_waitcnt vmcnt(5)
    s_barrier
    s_add_u32 s3, s11, 9
    s_sub_u32 s36, s3, 10
    s_cmp_ge_u32 s3, 10
    s_cselect_b32 s3, s36, s3
    s_mul_i32 s36, s3, s29
    s_add_u32 s36, s36, s30
    s_add_u32 m0, s33, 118784
    s_nop 0
    buffer_load_dwordx4 v24, s[48:51], s36 offen lds
    s_add_u32 m0, s33, 119808
    s_nop 0
    buffer_load_dwordx4 v25, s[48:51], s36 offen lds
    s_add_u32 m0, s33, 120832
    s_nop 0
    buffer_load_dwordx4 v26, s[48:51], s36 offen lds
    s_add_u32 m0, s33, 121856
    s_nop 0
    buffer_load_dwordx4 v27, s[48:51], s36 offen lds
    s_add_u32 m0, s33, 122880
    s_nop 0
    buffer_load_dwordx4 v28, s[48:51], s36 offen lds
    s_waitcnt vmcnt(5)
    s_barrier
    s_waitcnt vmcnt(0)
    s_barrier
    s_cmp_lg_u32 s53, 7
    s_cbranch_scc1 L_mk_g5
    v_lshrrev_b32 v5, 3, v4
    v_mul_u32_u24 v6, 1280, v5
    v_and_b32 v7, 7, v4
    v_lshlrev_b32 v7, 4, v7
    v_add_u32 v6, v6, v7
    s_lshl_b32 s36, s9, 4
    s_add_u32 s36, s36, s10
    s_mul_i32 s37, s36, 10240
    s_mov_b32 s20, s40
    s_mov_b32 s21, s41
    s_mov_b32 s22, 1280
    buffer_load_dwordx4 v[64:67], v6, s[12:15], s37 offen offset:0
    buffer_load_dwordx4 v[104:107], v7, s[20:23], 0 offen offset:0
    buffer_load_dwordx4 v[68:71], v6, s[12:15], s37 offen offset:128
    buffer_load_dwordx4 v[108:111], v7, s[20:23], 0 offen offset:128
    buffer_load_dwordx4 v[72:75], v6, s[12:15], s37 offen offset:256
    buffer_load_dwordx4 v[112:115], v7, s[20:23], 0 offen offset:256
    buffer_load_dwordx4 v[76:79], v6, s[12:15], s37 offen offset:384
    buffer_load_dwordx4 v[116:119], v7, s[20:23], 0 offen offset:384
    buffer_load_dwordx4 v[80:83], v6, s[12:15], s37 offen offset:512
    buffer_load_dwordx4 v[120:123], v7, s[20:23], 0 offen offset:512
    buffer_load_dwordx4 v[84:87], v6, s[12:15], s37 offen offset:640
    buffer_load_dwordx4 v[124:127], v7, s[20:23], 0 offen offset:640
    buffer_load_dwordx4 v[88:91], v6, s[12:15], s37 offen offset:768
    buffer_load_dwordx4 v[128:131], v7, s[20:23], 0 offen offset:768
    buffer_load_dwordx4 v[92:95], v6, s[12:15], s37 offen offset:896
    buffer_load_dwordx4 v[132:135], v7, s[20:23], 0 offen offset:896
    buffer_load_dwordx4 v[96:99], v6, s[12:15], s37 offen offset:1024
    buffer_load_dwordx4 v[136:139], v7, s[20:23], 0 offen offset:1024
    buffer_load_dwordx4 v[100:103], v6, s[12:15], s37 offen offset:1152
    buffer_load_dwordx4 v[140:143], v7, s[20:23], 0 offen offset:1152
    v_mov_b32 v38, 0
    s_waitcnt vmcnt(0)
    v_dot2_f32_bf16 v38, v64, v104, v38
    v_dot2_f32_bf16 v38, v65, v105, v38
    v_dot2_f32_bf16 v38, v66, v106, v38
    v_dot2_f32_bf16 v38, v67, v107, v38
    v_dot2_f32_bf16 v38, v68, v108, v38
    v_dot2_f32_bf16 v38, v69, v109, v38
    v_dot2_f32_bf16 v38, v70, v110, v38
    v_dot2_f32_bf16 v38, v71, v111, v38
    v_dot2_f32_bf16 v38, v72, v112, v38
    v_dot2_f32_bf16 v38, v73, v113, v38
    v_dot2_f32_bf16 v38, v74, v114, v38
    v_dot2_f32_bf16 v38, v75, v115, v38
    v_dot2_f32_bf16 v38, v76, v116, v38
    v_dot2_f32_bf16 v38, v77, v117, v38
    v_dot2_f32_bf16 v38, v78, v118, v38
    v_dot2_f32_bf16 v38, v79, v119, v38
    v_dot2_f32_bf16 v38, v80, v120, v38
    v_dot2_f32_bf16 v38, v81, v121, v38
    v_dot2_f32_bf16 v38, v82, v122, v38
    v_dot2_f32_bf16 v38, v83, v123, v38
    v_dot2_f32_bf16 v38, v84, v124, v38
    v_dot2_f32_bf16 v38, v85, v125, v38
    v_dot2_f32_bf16 v38, v86, v126, v38
    v_dot2_f32_bf16 v38, v87, v127, v38
    v_dot2_f32_bf16 v38, v88, v128, v38
    v_dot2_f32_bf16 v38, v89, v129, v38
    v_dot2_f32_bf16 v38, v90, v130, v38
    v_dot2_f32_bf16 v38, v91, v131, v38
    v_dot2_f32_bf16 v38, v92, v132, v38
    v_dot2_f32_bf16 v38, v93, v133, v38
    v_dot2_f32_bf16 v38, v94, v134, v38
    v_dot2_f32_bf16 v38, v95, v135, v38
    v_dot2_f32_bf16 v38, v96, v136, v38
    v_dot2_f32_bf16 v38, v97, v137, v38
    v_dot2_f32_bf16 v38, v98, v138, v38
    v_dot2_f32_bf16 v38, v99, v139, v38
    v_dot2_f32_bf16 v38, v100, v140, v38
    v_dot2_f32_bf16 v38, v101, v141, v38
    v_dot2_f32_bf16 v38, v102, v142, v38
    v_dot2_f32_bf16 v38, v103, v143, v38
    s_nop 2
    v_add_f32_dpp v38, v38, v38 quad_perm:[1,0,3,2] row_mask:0xf bank_mask:0xf
    s_nop 1
    v_add_f32_dpp v38, v38, v38 quad_perm:[2,3,0,1] row_mask:0xf bank_mask:0xf
    s_nop 1
    v_add_f32_dpp v38, v38, v38 row_half_mirror row_mask:0xf bank_mask:0xf
    s_nop 1
    v_cvt_pk_bf16_f32 v38, v38, v38
    v_and_b32 v38, 0xffff0000, v38
    v_mul_f32 v38, 0xbfb8aa3b, v38
    v_exp_f32 v38, v38
    s_nop 0
    v_add_f32 v38, 1.0, v38
    v_rcp_f32 v38, v38
    s_nop 0
    v_cvt_pk_bf16_f32 v38, v38, v38
    v_and_b32 v38, 0xffff0000, v38
    v_sub_f32 v39, 1.0, v38
    v_cvt_pk_bf16_f32 v39, v39, v39
    v_and_b32 v39, 0xffff0000, v39
    v_lshlrev_b32 v5, 3, v5
    s_lshl_b32 s36, s36, 6
    s_add_u32 s36, s36, 10682368
    s_mov_b32 s38, 0x01010101
    s_mov_b32 s39, 0x01010101
    s_mov_b64 exec, s[38:39]
    buffer_store_dwordx2 v[38:39], v5, s[4:7], s36 offen sc1
    s_mov_b64 exec, -1
L_mk_g5:
    s_branch L_mk_ld1t
L_mk_ld1b:
    s_add_u32 s3, s11, 0
    s_sub_u32 s36, s3, 10
    s_cmp_ge_u32 s3, 10
    s_cselect_b32 s3, s36, s3
    s_lshl_b32 s36, s3, 7
    s_add_u32 s36, s36, s26
    s_add_u32 m0, s31, 0
    s_add_u32 s37, s36, 0
    buffer_load_dwordx4 v16, s[12:15], s37 offen lds
    s_add_u32 m0, s31, 1024
    s_add_u32 s37, s36, 10240
    buffer_load_dwordx4 v17, s[12:15], s37 offen lds
    s_add_u32 m0, s31, 2048
    s_add_u32 s37, s36, 20480
    buffer_load_dwordx4 v16, s[12:15], s37 offen lds
    s_add_u32 m0, s31, 3072
    s_add_u32 s37, s36, 30720
    buffer_load_dwordx4 v17, s[12:15], s37 offen lds
    s_add_u32 m0, s31, 4096
    s_add_u32 s37, s36, 40960
    buffer_load_dwordx4 v16, s[12:15], s37 offen lds
    s_add_u32 m0, s31, 5120
    s_add_u32 s37, s36, 51200
    buffer_load_dwordx4 v17, s[12:15], s37 offen lds
    s_mov_b32 s4, s62
    s_and_b32 s5, s63, 0xffff
    s_mov_b32 s6, 268435456
    s_mov_b32 s7, 0x20000
    s_and_b32 s61, s61, 0xffff
    s_mov_b32 s62, 256
    s_mov_b32 s63, 0x20000
    s_and_b32 s17, s17, 0xffff
    s_cmp_lt_u32 s10, 8
    s_cselect_b32 s48, s48, s16
    s_cselect_b32 s49, s49, s17
    s_cselect_b32 s24, s24, 3840
    s_cselect_b32 s20, s20, s22
    s_cselect_b32 s21, s21, s23
    s_and_b32 s41, s41, 0xffff
    s_and_b32 s49, s49, 0xffff
    s_mul_i32 s50, s24, 640
    s_mov_b32 s51, 0x20000
    s_and_b32 s21, s21, 0xffff
    s_mov_b32 s22, 25600
    s_mov_b32 s23, 0x20000
    s_mov_b32 s18, 2457600
    s_mov_b32 s19, 0x20000
    s_and_b32 s36, s8, 1
    s_mul_i32 s44, s36, 320
    s_mul_i32 s32, s36, 5120
    s_mov_b32 s43, 3840
    v_lshlrev_b32 v23, 4, v4
    s_mul_i32 s28, s36, 1280
    s_add_u32 s3, s11, 1
    s_sub_u32 s36, s3, 10
    s_cmp_ge_u32 s3, 10
    s_cselect_b32 s3, s36, s3
    s_lshl_b32 s36, s3, 7
    s_add_u32 s36, s36, s26
    s_add_u32 m0, s31, 29696
    s_add_u32 s37, s36, 0
    buffer_load_dwordx4 v16, s[12:15], s37 offen lds
    s_add_u32 m0, s31, 30720
    s_add_u32 s37, s36, 10240
    buffer_load_dwordx4 v17, s[12:15], s37 offen lds
    s_add_u32 m0, s31, 31744
    s_add_u32 s37, s36, 20480
    buffer_load_dwordx4 v16, s[12:15], s37 offen lds
    s_add_u32 m0, s31, 32768
    s_add_u32 s37, s36, 30720
    buffer_load_dwordx4 v17, s[12:15], s37 offen lds
    s_add_u32 m0, s31, 33792
    s_add_u32 s37, s36, 40960
    buffer_load_dwordx4 v16, s[12:15], s37 offen lds
    s_add_u32 m0, s31, 34816
    s_add_u32 s37, s36, 51200
    buffer_load_dwordx4 v17, s[12:15], s37 offen lds
    v_add_u32 v5, s44, v4
    v_mul_u32_u24 v6, 6554, v5
    v_lshrrev_b32 v6, 16, v6
    v_mul_u32_u24 v7, 10, v6
    v_sub_u32 v5, v5, v7
    v_mul_lo_u32 v24, v6, s24
    v_lshl_add_u32 v24, v5, 4, v24
    v_add_u32 v5, s44, v4
    v_add_u32 v5, 64, v5
    v_mul_u32_u24 v6, 6554, v5
    v_lshrrev_b32 v6, 16, v6
    v_mul_u32_u24 v7, 10, v6
    v_sub_u32 v5, v5, v7
    v_mul_lo_u32 v25, v6, s24
    v_lshl_add_u32 v25, v5, 4, v25
    v_add_u32 v5, s44, v4
    v_add_u32 v5, 128, v5
    v_mul_u32_u24 v6, 6554, v5
    v_lshrrev_b32 v6, 16, v6
    v_mul_u32_u24 v7, 10, v6
    v_sub_u32 v5, v5, v7
    v_mul_lo_u32 v26, v6, s24
    v_lshl_add_u32 v26, v5, 4, v26
    v_add_u32 v5, s44, v4
    v_add_u32 v5, 192, v5
    v_mul_u32_u24 v6, 6554, v5
    v_lshrrev_b32 v6, 16, v6
    v_mul_u32_u24 v7, 10, v6
    v_sub_u32 v5, v5, v7
    v_mul_lo_u32 v27, v6, s24
    v_lshl_add_u32 v27, v5, 4, v27
    v_add_u32 v5, s44, v4
    v_add_u32 v5, 256, v5
    v_mul_u32_u24 v6, 6554, v5
    v_lshrrev_b32 v6, 16, v6
    v_mul_u32_u24 v7, 10, v6
    v_sub_u32 v5, v5, v7
    v_mul_lo_u32 v28, v6, s24
    v_lshl_add_u32 v28, v5, 4, v28
    s_lshl_b32 s29, s24, 6
    s_mul_i32 s33, s8, 5120
    s_waitcnt vmcnt(6)
    s_barrier
    s_add_u32 s3, s11, 2
    s_sub_u32 s36, s3, 10
    s_cmp_ge_u32 s3, 10
    s_cselect_b32 s3, s36, s3
    s_lshl_b32 s36, s3, 7
    s_add_u32 s36, s36, s26
    s_add_u32 m0, s31, 59392
    s_add_u32 s37, s36, 0
    buffer_load_dwordx4 v16, s[12:15], s37 offen lds
    s_add_u32 m0, s31, 60416
    s_add_u32 s37, s36, 10240
    buffer_load_dwordx4 v17, s[12:15], s37 offen lds
    s_add_u32 m0, s31, 61440
    s_add_u32 s37, s36, 20480
    buffer_load_dwordx4 v16, s[12:15], s37 offen lds
    s_add_u32 m0, s31, 62464
    s_add_u32 s37, s36, 30720
    buffer_load_dwordx4 v17, s[12:15], s37 offen lds
    s_add_u32 m0, s31, 63488
    s_add_u32 s37, s36, 40960
    buffer_load_dwordx4 v16, s[12:15], s37 offen lds
    s_add_u32 m0, s31, 64512
    s_add_u32 s37, s36, 51200
    buffer_load_dwordx4 v17, s[12:15], s37 offen lds
    s_waitcnt vmcnt(6)
    s_barrier
    s_add_u32 s3, s11, 3
    s_sub_u32 s36, s3, 10
    s_cmp_ge_u32 s3, 10
    s_cselect_b32 s3, s36, s3
    s_lshl_b32 s36, s3, 7
    s_add_u32 s36, s36, s26
    s_add_u32 m0, s31, 89088
    s_add_u32 s37, s36, 0
    buffer_load_dwordx4 v16, s[12:15], s37 offen lds
    s_add_u32 m0, s31, 90112
    s_add_u32 s37, s36, 10240
    buffer_load_dwordx4 v17, s[12:15], s37 offen lds
    s_add_u32 m0, s31, 91136
    s_add_u32 s37, s36, 20480
    buffer_load_dwordx4 v16, s[12:15], s37 offen lds
    s_add_u32 m0, s31, 92160
    s_add_u32 s37, s36, 30720
    buffer_load_dwordx4 v17, s[12:15], s37 offen lds
    s_add_u32 m0, s31, 93184
    s_add_u32 s37, s36, 40960
    buffer_load_dwordx4 v16, s[12:15], s37 offen lds
    s_add_u32 m0, s31, 94208
    s_add_u32 s37, s36, 51200
    buffer_load_dwordx4 v17, s[12:15], s37 offen lds
    s_waitcnt vmcnt(6)
    s_barrier
    s_add_u32 s3, s11, 4
    s_sub_u32 s36, s3, 10
    s_cmp_ge_u32 s3, 10
    s_cselect_b32 s3, s36, s3
    s_lshl_b32 s36, s3, 7
    s_add_u32 s36, s36, s26
    s_add_u32 m0, s31, 118784
    s_add_u32 s37, s36, 0
    buffer_load_dwordx4 v16, s[12:15], s37 offen lds
    s_add_u32 m0, s31, 119808
    s_add_u32 s37, s36, 10240
    buffer_load_dwordx4 v17, s[12:15], s37 offen lds
    s_add_u32 m0, s31, 120832
    s_add_u32 s37, s36, 20480
    buffer_load_dwordx4 v16, s[12:15], s37 offen lds
    s_add_u32 m0, s31, 121856
    s_add_u32 s37, s36, 30720
    buffer_load_dwordx4 v17, s[12:15], s37 offen lds
    s_add_u32 m0, s31, 122880
    s_add_u32 s37, s36, 40960
    buffer_load_dwordx4 v16, s[12:15], s37 offen lds
    s_add_u32 m0, s31, 123904
    s_add_u32 s37, s36, 51200
    buffer_load_dwordx4 v17, s[12:15], s37 offen lds
    s_waitcnt vmcnt(6)
    s_barrier
    s_add_u32 s3, s11, 5
    s_sub_u32 s36, s3, 10
    s_cmp_ge_u32 s3, 10
    s_cselect_b32 s3, s36, s3
    s_lshl_b32 s36, s3, 7
    s_add_u32 s36, s36, s26
    s_add_u32 m0, s31, 0
    s_add_u32 s37, s36, 0
    buffer_load_dwordx4 v16, s[12:15], s37 offen lds
    s_add_u32 m0, s31, 1024
    s_add_u32 s37, s36, 10240
    buffer_load_dwordx4 v17, s[12:15], s37 offen lds
    s_add_u32 m0, s31, 2048
    s_add_u32 s37, s36, 20480
    buffer_load_dwordx4 v16, s[12:15], s37 offen lds
    s_add_u32 m0, s31, 3072
    s_add_u32 s37, s36, 30720
    buffer_load_dwordx4 v17, s[12:15], s37 offen lds
    s_add_u32 m0, s31, 4096
    s_add_u32 s37, s36, 40960
    buffer_load_dwordx4 v16, s[12:15], s37 offen lds
    s_add_u32 m0, s31, 5120
    s_add_u32 s37, s36, 51200
    buffer_load_dwordx4 v17, s[12:15], s37 offen lds
    s_waitcnt vmcnt(6)
    s_barrier
    s_add_u32 s3, s11, 6
    s_sub_u32 s36, s3, 10
    s_cmp_ge_u32 s3, 10
    s_cselect_b32 s3, s36, s3
    s_lshl_b32 s36, s3, 7
    s_add_u32 s36, s36, s26
    s_add_u32 m0, s31, 29696
    s_add_u32 s37, s36, 0
    buffer_load_dwordx4 v16, s[12:15], s37 offen lds
    s_add_u32 m0, s31, 30720
    s_add_u32 s37, s36, 10240
    buffer_load_dwordx4 v17, s[12:15], s37 offen lds
    s_add_u32 m0, s31, 31744
    s_add_u32 s37, s36, 20480
    buffer_load_dwordx4 v16, s[12:15], s37 offen lds
    s_add_u32 m0, s31, 32768
    s_add_u32 s37, s36, 30720
    buffer_load_dwordx4 v17, s[12:15], s37 offen lds
    s_add_u32 m0, s31, 33792
    s_add_u32 s37, s36, 40960
    buffer_load_dwordx4 v16, s[12:15], s37 offen lds
    s_add_u32 m0, s31, 34816
    s_add_u32 s37, s36, 51200
    buffer_load_dwordx4 v17, s[12:15], s37 offen lds
    s_waitcnt vmcnt(6)
    s_barrier
    s_add_u32 s3, s11, 7
    s_sub_u32 s36, s3, 10
    s_cmp_ge_u32 s3, 10
    s_cselect_b32 s3, s36, s3
    s_lshl_b32 s36, s3, 7
    s_add_u32 s36, s36, s26
    s_add_u32 m0, s31, 59392
    s_add_u32 s37, s36, 0
    buffer_load_dwordx4 v16, s[12:15], s37 offen lds
    s_add_u32 m0, s31, 60416
    s_add_u32 s37, s36, 10240
    buffer_load_dwordx4 v17, s[12:15], s37 offen lds
    s_add_u32 m0, s31, 61440
    s_add_u32 s37, s36, 20480
    buffer_load_dwordx4 v16, s[12:15], s37 offen lds
    s_add_u32 m0, s31, 62464
    s_add_u32 s37, s36, 30720
    buffer_load_dwordx4 v17, s[12:15], s37 offen lds
    s_add_u32 m0, s31, 63488
    s_add_u32 s37, s36, 40960
    buffer_load_dwordx4 v16, s[12:15], s37 offen lds
    s_add_u32 m0, s31, 64512
    s_add_u32 s37, s36, 51200
    buffer_load_dwordx4 v17, s[12:15], s37 offen lds
    s_waitcnt vmcnt(6)
    s_barrier
    s_add_u32 s3, s11, 8
    s_sub_u32 s36, s3, 10
    s_cmp_ge_u32 s3, 10
    s_cselect_b32 s3, s36, s3
    s_lshl_b32 s36, s3, 7
    s_add_u32 s36, s36, s26
    s_add_u32 m0, s31, 89088
    s_add_u32 s37, s36, 0
    buffer_load_dwordx4 v16, s[12:15], s37 offen lds
    s_add_u32 m0, s31, 90112
    s_add_u32 s37, s36, 10240
    buffer_load_dwordx4 v17, s[12:15], s37 offen lds
    s_add_u32 m0, s31, 91136
    s_add_u32 s37, s36, 20480
    buffer_load_dwordx4 v16, s[12:15], s37 offen lds
    s_add_u32 m0, s31, 92160
    s_add_u32 s37, s36, 30720
    buffer_load_dwordx4 v17, s[12:15], s37 offen lds
    s_add_u32 m0, s31, 93184
    s_add_u32 s37, s36, 40960
    buffer_load_dwordx4 v16, s[12:15], s37 offen lds
    s_add_u32 m0, s31, 94208
    s_add_u32 s37, s36, 51200
    buffer_load_dwordx4 v17, s[12:15], s37 offen lds
    s_waitcnt vmcnt(6)
    s_barrier
    s_add_u32 s3, s11, 9
    s_sub_u32 s36, s3, 10
    s_cmp_ge_u32 s3, 10
    s_cselect_b32 s3, s36, s3
    s_lshl_b32 s36, s3, 7
    s_add_u32 s36, s36, s26
    s_add_u32 m0, s31, 118784
    s_add_u32 s37, s36, 0
    buffer_load_dwordx4 v16, s[12:15], s37 offen lds
    s_add_u32 m0, s31, 119808
    s_add_u32 s37, s36, 10240
    buffer_load_dwordx4 v17, s[12:15], s37 offen lds
    s_add_u32 m0, s31, 120832
    s_add_u32 s37, s36, 20480
    buffer_load_dwordx4 v16, s[12:15], s37 offen lds
    s_add_u32 m0, s31, 121856
    s_add_u32 s37, s36, 30720
    buffer_load_dwordx4 v17, s[12:15], s37 offen lds
    s_add_u32 m0, s31, 122880
    s_add_u32 s37, s36, 40960
    buffer_load_dwordx4 v16, s[12:15], s37 offen lds
    s_add_u32 m0, s31, 123904
    s_add_u32 s37, s36, 51200
    buffer_load_dwordx4 v17, s[12:15], s37 offen lds
    s_waitcnt vmcnt(6)
    s_barrier
    s_add_u32 s3, s11, 1
    s_sub_u32 s36, s3, 10
    s_cmp_ge_u32 s3, 10
    s_cselect_b32 s3, s36, s3
    s_mul_i32 s36, s3, s29
    s_add_u32 s36, s36, s30
    s_add_u32 m0, s33, 0
    s_nop 0
    buffer_load_dwordx4 v24, s[48:51], s36 offen lds
    s_add_u32 m0, s33, 1024
    s_nop 0
    buffer_load_dwordx4 v25, s[48:51], s36 offen lds
    s_add_u32 m0, s33, 2048
    s_nop 0
    buffer_load_dwordx4 v26, s[48:51], s36 offen lds
    s_add_u32 m0, s33, 3072
    s_nop 0
    buffer_load_dwordx4 v27, s[48:51], s36 offen lds
    s_add_u32 m0, s33, 4096
    s_nop 0
    buffer_load_dwordx4 v28, s[48:51], s36 offen lds
    s_waitcnt vmcnt(5)
    s_barrier
    s_add_u32 s3, s11, 3
    s_sub_u32 s36, s3, 10
    s_cmp_ge_u32 s3, 10
    s_cselect_b32 s3, s36, s3
    s_mul_i32 s36, s3, s29
    s_add_u32 s36, s36, s30
    s_add_u32 m0, s33, 29696
    s_nop 0
    buffer_load_dwordx4 v24, s[48:51], s36 offen lds
    s_add_u32 m0, s33, 30720
    s_nop 0
    buffer_load_dwordx4 v25, s[48:51], s36 offen lds
    s_add_u32 m0, s33, 31744
    s_nop 0
    buffer_load_dwordx4 v26, s[48:51], s36 offen lds
    s_add_u32 m0, s33, 32768
    s_nop 0
    buffer_load_dwordx4 v27, s[48:51], s36 offen lds
    s_add_u32 m0, s33, 33792
    s_nop 0
    buffer_load_dwordx4 v28, s[48:51], s36 offen lds
    s_waitcnt vmcnt(5)
    s_barrier
    s_add_u32 s3, s11, 5
    s_sub_u32 s36, s3, 10
    s_cmp_ge_u32 s3, 10
    s_cselect_b32 s3, s36, s3
    s_mul_i32 s36, s3, s29
    s_add_u32 s36, s36, s30
    s_add_u32 m0, s33, 59392
    s_nop 0
    buffer_load_dwordx4 v24, s[48:51], s36 offen lds
    s_add_u32 m0, s33, 60416
    s_nop 0
    buffer_load_dwordx4 v25, s[48:51], s36 offen lds
    s_add_u32 m0, s33, 61440
    s_nop 0
    buffer_load_dwordx4 v26, s[48:51], s36 offen lds
    s_add_u32 m0, s33, 62464
    s_nop 0
    buffer_load_dwordx4 v27, s[48:51], s36 offen lds
    s_add_u32 m0, s33, 63488
    s_nop 0
    buffer_load_dwordx4 v28, s[48:51], s36 offen lds
    s_waitcnt vmcnt(5)
    s_barrier
    s_add_u32 s3, s11, 7
    s_sub_u32 s36, s3, 10
    s_cmp_ge_u32 s3, 10
    s_cselect_b32 s3, s36, s3
    s_mul_i32 s36, s3, s29
    s_add_u32 s36, s36, s30
    s_add_u32 m0, s33, 89088
    s_nop 0
    buffer_load_dwordx4 v24, s[48:51], s36 offen lds
    s_add_u32 m0, s33, 90112
    s_nop 0
    buffer_load_dwordx4 v25, s[48:51], s36 offen lds
    s_add_u32 m0, s33, 91136
    s_nop 0
    buffer_load_dwordx4 v26, s[48:51], s36 offen lds
    s_add_u32 m0, s33, 92160
    s_nop 0
    buffer_load_dwordx4 v27, s[48:51], s36 offen lds
    s_add_u32 m0, s33, 93184
    s_nop 0
    buffer_load_dwordx4 v28, s[48:51], s36 offen lds
    s_waitcnt vmcnt(5)
    s_barrier
    s_add_u32 s3, s11, 9
    s_sub_u32 s36, s3, 10
    s_cmp_ge_u32 s3, 10
    s_cselect_b32 s3, s36, s3
    s_mul_i32 s36, s3, s29
    s_add_u32 s36, s36, s30
    s_add_u32 m0, s33, 118784
    s_nop 0
    buffer_load_dwordx4 v24, s[48:51], s36 offen lds
    s_add_u32 m0, s33, 119808
    s_nop 0
    buffer_load_dwordx4 v25, s[48:51], s36 offen lds
    s_add_u32 m0, s33, 120832
    s_nop 0
    buffer_load_dwordx4 v26, s[48:51], s36 offen lds
    s_add_u32 m0, s33, 121856
    s_nop 0
    buffer_load_dwordx4 v27, s[48:51], s36 offen lds
    s_add_u32 m0, s33, 122880
    s_nop 0
    buffer_load_dwordx4 v28, s[48:51], s36 offen lds
    s_waitcnt vmcnt(5)
    s_barrier
    s_waitcnt vmcnt(0)
    s_barrier
    s_cmp_lg_u32 s53, 7
    s_cbranch_scc1 L_mk_g6
    v_lshrrev_b32 v5, 3, v4
    v_mul_u32_u24 v6, 1280, v5
    v_and_b32 v7, 7, v4
    v_lshlrev_b32 v7, 4, v7
    v_add_u32 v6, v6, v7
    s_lshl_b32 s36, s9, 4
    s_add_u32 s36, s36, s10
    s_mul_i32 s37, s36, 10240
    s_mov_b32 s20, s40
    s_mov_b32 s21, s41
    s_mov_b32 s22, 1280
    buffer_load_dwordx4 v[64:67], v6, s[12:15], s37 offen offset:0
    buffer_load_dwordx4 v[104:107], v7, s[20:23], 0 offen offset:0
    buffer_load_dwordx4 v[68:71], v6, s[12:15], s37 offen offset:128
    buffer_load_dwordx4 v[108:111], v7, s[20:23], 0 offen offset:128
    buffer_load_dwordx4 v[72:75], v6, s[12:15], s37 offen offset:256
    buffer_load_dwordx4 v[112:115], v7, s[20:23], 0 offen offset:256
    buffer_load_dwordx4 v[76:79], v6, s[12:15], s37 offen offset:384
    buffer_load_dwordx4 v[116:119], v7, s[20:23], 0 offen offset:384
    buffer_load_dwordx4 v[80:83], v6, s[12:15], s37 offen offset:512
    buffer_load_dwordx4 v[120:123], v7, s[20:23], 0 offen offset:512
    buffer_load_dwordx4 v[84:87], v6, s[12:15], s37 offen offset:640
    buffer_load_dwordx4 v[124:127], v7, s[20:23], 0 offen offset:640
    buffer_load_dwordx4 v[88:91], v6, s[12:15], s37 offen offset:768
    buffer_load_dwordx4 v[128:131], v7, s[20:23], 0 offen offset:768
    buffer_load_dwordx4 v[92:95], v6, s[12:15], s37 offen offset:896
    buffer_load_dwordx4 v[132:135], v7, s[20:23], 0 offen offset:896
    buffer_load_dwordx4 v[96:99], v6, s[12:15], s37 offen offset:1024
    buffer_load_dwordx4 v[136:139], v7, s[20:23], 0 offen offset:1024
    buffer_load_dwordx4 v[100:103], v6, s[12:15], s37 offen offset:1152
    buffer_load_dwordx4 v[140:143], v7, s[20:23], 0 offen offset:1152
    v_mov_b32 v38, 0
    s_waitcnt vmcnt(0)
    v_dot2_f32_bf16 v38, v64, v104, v38
    v_dot2_f32_bf16 v38, v65, v105, v38
    v_dot2_f32_bf16 v38, v66, v106, v38
    v_dot2_f32_bf16 v38, v67, v107, v38
    v_dot2_f32_bf16 v38, v68, v108, v38
    v_dot2_f32_bf16 v38, v69, v109, v38
    v_dot2_f32_bf16 v38, v70, v110, v38
    v_dot2_f32_bf16 v38, v71, v111, v38
    v_dot2_f32_bf16 v38, v72, v112, v38
    v_dot2_f32_bf16 v38, v73, v113, v38
    v_dot2_f32_bf16 v38, v74, v114, v38
    v_dot2_f32_bf16 v38, v75, v115, v38
    v_dot2_f32_bf16 v38, v76, v116, v38
    v_dot2_f32_bf16 v38, v77, v117, v38
    v_dot2_f32_bf16 v38, v78, v118, v38
    v_dot2_f32_bf16 v38, v79, v119, v38
    v_dot2_f32_bf16 v38, v80, v120, v38
    v_dot2_f32_bf16 v38, v81, v121, v38
    v_dot2_f32_bf16 v38, v82, v122, v38
    v_dot2_f32_bf16 v38, v83, v123, v38
    v_dot2_f32_bf16 v38, v84, v124, v38
    v_dot2_f32_bf16 v38, v85, v125, v38
    v_dot2_f32_bf16 v38, v86, v126, v38
    v_dot2_f32_bf16 v38, v87, v127, v38
    v_dot2_f32_bf16 v38, v88, v128, v38
    v_dot2_f32_bf16 v38, v89, v129, v38
    v_dot2_f32_bf16 v38, v90, v130, v38
    v_dot2_f32_bf16 v38, v91, v131, v38
    v_dot2_f32_bf16 v38, v92, v132, v38
    v_dot2_f32_bf16 v38, v93, v133, v38
    v_dot2_f32_bf16 v38, v94, v134, v38
    v_dot2_f32_bf16 v38, v95, v135, v38
    v_dot2_f32_bf16 v38, v96, v136, v38
    v_dot2_f32_bf16 v38, v97, v137, v38
    v_dot2_f32_bf16 v38, v98, v138, v38
    v_dot2_f32_bf16 v38, v99, v139, v38
    v_dot2_f32_bf16 v38, v100, v140, v38
    v_dot2_f32_bf16 v38, v101, v141, v38
    v_dot2_f32_bf16 v38, v102, v142, v38
    v_dot2_f32_bf16 v38, v103, v143, v38
    s_nop 2
    v_add_f32_dpp v38, v38, v38 quad_perm:[1,0,3,2] row_mask:0xf bank_mask:0xf
    s_nop 1
    v_add_f32_dpp v38, v38, v38 quad_perm:[2,3,0,1] row_mask:0xf bank_mask:0xf
    s_nop 1
    v_add_f32_dpp v38, v38, v38 row_half_mirror row_mask:0xf bank_mask:0xf
    s_nop 1
    v_cvt_pk_bf16_f32 v38, v38, v38
    v_and_b32 v38, 0xffff0000, v38
    v_mul_f32 v38, 0xbfb8aa3b, v38
    v_exp_f32 v38, v38
    s_nop 0
    v_add_f32 v38, 1.0, v38
    v_rcp_f32 v38, v38
    s_nop 0
    v_cvt_pk_bf16_f32 v38, v38, v38
    v_and_b32 v38, 0xffff0000, v38
    v_sub_f32 v39, 1.0, v38
    v_cvt_pk_bf16_f32 v39, v39, v39
    v_and_b32 v39, 0xffff0000, v39
    v_lshlrev_b32 v5, 3, v5
    s_lshl_b32 s36, s36, 6
    s_add_u32 s36, s36, 10682368
    s_mov_b32 s38, 0x01010101
    s_mov_b32 s39, 0x01010101
    s_mov_b64 exec, s[38:39]
    buffer_store_dwordx2 v[38:39], v5, s[4:7], s36 offen sc1
    s_mov_b64 exec, -1
L_mk_g6:
L_mk_ld1t:
    v_and_b32 v168, 63, v0
    v_lshlrev_b32 v1, 4, v168
    v_and_b32 v169, 31, v0
    v_bfe_u32 v170, v0, 5, 1
    v_lshlrev_b32 v2, 3, v169
    v_lshl_add_u32 v2, v170, 2, v2
    v_add_u32 v2, 1024, v2
    v_mul_u32_u24 v3, 320, v170
    v_lshl_add_u32 v3, v169, 4, v3
    v_add_u32 v3, 1280, v3
    s_mov_b32 s14, 0x000fffff
    s_mov_b32 s15, 0x000fffff
    s_mov_b32 s16, 0
    s_mov_b32 s17, -1
    s_mov_b32 s20, 0
    s_mov_b32 s18, 0x00100000
    s_mov_b32 s19, 0x00100000
    v_mov_b32 v37, 0x3f803f80
    v_mov_b32 v40, 0
    v_mov_b32 v41, 0
    v_mov_b32 v42, 0
    v_mov_b32 v43, 0
    v_mov_b32 v44, 0
    v_mov_b32 v45, 0
    v_mov_b32 v46, 0
    v_mov_b32 v47, 0
    v_mov_b32 v39, 0x3f803f80
    v_mov_b32 v48, 0
    v_mov_b32 v49, 0
    v_mov_b32 v50, 0
    v_mov_b32 v51, 0
    v_mov_b32 v52, 0
    v_mov_b32 v53, 0
    v_mov_b32 v54, 0
    v_mov_b32 v55, 0
    s_mov_b64 exec, s[18:19]
    v_mov_b32 v40, 0x3f803f80
    v_mov_b32 v41, 0x3f803f80
    v_mov_b32 v42, 0x3f803f80
    v_mov_b32 v43, 0x3f803f80
    v_mov_b32 v44, 0x3f803f80
    v_mov_b32 v45, 0x3f803f80
    v_mov_b32 v46, 0x3f803f80
    v_mov_b32 v47, 0x3f803f80
    v_mov_b32 v48, 0x3f803f80
    v_mov_b32 v49, 0x3f803f80
    v_mov_b32 v50, 0x3f803f80
    v_mov_b32 v51, 0x3f803f80
    v_mov_b32 v52, 0x3f803f80
    v_mov_b32 v53, 0x3f803f80
    v_mov_b32 v54, 0x3f803f80
    v_mov_b32 v55, 0x3f803f80
    s_mov_b64 exec, -1
    s_mov_b32 s9, s54
    s_mov_b32 s10, s55
    s_mov_b32 s11, s56
    s_mov_b32 s13, s57
    s_mov_b32 s22, s59
    s_lshl_b32 s28, s56, 8
    s_add_u32 s28, s28, 10649600
    s_add_u32 s29, s28, 8448
    s_mul_i32 s25, s8, 5120
    s_add_u32 s25, s25, 49152
    s_mul_i32 s26, s57, 2560
    s_add_u32 s27, s25, s26
    s_sub_u32 s25, s25, s26
    s_add_u32 s25, s25, 2560
    s_load_dwordx2 s[40:41], s[0:1], 32
    s_load_dwordx2 s[42:43], s[0:1], 56
    s_and_b32 s48, s53, 1
    s_bfe_u32 s49, s53, 0x10001
    s_lshr_b32 s50, s53, 2
    s_and_b32 s51, s58, 3
    s_lshr_b32 s36, s58, 3
    s_lshl_b32 s36, s36, 2
    s_add_u32 s51, s51, s36
    s_mov_b32 s99, s51
    s_add_u32 s98, s99, s48
    s_mul_i32 s51, s51, 160
    s_mul_i32 s44, s48, 20480
    s_mul_i32 s36, s49, 10240
    s_add_u32 s44, s44, s36
    s_mul_i32 s36, s50, 5120
    s_add_u32 s44, s44, s36
    s_lshl_b32 s36, s48, 1
    s_add_u32 s36, s36, s50
    s_mul_i32 s45, s50, 51200
    s_add_u32 s45, s45, s51
    s_mul_i32 s46, s36, 204800
    s_add_u32 s46, s46, s51
    s_waitcnt lgkmcnt(0)
    s_cmp_eq_u32 s48, 0
    s_cselect_b32 s100, s40, s42
    s_cselect_b32 s101, s41, s43
    s_cmp_eq_u32 s49, 0
    s_cselect_b32 s40, s40, s42
    s_cselect_b32 s41, s41, s43
    s_and_b32 s41, s41, 0xffff
    s_mov_b32 s42, 819200
    s_mov_b32 s43, 0x20000
    s_lshl_b32 s36, s52, 3
    s_add_u32 s36, s36, s53
    s_lshr_b32 s37, s36, 1
    s_mul_i32 s47, s37, 6400
    s_add_u32 s52, s47, 6272
    s_cmp_lg_u32 s53, 6
    s_cbranch_scc1 L_mk_tb
    v_and_b32 v168, 63, v0
    v_add_u32 v169, 0, v168
    v_mul_u32_u24 v170, 6554, v169
    v_lshrrev_b32 v170, 16, v170
    v_mul_u32_u24 v171, 10, v170
    v_sub_u32 v169, v169, v171
    v_lshrrev_b32 v171, 2, v170
    v_bfe_u32 v172, v171, 1, 1
    v_xor_b32 v171, v171, v172
    v_and_b32 v170, 3, v170
    v_lshrrev_b32 v172, 2, v171
    v_add_u32 v172, v172, v171
    v_lshl_add_u32 v172, v172, 2, v170
    v_mul_u32_u24 v172, 1280, v172
    v_lshl_add_u32 v240, v169, 4, v172
    v_mul_u32_u24 v172, 20, v171
    v_add3_u32 v172, v172, v170, 16
    v_mul_u32_u24 v172, 1280, v172
    v_lshl_add_u32 v245, v169, 4, v172
    v_add_u32 v169, 64, v168
    v_mul_u32_u24 v170, 6554, v169
    v_lshrrev_b32 v170, 16, v170
    v_mul_u32_u24 v171, 10, v170
    v_sub_u32 v169, v169, v171
    v_lshrrev_b32 v171, 2, v170
    v_bfe_u32 v172, v171, 1, 1
    v_xor_b32 v171, v171, v172
    v_and_b32 v170, 3, v170
    v_lshrrev_b32 v172, 2, v171
    v_add_u32 v172, v172, v171
    v_lshl_add_u32 v172, v172, 2, v170
    v_mul_u32_u24 v172, 1280, v172
    v_lshl_add_u32 v241, v169, 4, v172
    v_mul_u32_u24 v172, 20, v171
    v_add3_u32 v172, v172, v170, 16
    v_mul_u32_u24 v172, 1280, v172
    v_lshl_add_u32 v246, v169, 4, v172
    v_add_u32 v169, 128, v168
    v_mul_u32_u24 v170, 6554, v169
    v_lshrrev_b32 v170, 16, v170
    v_mul_u32_u24 v171, 10, v170
    v_sub_u32 v169, v169, v171
    v_lshrrev_b32 v171, 2, v170
    v_bfe_u32 v172, v171, 1, 1
    v_xor_b32 v171, v171, v172
    v_and_b32 v170, 3, v170
    v_lshrrev_b32 v172, 2, v171
    v_add_u32 v172, v172, v171
    v_lshl_add_u32 v172, v172, 2, v170
    v_mul_u32_u24 v172, 1280, v172
    v_lshl_add_u32 v242, v169, 4, v172
    v_mul_u32_u24 v172, 20, v171
    v_add3_u32 v172, v172, v170, 16
    v_mul_u32_u24 v172, 1280, v172
    v_lshl_add_u32 v247, v169, 4, v172
    v_add_u32 v169, 192, v168
    v_mul_u32_u24 v170, 6554, v169
    v_lshrrev_b32 v170, 16, v170
    v_mul_u32_u24 v171, 10, v170
    v_sub_u32 v169, v169, v171
    v_lshrrev_b32 v171, 2, v170
    v_bfe_u32 v172, v171, 1, 1
    v_xor_b32 v171, v171, v172
    v_and_b32 v170, 3, v170
    v_lshrrev_b32 v172, 2, v171
    v_add_u32 v172, v172, v171
    v_lshl_add_u32 v172, v172, 2, v170
    v_mul_u32_u24 v172, 1280, v172
    v_lshl_add_u32 v243, v169, 4, v172
    v_mul_u32_u24 v172, 20, v171
    v_add3_u32 v172, v172, v170, 16
    v_mul_u32_u24 v172, 1280, v172
    v_lshl_add_u32 v248, v169, 4, v172
    v_add_u32 v169, 256, v168
    v_mul_u32_u24 v170, 6554, v169
    v_lshrrev_b32 v170, 16, v170
    v_mul_u32_u24 v171, 10, v170
    v_sub_u32 v169, v169, v171
    v_lshrrev_b32 v171, 2, v170
    v_bfe_u32 v172, v171, 1, 1
    v_xor_b32 v171, v171, v172
    v_and_b32 v170, 3, v170
    v_lshrrev_b32 v172, 2, v171
    v_add_u32 v172, v172, v171
    v_lshl_add_u32 v172, v172, 2, v170
    v_mul_u32_u24 v172, 1280, v172
    v_lshl_add_u32 v244, v169, 4, v172
    v_mul_u32_u24 v172, 20, v171
    v_add3_u32 v172, v172, v170, 16
    v_mul_u32_u24 v172, 1280, v172
    v_lshl_add_u32 v249, v169, 4, v172
    v_mul_u32_u24 v169, 48, v168
    v_add_u32 v169, 69632, v169
    v_mov_b32 v170, 72704
    v_mov_b32 v171, 0
    ds_write_b128 v169, v[240:243]
    ds_write_b128 v169, v[244:247] offset:16
    ds_write_b64 v169, v[248:249] offset:32
    ds_write_b32 v170, v171
    s_waitcnt lgkmcnt(0)
L_mk_tb:
    s_barrier
    s_branch L_mk_join
L_mk_compute:
    s_mov_b32 s4, s62
    s_and_b32 s5, s63, 0xffff
    s_mov_b32 s6, 268435456
    s_mov_b32 s7, 0x20000
    s_and_b32 s61, s61, 0xffff
    s_mov_b32 s62, 256
    s_mov_b32 s63, 0x20000
    s_and_b32 s17, s17, 0xffff
    s_cmp_lt_u32 s10, 8
    s_cselect_b32 s48, s48, s16
    s_cselect_b32 s49, s49, s17
    s_cselect_b32 s24, s24, 3840
    s_cselect_b32 s20, s20, s22
    s_cselect_b32 s21, s21, s23
    s_and_b32 s41, s41, 0xffff
    s_and_b32 s49, s49, 0xffff
    s_mul_i32 s50, s24, 640
    s_mov_b32 s51, 0x20000
    s_and_b32 s21, s21, 0xffff
    s_mov_b32 s22, 25600
    s_mov_b32 s23, 0x20000
    s_mov_b32 s18, 2457600
    s_mov_b32 s19, 0x20000
    v_and_b32 v168, 63, v0
    v_lshlrev_b32 v1, 4, v168
    v_and_b32 v169, 31, v0
    v_bfe_u32 v170, v0, 5, 1
    v_lshlrev_b32 v2, 3, v169
    v_lshl_add_u32 v2, v170, 2, v2
    v_add_u32 v2, 1024, v2
    v_mul_u32_u24 v3, 320, v170
    v_lshl_add_u32 v3, v169, 4, v3
    v_add_u32 v3, 1280, v3
    s_and_b32 s47, s10, 1
    s_lshl_b32 s47, s47, 2
    s_and_b32 s42, s10, 7
    s_lshl_b32 s42, s42, 2
    s_add_u32 s42, s42, 1
    s_mul_i32 s35, s46, 2560
    s_add_u32 s35, s35, 5242880
    s_mul_i32 s31, s42, 163840
    s_add_u32 s31, s31, s35
    s_lshl_b32 s26, s46, 2
    s_add_u32 s26, s26, 10649600
    s_add_u32 s27, s26, 8448
    s_lshl_b32 s30, s42, 8
    s_add_u32 s30, s30, s26
    s_cmp_ge_u32 s10, 8
    s_cbranch_scc1 L_mk_V
    s_add_u32 s32, s31, 163840
    s_add_u32 s33, s31, 327680
    s_add_u32 s34, s31, 491520
    s_cmp_eq_u32 s10, 1
    s_cselect_b32 s36, -1, 0
    s_cselect_b32 s29, 1, 0
    s_mov_b32 s37, 0
    s_cmp_eq_u32 s10, 0
    s_cselect_b32 s38, -1, 0
    s_mov_b32 s39, s38
    v_and_b32 v4, 31, v0
    v_bfe_u32 v5, v0, 5, 1
    v_bfe_u32 v6, v0, 1, 3
    v_xor_b32 v6, v6, v5
    v_lshlrev_b32 v7, 7, v4
    s_lshl_b32 s25, s8, 12
    v_add_u32 v8, s25, v7
    v_xor_b32 v9, 0, v6
    v_lshl_add_u32 v236, v9, 4, v8
    v_xor_b32 v9, 2, v6
    v_lshl_add_u32 v237, v9, 4, v8
    v_xor_b32 v9, 4, v6
    v_lshl_add_u32 v238, v9, 4, v8
    v_xor_b32 v9, 6, v6
    v_lshl_add_u32 v239, v9, 4, v8
    v_bfe_u32 v7, v0, 2, 2
    v_lshl_add_u32 v7, v5, 3, v7
    v_and_b32 v8, 3, v0
    v_bfe_u32 v9, v0, 4, 1
    v_mul_u32_u24 v10, 160, v7
    v_add_u32 v10, 16384, v10
    v_mul_u32_u24 v11, 5, v9
    v_add_u32 v11, v11, v8
    v_lshl_add_u32 v248, v11, 3, v10
    v_add_u32 v249, 80, v248
    v_mul_u32_u24 v11, 5, v8
    v_add_u32 v11, 4, v11
    v_lshl_add_u32 v11, v11, 3, v10
    v_add_u32 v12, s47, v8
    v_mul_u32_u24 v13, 40, v7
    v_lshl_add_u32 v12, v12, 3, v13
    v_add_u32 v12, 26624, v12
    v_cmp_eq_u32 vcc, 1, v9
    v_mov_b32 v13, 160
    v_mov_b32 v14, 40
    v_cndmask_b32 v11, v11, v12, vcc
    v_cndmask_b32 v13, v13, v14, vcc
    v_mad_u32_u24 v240, v13, 0, v11
    v_mad_u32_u24 v241, v13, 4, v11
    v_mad_u32_u24 v242, v13, 16, v11
    v_mad_u32_u24 v243, v13, 20, v11
    v_mad_u32_u24 v244, v13, 32, v11
    v_mad_u32_u24 v245, v13, 36, v11
    v_mad_u32_u24 v246, v13, 48, v11
    v_mad_u32_u24 v247, v13, 52, v11
    v_mov_b32 v164, 0
    v_mov_b32 v165, 0
    v_mov_b32 v166, 0
    v_mov_b32 v167, 0
    v_mov_b32 v168, 0
    v_mov_b32 v169, 0
    v_mov_b32 v170, 0
    v_mov_b32 v171, 0
    v_mov_b32 v172, 0
    v_mov_b32 v173, 0
    v_mov_b32 v174, 0
    v_mov_b32 v175, 0
    v_mov_b32 v176, 0
    v_mov_b32 v177, 0
    v_mov_b32 v178, 0
    v_mov_b32 v179, 0
    v_mov_b32 v180, 0
    v_mov_b32 v181, 0
    v_mov_b32 v182, 0
    v_mov_b32 v183, 0
    v_mov_b32 v184, 0
    v_mov_b32 v185, 0
    v_mov_b32 v186, 0
    v_mov_b32 v187, 0
    v_mov_b32 v188, 0
    v_mov_b32 v189, 0
    v_mov_b32 v190, 0
    v_mov_b32 v191, 0
    v_mov_b32 v192, 0
    v_mov_b32 v193, 0
    v_mov_b32 v194, 0
    v_mov_b32 v195, 0
    v_mov_b32 v196, 0
    v_mov_b32 v197, 0
    v_mov_b32 v198, 0
    v_mov_b32 v199, 0
    v_mov_b32 v200, 0
    v_mov_b32 v201, 0
    v_mov_b32 v202, 0
    v_mov_b32 v203, 0
    v_mov_b32 v204, 0
    v_mov_b32 v205, 0
    v_mov_b32 v206, 0
    v_mov_b32 v207, 0
    v_mov_b32 v208, 0
    v_mov_b32 v209, 0
    v_mov_b32 v210, 0
    v_mov_b32 v211, 0
    s_load_dwordx2 s[40:41], s[0:1], 32
    s_load_dwordx2 s[42:43], s[0:1], 56
    s_and_b32 s48, s53, 1
    s_bfe_u32 s49, s53, 0x10001
    s_lshr_b32 s50, s53, 2
    s_and_b32 s51, s58, 3
    s_lshr_b32 s28, s58, 3
    s_lshl_b32 s28, s28, 2
    s_add_u32 s51, s51, s28
    s_mov_b32 s99, s51
    s_add_u32 s98, s99, s48
    s_mul_i32 s51, s51, 160
    s_mul_i32 s44, s48, 20480
    s_mul_i32 s28, s49, 10240
    s_add_u32 s44, s44, s28
    s_mul_i32 s28, s50, 5120
    s_add_u32 s44, s44, s28
    s_lshl_b32 s28, s48, 1
    s_add_u32 s28, s28, s50
    s_mul_i32 s45, s50, 51200
    s_add_u32 s45, s45, s51
    s_mul_i32 s46, s28, 204800
    s_add_u32 s46, s46, s51
    s_waitcnt lgkmcnt(0)
    s_cmp_eq_u32 s48, 0
    s_cselect_b32 s100, s40, s42
    s_cselect_b32 s101, s41, s43
    s_cmp_eq_u32 s49, 0
    s_cselect_b32 s40, s40, s42
    s_cselect_b32 s41, s41, s43
    s_and_b32 s41, s41, 0xffff
    s_mov_b32 s42, 819200
    s_mov_b32 s43, 0x20000
    s_lshl_b32 s28, s52, 3
    s_add_u32 s28, s28, s53
    s_lshr_b32 s25, s28, 1
    s_mul_i32 s47, s25, 6400
    s_add_u32 s52, s47, 6272
    s_barrier
    ds_read_b128 v[4:7], v236
    ds_read_b64_tr_b16 v[212:213], v248 offset:0
    ds_read_b64_tr_b16 v[214:215], v248 offset:640
    ds_read_b64_tr_b16 v[216:217], v249 offset:0
    ds_read_b64_tr_b16 v[218:219], v249 offset:640
    ds_read_b64_tr_b16 v[220:221], v240
    ds_read_b64_tr_b16 v[222:223], v241
    ds_read_b128 v[8:11], v237
    ds_read_b64_tr_b16 v[224:225], v248 offset:2560
    ds_read_b64_tr_b16 v[226:227], v248 offset:3200
    ds_read_b64_tr_b16 v[228:229], v249 offset:2560
    ds_read_b64_tr_b16 v[230:231], v249 offset:3200
    ds_read_b64_tr_b16 v[232:233], v242
    ds_read_b64_tr_b16 v[234:235], v243
    s_waitcnt lgkmcnt(7)
    v_mfma_f32_32x32x16_bf16 v[164:179], v[212:215], v[4:7], v[164:179]
    ds_read_b128 v[12:15], v238
    ds_read_b64_tr_b16 v[152:153], v248 offset:5120
    ds_read_b64_tr_b16 v[154:155], v248 offset:5760
    ds_read_b64_tr_b16 v[156:157], v249 offset:5120
    v_mfma_f32_32x32x16_bf16 v[180:195], v[216:219], v[4:7], v[180:195]
    ds_read_b64_tr_b16 v[158:159], v249 offset:5760
    ds_read_b64_tr_b16 v[160:161], v244
    ds_read_b64_tr_b16 v[162:163], v245
    v_mfma_f32_32x32x16_bf16 v[196:211], v[220:223], v[4:7], v[196:211]
    s_waitcnt lgkmcnt(7)
    v_mfma_f32_32x32x16_bf16 v[164:179], v[224:227], v[8:11], v[164:179]
    ds_read_b128 v[16:19], v239
    ds_read_b64_tr_b16 v[212:213], v248 offset:7680
    ds_read_b64_tr_b16 v[214:215], v248 offset:8320
    ds_read_b64_tr_b16 v[216:217], v249 offset:7680
    v_mfma_f32_32x32x16_bf16 v[180:195], v[228:231], v[8:11], v[180:195]
    ds_read_b64_tr_b16 v[218:219], v249 offset:8320
    ds_read_b64_tr_b16 v[220:221], v246
    ds_read_b64_tr_b16 v[222:223], v247
    v_mfma_f32_32x32x16_bf16 v[196:211], v[232:235], v[8:11], v[196:211]
    s_waitcnt lgkmcnt(7)
    v_mfma_f32_32x32x16_bf16 v[164:179], v[152:155], v[12:15], v[164:179]
    s_barrier
    v_add_u32 v236, 29696, v236
    v_add_u32 v237, 29696, v237
    v_add_u32 v238, 29696, v238
    v_add_u32 v239, 29696, v239
    v_add_u32 v248, 29696, v248
    v_add_u32 v249, 29696, v249
    v_add_u32 v240, 29696, v240
    v_add_u32 v241, 29696, v241
    v_add_u32 v242, 29696, v242
    v_add_u32 v243, 29696, v243
    v_add_u32 v244, 29696, v244
    v_add_u32 v245, 29696, v245
    v_add_u32 v246, 29696, v246
    v_add_u32 v247, 29696, v247
    ds_read_b128 v[20:23], v236
    ds_read_b64_tr_b16 v[224:225], v248 offset:0
    ds_read_b64_tr_b16 v[226:227], v248 offset:640
    ds_read_b64_tr_b16 v[228:229], v249 offset:0
    v_mfma_f32_32x32x16_bf16 v[180:195], v[156:159], v[12:15], v[180:195]
    ds_read_b64_tr_b16 v[230:231], v249 offset:640
    ds_read_b64_tr_b16 v[232:233], v240
    ds_read_b64_tr_b16 v[234:235], v241
    v_mfma_f32_32x32x16_bf16 v[196:211], v[160:163], v[12:15], v[196:211]
    s_waitcnt lgkmcnt(7)
    v_mfma_f32_32x32x16_bf16 v[164:179], v[212:215], v[16:19], v[164:179]
    ds_read_b128 v[24:27], v237
    ds_read_b64_tr_b16 v[152:153], v248 offset:2560
    ds_read_b64_tr_b16 v[154:155], v248 offset:3200
    ds_read_b64_tr_b16 v[156:157], v249 offset:2560
    v_mfma_f32_32x32x16_bf16 v[180:195], v[216:219], v[16:19], v[180:195]
    ds_read_b64_tr_b16 v[158:159], v249 offset:3200
    ds_read_b64_tr_b16 v[160:161], v242
    ds_read_b64_tr_b16 v[162:163], v243
    v_mfma_f32_32x32x16_bf16 v[196:211], v[220:223], v[16:19], v[196:211]
    s_waitcnt lgkmcnt(7)
    v_mfma_f32_32x32x16_bf16 v[164:179], v[224:227], v[20:23], v[164:179]
    ds_read_b128 v[28:31], v238
    ds_read_b64_tr_b16 v[212:213], v248 offset:5120
    ds_read_b64_tr_b16 v[214:215], v248 offset:5760
    ds_read_b64_tr_b16 v[216:217], v249 offset:5120
    v_mfma_f32_32x32x16_bf16 v[180:195], v[228:231], v[20:23], v[180:195]
    ds_read_b64_tr_b16 v[218:219], v249 offset:5760
    ds_read_b64_tr_b16 v[220:221], v244
    ds_read_b64_tr_b16 v[222:223], v245
    v_mfma_f32_32x32x16_bf16 v[196:211], v[232:235], v[20:23], v[196:211]
    s_waitcnt lgkmcnt(7)
    v_mfma_f32_32x32x16_bf16 v[164:179], v[152:155], v[24:27], v[164:179]
    ds_read_b128 v[32:35], v239
    ds_read_b64_tr_b16 v[224:225], v248 offset:7680
    ds_read_b64_tr_b16 v[226:227], v248 offset:8320
    ds_read_b64_tr_b16 v[228:229], v249 offset:7680
    v_mfma_f32_32x32x16_bf16 v[180:195], v[156:159], v[24:27], v[180:195]
    ds_read_b64_tr_b16 v[230:231], v249 offset:8320
    ds_read_b64_tr_b16 v[232:233], v246
    ds_read_b64_tr_b16 v[234:235], v247
    v_mfma_f32_32x32x16_bf16 v[196:211], v[160:163], v[24:27], v[196:211]
    s_waitcnt lgkmcnt(7)
    v_mfma_f32_32x32x16_bf16 v[164:179], v[212:215], v[28:31], v[164:179]
    s_barrier
    v_add_u32 v236, 29696, v236
    v_add_u32 v237, 29696, v237
    v_add_u32 v238, 29696, v238
    v_add_u32 v239, 29696, v239
    v_add_u32 v248, 29696, v248
    v_add_u32 v249, 29696, v249
    v_add_u32 v240, 29696, v240
    v_add_u32 v241, 29696, v241
    v_add_u32 v242, 29696, v242
    v_add_u32 v243, 29696, v243
    v_add_u32 v244, 29696, v244
    v_add_u32 v245, 29696, v245
    v_add_u32 v246, 29696, v246
    v_add_u32 v247, 29696, v247
    ds_read_b128 v[36:39], v236
    ds_read_b64_tr_b16 v[152:153], v248 offset:0
    ds_read_b64_tr_b16 v[154:155], v248 offset:640
    ds_read_b64_tr_b16 v[156:157], v249 offset:0
    v_mfma_f32_32x32x16_bf16 v[180:195], v[216:219], v[28:31], v[180:195]
    ds_read_b64_tr_b16 v[158:159], v249 offset:640
    ds_read_b64_tr_b16 v[160:161], v240
    ds_read_b64_tr_b16 v[162:163], v241
    v_mfma_f32_32x32x16_bf16 v[196:211], v[220:223], v[28:31], v[196:211]
    s_waitcnt lgkmcnt(7)
    v_mfma_f32_32x32x16_bf16 v[164:179], v[224:227], v[32:35], v[164:179]
    ds_read_b128 v[40:43], v237
    ds_read_b64_tr_b16 v[212:213], v248 offset:2560
    ds_read_b64_tr_b16 v[214:215], v248 offset:3200
    ds_read_b64_tr_b16 v[216:217], v249 offset:2560
    v_mfma_f32_32x32x16_bf16 v[180:195], v[228:231], v[32:35], v[180:195]
    ds_read_b64_tr_b16 v[218:219], v249 offset:3200
    ds_read_b64_tr_b16 v[220:221], v242
    ds_read_b64_tr_b16 v[222:223], v243
    v_mfma_f32_32x32x16_bf16 v[196:211], v[232:235], v[32:35], v[196:211]
    s_waitcnt lgkmcnt(7)
    v_mfma_f32_32x32x16_bf16 v[164:179], v[152:155], v[36:39], v[164:179]
    ds_read_b128 v[44:47], v238
    ds_read_b64_tr_b16 v[224:225], v248 offset:5120
    ds_read_b64_tr_b16 v[226:227], v248 offset:5760
    ds_read_b64_tr_b16 v[228:229], v249 offset:5120
    v_mfma_f32_32x32x16_bf16 v[180:195], v[156:159], v[36:39], v[180:195]
    ds_read_b64_tr_b16 v[230:231], v249 offset:5760
    ds_read_b64_tr_b16 v[232:233], v244
    ds_read_b64_tr_b16 v[234:235], v245
    v_mfma_f32_32x32x16_bf16 v[196:211], v[160:163], v[36:39], v[196:211]
    s_waitcnt lgkmcnt(7)
    v_mfma_f32_32x32x16_bf16 v[164:179], v[212:215], v[40:43], v[164:179]
    ds_read_b128 v[48:51], v239
    ds_read_b64_tr_b16 v[152:153], v248 offset:7680
    ds_read_b64_tr_b16 v[154:155], v248 offset:8320
    ds_read_b64_tr_b16 v[156:157], v249 offset:7680
    v_mfma_f32_32x32x16_bf16 v[180:195], v[216:219], v[40:43], v[180:195]
    ds_read_b64_tr_b16 v[158:159], v249 offset:8320
    ds_read_b64_tr_b16 v[160:161], v246
    ds_read_b64_tr_b16 v[162:163], v247
    v_mfma_f32_32x32x16_bf16 v[196:211], v[220:223], v[40:43], v[196:211]
    s_waitcnt lgkmcnt(7)
    v_mfma_f32_32x32x16_bf16 v[164:179], v[224:227], v[44:47], v[164:179]
    s_barrier
    v_add_u32 v236, 29696, v236
    v_add_u32 v237, 29696, v237
    v_add_u32 v238, 29696, v238
    v_add_u32 v239, 29696, v239
    v_add_u32 v248, 29696, v248
    v_add_u32 v249, 29696, v249
    v_add_u32 v240, 29696, v240
    v_add_u32 v241, 29696, v241
    v_add_u32 v242, 29696, v242
    v_add_u32 v243, 29696, v243
    v_add_u32 v244, 29696, v244
    v_add_u32 v245, 29696, v245
    v_add_u32 v246, 29696, v246
    v_add_u32 v247, 29696, v247
    ds_read_b128 v[52:55], v236
    ds_read_b64_tr_b16 v[212:213], v248 offset:0
    ds_read_b64_tr_b16 v[214:215], v248 offset:640
    ds_read_b64_tr_b16 v[216:217], v249 offset:0
    v_mfma_f32_32x32x16_bf16 v[180:195], v[228:231], v[44:47], v[180:195]
    ds_read_b64_tr_b16 v[218:219], v249 offset:640
    ds_read_b64_tr_b16 v[220:221], v240
    ds_read_b64_tr_b16 v[222:223], v241
    v_mfma_f32_32x32x16_bf16 v[196:211], v[232:235], v[44:47], v[196:211]
    s_waitcnt lgkmcnt(7)
    v_mfma_f32_32x32x16_bf16 v[164:179], v[152:155], v[48:51], v[164:179]
    ds_read_b128 v[56:59], v237
    ds_read_b64_tr_b16 v[224:225], v248 offset:2560
    ds_read_b64_tr_b16 v[226:227], v248 offset:3200
    ds_read_b64_tr_b16 v[228:229], v249 offset:2560
    v_mfma_f32_32x32x16_bf16 v[180:195], v[156:159], v[48:51], v[180:195]
    ds_read_b64_tr_b16 v[230:231], v249 offset:3200
    ds_read_b64_tr_b16 v[232:233], v242
    ds_read_b64_tr_b16 v[234:235], v243
    v_mfma_f32_32x32x16_bf16 v[196:211], v[160:163], v[48:51], v[196:211]
    s_waitcnt lgkmcnt(7)
    v_mfma_f32_32x32x16_bf16 v[164:179], v[212:215], v[52:55], v[164:179]
    ds_read_b128 v[60:63], v238
    ds_read_b64_tr_b16 v[152:153], v248 offset:5120
    ds_read_b64_tr_b16 v[154:155], v248 offset:5760
    ds_read_b64_tr_b16 v[156:157], v249 offset:5120
    v_mfma_f32_32x32x16_bf16 v[180:195], v[216:219], v[52:55], v[180:195]
    ds_read_b64_tr_b16 v[158:159], v249 offset:5760
    ds_read_b64_tr_b16 v[160:161], v244
    ds_read_b64_tr_b16 v[162:163], v245
    v_mfma_f32_32x32x16_bf16 v[196:211], v[220:223], v[52:55], v[196:211]
    s_waitcnt lgkmcnt(7)
    v_mfma_f32_32x32x16_bf16 v[164:179], v[224:227], v[56:59], v[164:179]
    ds_read_b128 v[64:67], v239
    ds_read_b64_tr_b16 v[212:213], v248 offset:7680
    ds_read_b64_tr_b16 v[214:215], v248 offset:8320
    ds_read_b64_tr_b16 v[216:217], v249 offset:7680
    v_mfma_f32_32x32x16_bf16 v[180:195], v[228:231], v[56:59], v[180:195]
    ds_read_b64_tr_b16 v[218:219], v249 offset:8320
    ds_read_b64_tr_b16 v[220:221], v246
    ds_read_b64_tr_b16 v[222:223], v247
    v_mfma_f32_32x32x16_bf16 v[196:211], v[232:235], v[56:59], v[196:211]
    s_waitcnt lgkmcnt(7)
    v_mfma_f32_32x32x16_bf16 v[164:179], v[152:155], v[60:63], v[164:179]
    s_barrier
    v_add_u32 v236, 29696, v236
    v_add_u32 v237, 29696, v237
    v_add_u32 v238, 29696, v238
    v_add_u32 v239, 29696, v239
    v_add_u32 v248, 29696, v248
    v_add_u32 v249, 29696, v249
    v_add_u32 v240, 29696, v240
    v_add_u32 v241, 29696, v241
    v_add_u32 v242, 29696, v242
    v_add_u32 v243, 29696, v243
    v_add_u32 v244, 29696, v244
    v_add_u32 v245, 29696, v245
    v_add_u32 v246, 29696, v246
    v_add_u32 v247, 29696, v247
    ds_read_b128 v[68:71], v236
    ds_read_b64_tr_b16 v[224:225], v248 offset:0
    ds_read_b64_tr_b16 v[226:227], v248 offset:640
    ds_read_b64_tr_b16 v[228:229], v249 offset:0
    v_mfma_f32_32x32x16_bf16 v[180:195], v[156:159], v[60:63], v[180:195]
    ds_read_b64_tr_b16 v[230:231], v249 offset:640
    ds_read_b64_tr_b16 v[232:233], v240
    ds_read_b64_tr_b16 v[234:235], v241
    v_mfma_f32_32x32x16_bf16 v[196:211], v[160:163], v[60:63], v[196:211]
    s_waitcnt lgkmcnt(7)
    v_mfma_f32_32x32x16_bf16 v[164:179], v[212:215], v[64:67], v[164:179]
    ds_read_b128 v[72:75], v237
    ds_read_b64_tr_b16 v[152:153], v248 offset:2560
    ds_read_b64_tr_b16 v[154:155], v248 offset:3200
    ds_read_b64_tr_b16 v[156:157], v249 offset:2560
    v_mfma_f32_32x32x16_bf16 v[180:195], v[216:219], v[64:67], v[180:195]
    ds_read_b64_tr_b16 v[158:159], v249 offset:3200
    ds_read_b64_tr_b16 v[160:161], v242
    ds_read_b64_tr_b16 v[162:163], v243
    v_mfma_f32_32x32x16_bf16 v[196:211], v[220:223], v[64:67], v[196:211]
    s_waitcnt lgkmcnt(7)
    v_mfma_f32_32x32x16_bf16 v[164:179], v[224:227], v[68:71], v[164:179]
    ds_read_b128 v[76:79], v238
    ds_read_b64_tr_b16 v[212:213], v248 offset:5120
    ds_read_b64_tr_b16 v[214:215], v248 offset:5760
    ds_read_b64_tr_b16 v[216:217], v249 offset:5120
    v_mfma_f32_32x32x16_bf16 v[180:195], v[228:231], v[68:71], v[180:195]
    ds_read_b64_tr_b16 v[218:219], v249 offset:5760
    ds_read_b64_tr_b16 v[220:221], v244
    ds_read_b64_tr_b16 v[222:223], v245
    v_mfma_f32_32x32x16_bf16 v[196:211], v[232:235], v[68:71], v[196:211]
    s_waitcnt lgkmcnt(7)
    v_mfma_f32_32x32x16_bf16 v[164:179], v[152:155], v[72:75], v[164:179]
    ds_read_b128 v[80:83], v239
    ds_read_b64_tr_b16 v[224:225], v248 offset:7680
    ds_read_b64_tr_b16 v[226:227], v248 offset:8320
    ds_read_b64_tr_b16 v[228:229], v249 offset:7680
    v_mfma_f32_32x32x16_bf16 v[180:195], v[156:159], v[72:75], v[180:195]
    ds_read_b64_tr_b16 v[230:231], v249 offset:8320
    ds_read_b64_tr_b16 v[232:233], v246
    ds_read_b64_tr_b16 v[234:235], v247
    v_mfma_f32_32x32x16_bf16 v[196:211], v[160:163], v[72:75], v[196:211]
    s_waitcnt lgkmcnt(7)
    v_mfma_f32_32x32x16_bf16 v[164:179], v[212:215], v[76:79], v[164:179]
    s_barrier
    v_subrev_u32 v236, 118784, v236
    v_subrev_u32 v237, 118784, v237
    v_subrev_u32 v238, 118784, v238
    v_subrev_u32 v239, 118784, v239
    v_subrev_u32 v248, 118784, v248
    v_subrev_u32 v249, 118784, v249
    v_subrev_u32 v240, 118784, v240
    v_subrev_u32 v241, 118784, v241
    v_subrev_u32 v242, 118784, v242
    v_subrev_u32 v243, 118784, v243
    v_subrev_u32 v244, 118784, v244
    v_subrev_u32 v245, 118784, v245
    v_subrev_u32 v246, 118784, v246
    v_subrev_u32 v247, 118784, v247
    ds_read_b128 v[84:87], v236
    ds_read_b64_tr_b16 v[152:153], v248 offset:0
    ds_read_b64_tr_b16 v[154:155], v248 offset:640
    ds_read_b64_tr_b16 v[156:157], v249 offset:0
    v_mfma_f32_32x32x16_bf16 v[180:195], v[216:219], v[76:79], v[180:195]
    ds_read_b64_tr_b16 v[158:159], v249 offset:640
    ds_read_b64_tr_b16 v[160:161], v240
    ds_read_b64_tr_b16 v[162:163], v241
    v_mfma_f32_32x32x16_bf16 v[196:211], v[220:223], v[76:79], v[196:211]
    s_waitcnt lgkmcnt(7)
    v_mfma_f32_32x32x16_bf16 v[164:179], v[224:227], v[80:83], v[164:179]
    ds_read_b128 v[88:91], v237
    ds_read_b64_tr_b16 v[212:213], v248 offset:2560
    ds_read_b64_tr_b16 v[214:215], v248 offset:3200
    ds_read_b64_tr_b16 v[216:217], v249 offset:2560
    v_mfma_f32_32x32x16_bf16 v[180:195], v[228:231], v[80:83], v[180:195]
    ds_read_b64_tr_b16 v[218:219], v249 offset:3200
    ds_read_b64_tr_b16 v[220:221], v242
    ds_read_b64_tr_b16 v[222:223], v243
    v_mfma_f32_32x32x16_bf16 v[196:211], v[232:235], v[80:83], v[196:211]
    s_waitcnt lgkmcnt(7)
    v_mfma_f32_32x32x16_bf16 v[164:179], v[152:155], v[84:87], v[164:179]
    ds_read_b128 v[92:95], v238
    ds_read_b64_tr_b16 v[224:225], v248 offset:5120
    ds_read_b64_tr_b16 v[226:227], v248 offset:5760
    ds_read_b64_tr_b16 v[228:229], v249 offset:5120
    v_mfma_f32_32x32x16_bf16 v[180:195], v[156:159], v[84:87], v[180:195]
    ds_read_b64_tr_b16 v[230:231], v249 offset:5760
    ds_read_b64_tr_b16 v[232:233], v244
    ds_read_b64_tr_b16 v[234:235], v245
    v_mfma_f32_32x32x16_bf16 v[196:211], v[160:163], v[84:87], v[196:211]
    s_waitcnt lgkmcnt(7)
    v_mfma_f32_32x32x16_bf16 v[164:179], v[212:215], v[88:91], v[164:179]
    ds_read_b128 v[96:99], v239
    ds_read_b64_tr_b16 v[152:153], v248 offset:7680
    ds_read_b64_tr_b16 v[154:155], v248 offset:8320
    ds_read_b64_tr_b16 v[156:157], v249 offset:7680
    v_mfma_f32_32x32x16_bf16 v[180:195], v[216:219], v[88:91], v[180:195]
    ds_read_b64_tr_b16 v[158:159], v249 offset:8320
    ds_read_b64_tr_b16 v[160:161], v246
    ds_read_b64_tr_b16 v[162:163], v247
    v_mfma_f32_32x32x16_bf16 v[196:211], v[220:223], v[88:91], v[196:211]
    s_waitcnt lgkmcnt(7)
    v_mfma_f32_32x32x16_bf16 v[164:179], v[224:227], v[92:95], v[164:179]
    s_barrier
    v_add_u32 v236, 29696, v236
    v_add_u32 v237, 29696, v237
    v_add_u32 v238, 29696, v238
    v_add_u32 v239, 29696, v239
    v_add_u32 v248, 29696, v248
    v_add_u32 v249, 29696, v249
    v_add_u32 v240, 29696, v240
    v_add_u32 v241, 29696, v241
    v_add_u32 v242, 29696, v242
    v_add_u32 v243, 29696, v243
    v_add_u32 v244, 29696, v244
    v_add_u32 v245, 29696, v245
    v_add_u32 v246, 29696, v246
    v_add_u32 v247, 29696, v247
    ds_read_b128 v[100:103], v236
    ds_read_b64_tr_b16 v[212:213], v248 offset:0
    ds_read_b64_tr_b16 v[214:215], v248 offset:640
    ds_read_b64_tr_b16 v[216:217], v249 offset:0
    v_mfma_f32_32x32x16_bf16 v[180:195], v[228:231], v[92:95], v[180:195]
    ds_read_b64_tr_b16 v[218:219], v249 offset:640
    ds_read_b64_tr_b16 v[220:221], v240
    ds_read_b64_tr_b16 v[222:223], v241
    v_mfma_f32_32x32x16_bf16 v[196:211], v[232:235], v[92:95], v[196:211]
    s_waitcnt lgkmcnt(7)
    v_mfma_f32_32x32x16_bf16 v[164:179], v[152:155], v[96:99], v[164:179]
    ds_read_b128 v[104:107], v237
    ds_read_b64_tr_b16 v[224:225], v248 offset:2560
    ds_read_b64_tr_b16 v[226:227], v248 offset:3200
    ds_read_b64_tr_b16 v[228:229], v249 offset:2560
    v_mfma_f32_32x32x16_bf16 v[180:195], v[156:159], v[96:99], v[180:195]
    ds_read_b64_tr_b16 v[230:231], v249 offset:3200
    ds_read_b64_tr_b16 v[232:233], v242
    ds_read_b64_tr_b16 v[234:235], v243
    v_mfma_f32_32x32x16_bf16 v[196:211], v[160:163], v[96:99], v[196:211]
    s_waitcnt lgkmcnt(7)
    v_mfma_f32_32x32x16_bf16 v[164:179], v[212:215], v[100:103], v[164:179]
    ds_read_b128 v[108:111], v238
    ds_read_b64_tr_b16 v[152:153], v248 offset:5120
    ds_read_b64_tr_b16 v[154:155], v248 offset:5760
    ds_read_b64_tr_b16 v[156:157], v249 offset:5120
    v_mfma_f32_32x32x16_bf16 v[180:195], v[216:219], v[100:103], v[180:195]
    ds_read_b64_tr_b16 v[158:159], v249 offset:5760
    ds_read_b64_tr_b16 v[160:161], v244
    ds_read_b64_tr_b16 v[162:163], v245
    v_mfma_f32_32x32x16_bf16 v[196:211], v[220:223], v[100:103], v[196:211]
    s_waitcnt lgkmcnt(7)
    v_mfma_f32_32x32x16_bf16 v[164:179], v[224:227], v[104:107], v[164:179]
    ds_read_b128 v[112:115], v239
    ds_read_b64_tr_b16 v[212:213], v248 offset:7680
    ds_read_b64_tr_b16 v[214:215], v248 offset:8320
    ds_read_b64_tr_b16 v[216:217], v249 offset:7680
    v_mfma_f32_32x32x16_bf16 v[180:195], v[228:231], v[104:107], v[180:195]
    ds_read_b64_tr_b16 v[218:219], v249 offset:8320
    ds_read_b64_tr_b16 v[220:221], v246
    ds_read_b64_tr_b16 v[222:223], v247
    v_mfma_f32_32x32x16_bf16 v[196:211], v[232:235], v[104:107], v[196:211]
    s_waitcnt lgkmcnt(7)
    v_mfma_f32_32x32x16_bf16 v[164:179], v[152:155], v[108:111], v[164:179]
    s_barrier
    v_add_u32 v236, 29696, v236
    v_add_u32 v237, 29696, v237
    v_add_u32 v238, 29696, v238
    v_add_u32 v239, 29696, v239
    v_add_u32 v248, 29696, v248
    v_add_u32 v249, 29696, v249
    v_add_u32 v240, 29696, v240
    v_add_u32 v241, 29696, v241
    v_add_u32 v242, 29696, v242
    v_add_u32 v243, 29696, v243
    v_add_u32 v244, 29696, v244
    v_add_u32 v245, 29696, v245
    v_add_u32 v246, 29696, v246
    v_add_u32 v247, 29696, v247
    ds_read_b128 v[116:119], v236
    ds_read_b64_tr_b16 v[224:225], v248 offset:0
    ds_read_b64_tr_b16 v[226:227], v248 offset:640
    ds_read_b64_tr_b16 v[228:229], v249 offset:0
    v_mfma_f32_32x32x16_bf16 v[180:195], v[156:159], v[108:111], v[180:195]
    ds_read_b64_tr_b16 v[230:231], v249 offset:640
    ds_read_b64_tr_b16 v[232:233], v240
    ds_read_b64_tr_b16 v[234:235], v241
    v_mfma_f32_32x32x16_bf16 v[196:211], v[160:163], v[108:111], v[196:211]
    s_waitcnt lgkmcnt(7)
    v_mfma_f32_32x32x16_bf16 v[164:179], v[212:215], v[112:115], v[164:179]
    ds_read_b128 v[120:123], v237
    ds_read_b64_tr_b16 v[152:153], v248 offset:2560
    ds_read_b64_tr_b16 v[154:155], v248 offset:3200
    ds_read_b64_tr_b16 v[156:157], v249 offset:2560
    v_mfma_f32_32x32x16_bf16 v[180:195], v[216:219], v[112:115], v[180:195]
    ds_read_b64_tr_b16 v[158:159], v249 offset:3200
    ds_read_b64_tr_b16 v[160:161], v242
    ds_read_b64_tr_b16 v[162:163], v243
    v_mfma_f32_32x32x16_bf16 v[196:211], v[220:223], v[112:115], v[196:211]
    s_waitcnt lgkmcnt(7)
    v_mfma_f32_32x32x16_bf16 v[164:179], v[224:227], v[116:119], v[164:179]
    ds_read_b128 v[124:127], v238
    ds_read_b64_tr_b16 v[212:213], v248 offset:5120
    ds_read_b64_tr_b16 v[214:215], v248 offset:5760
    ds_read_b64_tr_b16 v[216:217], v249 offset:5120
    v_mfma_f32_32x32x16_bf16 v[180:195], v[228:231], v[116:119], v[180:195]
    ds_read_b64_tr_b16 v[218:219], v249 offset:5760
    ds_read_b64_tr_b16 v[220:221], v244
    ds_read_b64_tr_b16 v[222:223], v245
    v_mfma_f32_32x32x16_bf16 v[196:211], v[232:235], v[116:119], v[196:211]
    s_waitcnt lgkmcnt(7)
    v_mfma_f32_32x32x16_bf16 v[164:179], v[152:155], v[120:123], v[164:179]
    ds_read_b128 v[128:131], v239
    ds_read_b64_tr_b16 v[224:225], v248 offset:7680
    ds_read_b64_tr_b16 v[226:227], v248 offset:8320
    ds_read_b64_tr_b16 v[228:229], v249 offset:7680
    v_mfma_f32_32x32x16_bf16 v[180:195], v[156:159], v[120:123], v[180:195]
    ds_read_b64_tr_b16 v[230:231], v249 offset:8320
    ds_read_b64_tr_b16 v[232:233], v246
    ds_read_b64_tr_b16 v[234:235], v247
    v_mfma_f32_32x32x16_bf16 v[196:211], v[160:163], v[120:123], v[196:211]
    s_waitcnt lgkmcnt(7)
    v_mfma_f32_32x32x16_bf16 v[164:179], v[212:215], v[124:127], v[164:179]
    s_barrier
    v_add_u32 v236, 29696, v236
    v_add_u32 v237, 29696, v237
    v_add_u32 v238, 29696, v238
    v_add_u32 v239, 29696, v239
    v_add_u32 v248, 29696, v248
    v_add_u32 v249, 29696, v249
    v_add_u32 v240, 29696, v240
    v_add_u32 v241, 29696, v241
    v_add_u32 v242, 29696, v242
    v_add_u32 v243, 29696, v243
    v_add_u32 v244, 29696, v244
    v_add_u32 v245, 29696, v245
    v_add_u32 v246, 29696, v246
    v_add_u32 v247, 29696, v247
    ds_read_b128 v[132:135], v236
    ds_read_b64_tr_b16 v[152:153], v248 offset:0
    ds_read_b64_tr_b16 v[154:155], v248 offset:640
    ds_read_b64_tr_b16 v[156:157], v249 offset:0
    v_mfma_f32_32x32x16_bf16 v[180:195], v[216:219], v[124:127], v[180:195]
    ds_read_b64_tr_b16 v[158:159], v249 offset:640
    ds_read_b64_tr_b16 v[160:161], v240
    ds_read_b64_tr_b16 v[162:163], v241
    v_mfma_f32_32x32x16_bf16 v[196:211], v[220:223], v[124:127], v[196:211]
    s_waitcnt lgkmcnt(7)
    v_mfma_f32_32x32x16_bf16 v[164:179], v[224:227], v[128:131], v[164:179]
    ds_read_b128 v[136:139], v237
    ds_read_b64_tr_b16 v[212:213], v248 offset:2560
    ds_read_b64_tr_b16 v[214:215], v248 offset:3200
    ds_read_b64_tr_b16 v[216:217], v249 offset:2560
    v_mfma_f32_32x32x16_bf16 v[180:195], v[228:231], v[128:131], v[180:195]
    ds_read_b64_tr_b16 v[218:219], v249 offset:3200
    ds_read_b64_tr_b16 v[220:221], v242
    ds_read_b64_tr_b16 v[222:223], v243
    v_mfma_f32_32x32x16_bf16 v[196:211], v[232:235], v[128:131], v[196:211]
    s_waitcnt lgkmcnt(7)
    v_mfma_f32_32x32x16_bf16 v[164:179], v[152:155], v[132:135], v[164:179]
    ds_read_b128 v[140:143], v238
    ds_read_b64_tr_b16 v[224:225], v248 offset:5120
    ds_read_b64_tr_b16 v[226:227], v248 offset:5760
    ds_read_b64_tr_b16 v[228:229], v249 offset:5120
    v_mfma_f32_32x32x16_bf16 v[180:195], v[156:159], v[132:135], v[180:195]
    ds_read_b64_tr_b16 v[230:231], v249 offset:5760
    ds_read_b64_tr_b16 v[232:233], v244
    ds_read_b64_tr_b16 v[234:235], v245
    v_mfma_f32_32x32x16_bf16 v[196:211], v[160:163], v[132:135], v[196:211]
    s_waitcnt lgkmcnt(7)
    v_mfma_f32_32x32x16_bf16 v[164:179], v[212:215], v[136:139], v[164:179]
    v_mfma_f32_32x32x16_bf16 v[180:195], v[216:219], v[136:139], v[180:195]
    v_mfma_f32_32x32x16_bf16 v[196:211], v[220:223], v[136:139], v[196:211]
    s_waitcnt lgkmcnt(0)
    v_mfma_f32_32x32x16_bf16 v[164:179], v[224:227], v[140:143], v[164:179]
    ds_read_b128 v[144:147], v239
    ds_read_b64_tr_b16 v[212:213], v248 offset:7680
    ds_read_b64_tr_b16 v[214:215], v248 offset:8320
    ds_read_b64_tr_b16 v[216:217], v249 offset:7680
    v_mfma_f32_32x32x16_bf16 v[180:195], v[228:231], v[140:143], v[180:195]
    ds_read_b64_tr_b16 v[218:219], v249 offset:8320
    ds_read_b64_tr_b16 v[220:221], v246
    ds_read_b64_tr_b16 v[222:223], v247
    v_mfma_f32_32x32x16_bf16 v[196:211], v[232:235], v[140:143], v[196:211]
    s_waitcnt lgkmcnt(0)
    v_mfma_f32_32x32x16_bf16 v[164:179], v[212:215], v[144:147], v[164:179]
    s_barrier
    v_add_u32 v236, 29696, v236
    v_add_u32 v237, 29696, v237
    v_add_u32 v238, 29696, v238
    v_add_u32 v239, 29696, v239
    v_add_u32 v248, 29696, v248
    v_add_u32 v249, 29696, v249
    v_add_u32 v240, 29696, v240
    v_add_u32 v241, 29696, v241
    v_add_u32 v242, 29696, v242
    v_add_u32 v243, 29696, v243
    v_add_u32 v244, 29696, v244
    v_add_u32 v245, 29696, v245
    v_add_u32 v246, 29696, v246
    v_add_u32 v247, 29696, v247
    ds_read_b128 v[148:151], v236
    ds_read_b64_tr_b16 v[224:225], v248 offset:0
    ds_read_b64_tr_b16 v[226:227], v248 offset:640
    ds_read_b64_tr_b16 v[228:229], v249 offset:0
    v_mfma_f32_32x32x16_bf16 v[180:195], v[216:219], v[144:147], v[180:195]
    ds_read_b64_tr_b16 v[230:231], v249 offset:640
    ds_read_b64_tr_b16 v[232:233], v240
    ds_read_b64_tr_b16 v[234:235], v241
    v_mfma_f32_32x32x16_bf16 v[196:211], v[220:223], v[144:147], v[196:211]
    s_waitcnt lgkmcnt(0)
    v_mfma_f32_32x32x16_bf16 v[164:179], v[224:227], v[148:151], v[164:179]
    ds_read_b128 v[152:155], v237
    ds_read_b64_tr_b16 v[212:213], v248 offset:2560
    ds_read_b64_tr_b16 v[214:215], v248 offset:3200
    ds_read_b64_tr_b16 v[216:217], v249 offset:2560
    v_mfma_f32_32x32x16_bf16 v[180:195], v[228:231], v[148:151], v[180:195]
    ds_read_b64_tr_b16 v[218:219], v249 offset:3200
    ds_read_b64_tr_b16 v[220:221], v242
    ds_read_b64_tr_b16 v[222:223], v243
    v_mfma_f32_32x32x16_bf16 v[196:211], v[232:235], v[148:151], v[196:211]
    s_waitcnt lgkmcnt(0)
    v_mfma_f32_32x32x16_bf16 v[164:179], v[212:215], v[152:155], v[164:179]
    ds_read_b128 v[156:159], v238
    ds_read_b64_tr_b16 v[224:225], v248 offset:5120
    ds_read_b64_tr_b16 v[226:227], v248 offset:5760
    ds_read_b64_tr_b16 v[228:229], v249 offset:5120
    v_mfma_f32_32x32x16_bf16 v[180:195], v[216:219], v[152:155], v[180:195]
    ds_read_b64_tr_b16 v[230:231], v249 offset:5760
    ds_read_b64_tr_b16 v[232:233], v244
    ds_read_b64_tr_b16 v[234:235], v245
    v_mfma_f32_32x32x16_bf16 v[196:211], v[220:223], v[152:155], v[196:211]
    s_waitcnt lgkmcnt(0)
    v_mfma_f32_32x32x16_bf16 v[164:179], v[224:227], v[156:159], v[164:179]
    ds_read_b128 v[160:163], v239
    ds_read_b64_tr_b16 v[212:213], v248 offset:7680
    ds_read_b64_tr_b16 v[214:215], v248 offset:8320
    ds_read_b64_tr_b16 v[216:217], v249 offset:7680
    v_mfma_f32_32x32x16_bf16 v[180:195], v[228:231], v[156:159], v[180:195]
    ds_read_b64_tr_b16 v[218:219], v249 offset:8320
    ds_read_b64_tr_b16 v[220:221], v246
    ds_read_b64_tr_b16 v[222:223], v247
    v_mfma_f32_32x32x16_bf16 v[196:211], v[232:235], v[156:159], v[196:211]
    s_waitcnt lgkmcnt(0)
    v_mfma_f32_32x32x16_bf16 v[164:179], v[212:215], v[160:163], v[164:179]
    s_barrier
    v_mfma_f32_32x32x16_bf16 v[180:195], v[216:219], v[160:163], v[180:195]
    v_mfma_f32_32x32x16_bf16 v[196:211], v[220:223], v[160:163], v[196:211]
    v_bfe_u32 v251, v0, 5, 1
    v_bfe_u32 v252, v0, 2, 2
    v_lshl_add_u32 v252, v251, 3, v252
    v_mul_u32_u24 v252, 160, v252
    v_and_b32 v253, 3, v0
    v_bfe_u32 v254, v0, 4, 1
    v_mul_u32_u24 v254, 5, v254
    v_add_u32 v254, v254, v253
    v_lshl_add_u32 v248, v254, 3, v252
    v_add_u32 v249, 80, v248
    v_mul_u32_u24 v253, 5, v253
    v_add_u32 v253, 4, v253
    v_lshl_add_u32 v250, v253, 3, v252
    ds_read_b64_tr_b16 v[212:213], v248 offset:0
    ds_read_b64_tr_b16 v[214:215], v248 offset:640
    ds_read_b64_tr_b16 v[216:217], v248 offset:2560
    ds_read_b64_tr_b16 v[218:219], v248 offset:3200
    ds_read_b64_tr_b16 v[220:221], v248 offset:5120
    ds_read_b64_tr_b16 v[222:223], v248 offset:5760
    ds_read_b64_tr_b16 v[224:225], v248 offset:7680
    ds_read_b64_tr_b16 v[226:227], v248 offset:8320
    v_and_b32 v251, 63, v0
    v_lshlrev_b32 v251, 4, v251
    v_bfe_u32 v252, v0, 5, 1
    v_lshlrev_b32 v254, 8, v252
    v_mul_u32_u24 v252, 163840, v252
    v_and_b32 v253, 31, v0
    v_lshl_add_u32 v252, v253, 3, v252
    v_add_u32 v252, 1024, v252
    v_mul_f32 v236, v164, v164
    v_mul_f32 v237, v172, v172
    v_fmac_f32 v236, v165, v165
    v_fmac_f32 v237, v173, v173
    v_fmac_f32 v236, v166, v166
    v_fmac_f32 v237, v174, v174
    v_fmac_f32 v236, v167, v167
    v_fmac_f32 v237, v175, v175
    v_fmac_f32 v236, v168, v168
    v_fmac_f32 v237, v176, v176
    v_fmac_f32 v236, v169, v169
    v_fmac_f32 v237, v177, v177
    v_fmac_f32 v236, v170, v170
    v_fmac_f32 v237, v178, v178
    v_fmac_f32 v236, v171, v171
    v_fmac_f32 v237, v179, v179
    v_cvt_pk_bf16_f32 v164, v164, v165
    v_cvt_pk_bf16_f32 v165, v166, v167
    v_cvt_pk_bf16_f32 v166, v168, v169
    v_cvt_pk_bf16_f32 v167, v170, v171
    v_cvt_pk_bf16_f32 v168, v172, v173
    v_cvt_pk_bf16_f32 v169, v174, v175
    v_cvt_pk_bf16_f32 v170, v176, v177
    v_cvt_pk_bf16_f32 v171, v178, v179
    s_nop 1
    v_permlane32_swap_b32 v164, v166
    v_permlane32_swap_b32 v165, v167
    v_permlane32_swap_b32 v168, v170
    v_permlane32_swap_b32 v169, v171
    buffer_store_dwordx4 v[164:167], v251, s[4:7], s31 offen sc1
    buffer_store_dwordx4 v[168:171], v251, s[4:7], s32 offen sc1
    s_nop 0
    s_waitcnt lgkmcnt(6)
    v_mfma_f32_32x32x16_bf16 v[164:179], v[212:215], v[4:7], 0
    ds_read_b64_tr_b16 v[228:229], v248 offset:10240
    ds_read_b64_tr_b16 v[230:231], v248 offset:10880
    v_mul_f32 v239, v180, v180
    v_mul_f32 v240, v188, v188
    v_fmac_f32 v239, v181, v181
    s_waitcnt lgkmcnt(6)
    v_mfma_f32_32x32x16_bf16 v[164:179], v[216:219], v[8:11], v[164:179]
    ds_read_b64_tr_b16 v[232:233], v248 offset:12800
    ds_read_b64_tr_b16 v[234:235], v248 offset:13440
    v_fmac_f32 v240, v189, v189
    v_fmac_f32 v239, v182, v182
    v_fmac_f32 v240, v190, v190
    s_waitcnt lgkmcnt(6)
    v_mfma_f32_32x32x16_bf16 v[164:179], v[220:223], v[12:15], v[164:179]
    ds_read_b64_tr_b16 v[212:213], v248 offset:15360
    ds_read_b64_tr_b16 v[214:215], v248 offset:16000
    v_fmac_f32 v239, v183, v183
    v_fmac_f32 v240, v191, v191
    v_fmac_f32 v239, v184, v184
    s_waitcnt lgkmcnt(6)
    v_mfma_f32_32x32x16_bf16 v[164:179], v[224:227], v[16:19], v[164:179]
    ds_read_b64_tr_b16 v[216:217], v248 offset:17920
    ds_read_b64_tr_b16 v[218:219], v248 offset:18560
    v_fmac_f32 v240, v192, v192
    v_fmac_f32 v239, v185, v185
    v_fmac_f32 v240, v193, v193
    v_fmac_f32 v239, v186, v186
    s_waitcnt lgkmcnt(6)
    v_mfma_f32_32x32x16_bf16 v[164:179], v[228:231], v[20:23], v[164:179]
    ds_read_b64_tr_b16 v[220:221], v249 offset:0
    ds_read_b64_tr_b16 v[222:223], v249 offset:640
    v_fmac_f32 v240, v194, v194
    v_fmac_f32 v239, v187, v187
    v_fmac_f32 v240, v195, v195
    s_waitcnt lgkmcnt(6)
    v_mfma_f32_32x32x16_bf16 v[164:179], v[232:235], v[24:27], v[164:179]
    ds_read_b64_tr_b16 v[224:225], v249 offset:2560
    ds_read_b64_tr_b16 v[226:227], v249 offset:3200
    v_cvt_pk_bf16_f32 v180, v180, v181
    v_cvt_pk_bf16_f32 v181, v182, v183
    v_cvt_pk_bf16_f32 v182, v184, v185
    s_waitcnt lgkmcnt(6)
    v_mfma_f32_32x32x16_bf16 v[164:179], v[212:215], v[28:31], v[164:179]
    ds_read_b64_tr_b16 v[228:229], v249 offset:5120
    ds_read_b64_tr_b16 v[230:231], v249 offset:5760
    v_cvt_pk_bf16_f32 v183, v186, v187
    v_cvt_pk_bf16_f32 v184, v188, v189
    v_cvt_pk_bf16_f32 v185, v190, v191
    s_waitcnt lgkmcnt(6)
    v_mfma_f32_32x32x16_bf16 v[164:179], v[216:219], v[32:35], v[164:179]
    ds_read_b64_tr_b16 v[232:233], v249 offset:7680
    ds_read_b64_tr_b16 v[234:235], v249 offset:8320
    v_cvt_pk_bf16_f32 v186, v192, v193
    v_cvt_pk_bf16_f32 v187, v194, v195
    s_nop 1
    v_permlane32_swap_b32 v180, v182
    v_permlane32_swap_b32 v181, v183
    v_permlane32_swap_b32 v184, v186
    v_permlane32_swap_b32 v185, v187
    buffer_store_dwordx4 v[180:183], v251, s[4:7], s33 offen sc1
    buffer_store_dwordx4 v[184:187], v251, s[4:7], s34 offen sc1
    s_nop 0
    s_waitcnt lgkmcnt(6)
    v_mfma_f32_32x32x16_bf16 v[180:195], v[220:223], v[4:7], 0
    ds_read_b64_tr_b16 v[212:213], v249 offset:10240
    ds_read_b64_tr_b16 v[214:215], v249 offset:10880
    v_mul_f32 v238, v196, v196
    v_mul_f32 v241, v200, v200
    v_mul_f32 v242, v204, v204
    s_waitcnt lgkmcnt(6)
    v_mfma_f32_32x32x16_bf16 v[180:195], v[224:227], v[8:11], v[180:195]
    ds_read_b64_tr_b16 v[216:217], v249 offset:12800
    ds_read_b64_tr_b16 v[218:219], v249 offset:13440
    v_mul_f32 v244, v208, v208
    v_fmac_f32 v238, v197, v197
    v_fmac_f32 v241, v201, v201
    v_fmac_f32 v242, v205, v205
    s_waitcnt lgkmcnt(6)
    v_mfma_f32_32x32x16_bf16 v[180:195], v[228:231], v[12:15], v[180:195]
    ds_read_b64_tr_b16 v[220:221], v249 offset:15360
    ds_read_b64_tr_b16 v[222:223], v249 offset:16000
    v_fmac_f32 v244, v209, v209
    v_fmac_f32 v238, v198, v198
    v_fmac_f32 v241, v202, v202
    s_waitcnt lgkmcnt(6)
    v_mfma_f32_32x32x16_bf16 v[180:195], v[232:235], v[16:19], v[180:195]
    ds_read_b64_tr_b16 v[224:225], v249 offset:17920
    ds_read_b64_tr_b16 v[226:227], v249 offset:18560
    v_fmac_f32 v242, v206, v206
    v_fmac_f32 v244, v210, v210
    v_fmac_f32 v238, v199, v199
    v_fmac_f32 v241, v203, v203
    s_waitcnt lgkmcnt(6)
    v_mfma_f32_32x32x16_bf16 v[180:195], v[212:215], v[20:23], v[180:195]
    ds_read_b64_tr_b16 v[228:229], v250 offset:0
    ds_read_b64_tr_b16 v[230:231], v250 offset:640
    v_fmac_f32 v242, v207, v207
    v_fmac_f32 v244, v211, v211
    v_cvt_pk_bf16_f32 v196, v196, v197
    s_waitcnt lgkmcnt(6)
    v_mfma_f32_32x32x16_bf16 v[180:195], v[216:219], v[24:27], v[180:195]
    ds_read_b64_tr_b16 v[232:233], v250 offset:2560
    ds_read_b64_tr_b16 v[234:235], v250 offset:3200
    v_cvt_pk_bf16_f32 v197, v198, v199
    v_cvt_pk_bf16_f32 v198, v200, v201
    v_cvt_pk_bf16_f32 v199, v202, v203
    v_cvt_pk_bf16_f32 v200, v204, v205
    s_waitcnt lgkmcnt(6)
    v_mfma_f32_32x32x16_bf16 v[180:195], v[220:223], v[28:31], v[180:195]
    ds_read_b64_tr_b16 v[212:213], v250 offset:5120
    ds_read_b64_tr_b16 v[214:215], v250 offset:5760
    v_cvt_pk_bf16_f32 v201, v206, v207
    v_cvt_pk_bf16_f32 v202, v208, v209
    v_cvt_pk_bf16_f32 v203, v210, v211
    s_waitcnt lgkmcnt(6)
    v_mfma_f32_32x32x16_bf16 v[180:195], v[224:227], v[32:35], v[180:195]
    ds_read_b64_tr_b16 v[216:217], v250 offset:7680
    ds_read_b64_tr_b16 v[218:219], v250 offset:8320
    buffer_store_dwordx2 v[196:197], v252, s[4:7], s31 offen sc1
    buffer_store_dwordx2 v[198:199], v252, s[4:7], s33 offen sc1
    s_mov_b64 exec, s[36:37]
    buffer_store_dwordx2 v[200:201], v252, s[4:7], s35 offen sc1
    s_mov_b64 exec, -1
    v_permlane32_swap_b32 v200, v202
    v_permlane32_swap_b32 v201, v203
    s_mov_b64 exec, s[38:39]
    buffer_store_dwordx4 v[200:203], v251, s[4:7], s35 offen sc1
    s_mov_b64 exec, -1
    s_nop 0
    s_waitcnt lgkmcnt(6)
    v_mfma_f32_32x32x16_bf16 v[196:211], v[228:231], v[4:7], 0
    ds_read_b64_tr_b16 v[220:221], v250 offset:10240
    ds_read_b64_tr_b16 v[222:223], v250 offset:10880
    v_add_f32 v244, v244, v242
    v_mov_b32 v245, v244
    s_nop 1
    v_permlane32_swap_b32 v236, v237
    v_permlane32_swap_b32 v239, v240
    v_permlane32_swap_b32 v244, v245
    s_nop 1
    v_add_f32 v236, v236, v237
    s_waitcnt lgkmcnt(6)
    v_mfma_f32_32x32x16_bf16 v[196:211], v[232:235], v[8:11], v[196:211]
    ds_read_b64_tr_b16 v[224:225], v250 offset:12800
    ds_read_b64_tr_b16 v[226:227], v250 offset:13440
    v_add_f32 v236, v236, v238
    v_add_f32 v239, v239, v240
    v_add_f32 v239, v239, v241
    v_add_f32 v244, v244, v245
    s_nop 0
    v_max_f32_dpp v236, v236, v236 quad_perm:[1,0,3,2] row_mask:0xf bank_mask:0xf
    v_max_f32_dpp v239, v239, v239 quad_perm:[1,0,3,2] row_mask:0xf bank_mask:0xf
    v_max_f32_dpp v242, v242, v242 quad_perm:[1,0,3,2] row_mask:0xf bank_mask:0xf
    s_waitcnt lgkmcnt(6)
    v_mfma_f32_32x32x16_bf16 v[196:211], v[212:215], v[12:15], v[196:211]
    ds_read_b64_tr_b16 v[228:229], v250 offset:15360
    ds_read_b64_tr_b16 v[230:231], v250 offset:16000
    v_max_f32_dpp v244, v244, v244 quad_perm:[1,0,3,2] row_mask:0xf bank_mask:0xf
    v_max_f32_dpp v236, v236, v236 quad_perm:[2,3,0,1] row_mask:0xf bank_mask:0xf
    v_max_f32_dpp v239, v239, v239 quad_perm:[2,3,0,1] row_mask:0xf bank_mask:0xf
    v_max_f32_dpp v242, v242, v242 quad_perm:[2,3,0,1] row_mask:0xf bank_mask:0xf
    v_max_f32_dpp v244, v244, v244 quad_perm:[2,3,0,1] row_mask:0xf bank_mask:0xf
    v_max_f32_dpp v236, v236, v236 row_half_mirror row_mask:0xf bank_mask:0xf
    v_max_f32_dpp v239, v239, v239 row_half_mirror row_mask:0xf bank_mask:0xf
    v_max_f32_dpp v242, v242, v242 row_half_mirror row_mask:0xf bank_mask:0xf
    s_waitcnt lgkmcnt(6)
    v_mfma_f32_32x32x16_bf16 v[196:211], v[216:219], v[16:19], v[196:211]
    ds_read_b64_tr_b16 v[232:233], v250 offset:17920
    ds_read_b64_tr_b16 v[234:235], v250 offset:18560
    v_max_f32_dpp v244, v244, v244 row_half_mirror row_mask:0xf bank_mask:0xf
    v_max_f32_dpp v236, v236, v236 row_mirror row_mask:0xf bank_mask:0xf
    v_max_f32_dpp v239, v239, v239 row_mirror row_mask:0xf bank_mask:0xf
    v_max_f32_dpp v242, v242, v242 row_mirror row_mask:0xf bank_mask:0xf
    v_max_f32_dpp v244, v244, v244 row_mirror row_mask:0xf bank_mask:0xf
    v_mov_b32 v237, v236
    v_mov_b32 v240, v239
    v_mov_b32 v243, v242
    v_mov_b32 v245, v244
    s_waitcnt lgkmcnt(6)
    v_mfma_f32_32x32x16_bf16 v[196:211], v[220:223], v[20:23], v[196:211]
    s_nop 1
    v_permlane16_swap_b32 v236, v237
    v_permlane16_swap_b32 v239, v240
    v_permlane16_swap_b32 v242, v243
    v_permlane16_swap_b32 v244, v245
    s_nop 1
    v_max_f32 v236, v236, v237
    v_max_f32 v239, v239, v240
    s_barrier
    v_add_u32 v248, 29696, v248
    v_add_u32 v249, 29696, v249
    v_add_u32 v250, 29696, v250
    s_waitcnt lgkmcnt(4)
    v_mfma_f32_32x32x16_bf16 v[196:211], v[224:227], v[24:27], v[196:211]
    v_max_f32 v242, v242, v243
    v_max_f32 v244, v244, v245
    s_mov_b32 s36, 1
    s_mov_b32 s37, 1
    s_mov_b64 exec, s[36:37]
    buffer_store_dword v236, v254, s[4:7], s30 offen offset:0 sc1
    buffer_store_dword v239, v254, s[4:7], s30 offen offset:512 sc1
    s_and_b32 s38, s38, 1
    s_mov_b32 s39, 0
    s_mov_b64 exec, s[38:39]
    buffer_store_dword v244, v254, s[4:7], s26 offen sc1
    s_mov_b32 s38, s29
    s_mov_b64 exec, s[38:39]
    buffer_store_dword v242, v254, s[4:7], s27 offen sc1
    s_mov_b64 exec, -1
    ds_read_b64_tr_b16 v[212:213], v248 offset:2560
    ds_read_b64_tr_b16 v[214:215], v248 offset:3200
    ds_read_b64_tr_b16 v[216:217], v249 offset:2560
    ds_read_b64_tr_b16 v[218:219], v249 offset:3200
    ds_read_b64_tr_b16 v[220:221], v250 offset:2560
    ds_read_b64_tr_b16 v[222:223], v250 offset:3200
    s_waitcnt lgkmcnt(8)
    v_mfma_f32_32x32x16_bf16 v[196:211], v[228:231], v[28:31], v[196:211]
    s_waitcnt lgkmcnt(6)
    v_mfma_f32_32x32x16_bf16 v[196:211], v[232:235], v[32:35], v[196:211]
    ds_read_b64_tr_b16 v[236:237], v248 offset:0
    ds_read_b64_tr_b16 v[238:239], v248 offset:640
    ds_read_b64_tr_b16 v[240:241], v249 offset:0
    ds_read_b64_tr_b16 v[242:243], v249 offset:640
    ds_read_b64_tr_b16 v[244:245], v250 offset:0
    ds_read_b64_tr_b16 v[246:247], v250 offset:640
    s_branch L_mk_p2
L_mk_V:
    s_lshl_b32 s33, s47, 2
    s_sub_u32 s33, s33, 16
    s_cmp_eq_u32 s10, 9
    s_cselect_b32 s38, 0x000f0000, 0
    s_cmp_eq_u32 s10, 8
    s_cselect_b32 s38, 0xffff0000, s38
    s_mov_b32 s39, s38
    v_and_b32 v4, 31, v0
    v_bfe_u32 v5, v0, 5, 1
    v_bfe_u32 v6, v0, 1, 3
    v_xor_b32 v6, v6, v5
    v_lshlrev_b32 v7, 7, v4
    s_lshl_b32 s25, s8, 12
    v_add_u32 v8, s25, v7
    v_xor_b32 v9, 0, v6
    v_lshl_add_u32 v236, v9, 4, v8
    v_xor_b32 v9, 2, v6
    v_lshl_add_u32 v237, v9, 4, v8
    v_xor_b32 v9, 4, v6
    v_lshl_add_u32 v238, v9, 4, v8
    v_xor_b32 v9, 6, v6
    v_lshl_add_u32 v239, v9, 4, v8
    v_bfe_u32 v7, v0, 2, 2
    v_lshl_add_u32 v7, v5, 3, v7
    v_and_b32 v8, 3, v0
    v_bfe_u32 v9, v0, 4, 1
    v_mul_u32_u24 v10, 160, v7
    v_add_u32 v10, 16384, v10
    v_lshl_add_u32 v11, v9, 2, v8
    v_lshl_add_u32 v248, v11, 3, v10
    v_add_u32 v249, 64, v248
    v_add_u32 v11, 16, v8
    v_lshl_add_u32 v11, v11, 3, v10
    v_add_u32 v12, s47, v8
    v_mul_u32_u24 v13, 40, v7
    v_lshl_add_u32 v12, v12, 3, v13
    v_add_u32 v12, 26624, v12
    v_cmp_eq_u32 vcc, 1, v9
    v_mov_b32 v13, 160
    v_mov_b32 v14, 40
    v_cndmask_b32 v11, v11, v12, vcc
    v_cndmask_b32 v13, v13, v14, vcc
    v_mad_u32_u24 v240, v13, 0, v11
    v_mad_u32_u24 v241, v13, 4, v11
    v_mad_u32_u24 v242, v13, 16, v11
    v_mad_u32_u24 v243, v13, 20, v11
    v_mad_u32_u24 v244, v13, 32, v11
    v_mad_u32_u24 v245, v13, 36, v11
    v_mad_u32_u24 v246, v13, 48, v11
    v_mad_u32_u24 v247, v13, 52, v11
    v_mov_b32 v164, 0
    v_mov_b32 v165, 0
    v_mov_b32 v166, 0
    v_mov_b32 v167, 0
    v_mov_b32 v168, 0
    v_mov_b32 v169, 0
    v_mov_b32 v170, 0
    v_mov_b32 v171, 0
    v_mov_b32 v172, 0
    v_mov_b32 v173, 0
    v_mov_b32 v174, 0
    v_mov_b32 v175, 0
    v_mov_b32 v176, 0
    v_mov_b32 v177, 0
    v_mov_b32 v178, 0
    v_mov_b32 v179, 0
    v_mov_b32 v180, 0
    v_mov_b32 v181, 0
    v_mov_b32 v182, 0
    v_mov_b32 v183, 0
    v_mov_b32 v184, 0
    v_mov_b32 v185, 0
    v_mov_b32 v186, 0
    v_mov_b32 v187, 0
    v_mov_b32 v188, 0
    v_mov_b32 v189, 0
    v_mov_b32 v190, 0
    v_mov_b32 v191, 0
    v_mov_b32 v192, 0
    v_mov_b32 v193, 0
    v_mov_b32 v194, 0
    v_mov_b32 v195, 0
    v_mov_b32 v196, 0
    v_mov_b32 v197, 0
    v_mov_b32 v198, 0
    v_mov_b32 v199, 0
    v_mov_b32 v200, 0
    v_mov_b32 v201, 0
    v_mov_b32 v202, 0
    v_mov_b32 v203, 0
    v_mov_b32 v204, 0
    v_mov_b32 v205, 0
    v_mov_b32 v206, 0
    v_mov_b32 v207, 0
    v_mov_b32 v208, 0
    v_mov_b32 v209, 0
    v_mov_b32 v210, 0
    v_mov_b32 v211, 0
    s_load_dwordx2 s[40:41], s[0:1], 32
    s_load_dwordx2 s[42:43], s[0:1], 56
    s_and_b32 s48, s53, 1
    s_bfe_u32 s49, s53, 0x10001
    s_lshr_b32 s50, s53, 2
    s_and_b32 s51, s58, 3
    s_lshr_b32 s28, s58, 3
    s_lshl_b32 s28, s28, 2
    s_add_u32 s51, s51, s28
    s_mov_b32 s99, s51
    s_add_u32 s98, s99, s48
    s_mul_i32 s51, s51, 160
    s_mul_i32 s44, s48, 20480
    s_mul_i32 s28, s49, 10240
    s_add_u32 s44, s44, s28
    s_mul_i32 s28, s50, 5120
    s_add_u32 s44, s44, s28
    s_lshl_b32 s28, s48, 1
    s_add_u32 s28, s28, s50
    s_mul_i32 s45, s50, 51200
    s_add_u32 s45, s45, s51
    s_mul_i32 s46, s28, 204800
    s_add_u32 s46, s46, s51
    s_waitcnt lgkmcnt(0)
    s_cmp_eq_u32 s48, 0
    s_cselect_b32 s100, s40, s42
    s_cselect_b32 s101, s41, s43
    s_cmp_eq_u32 s49, 0
    s_cselect_b32 s40, s40, s42
    s_cselect_b32 s41, s41, s43
    s_and_b32 s41, s41, 0xffff
    s_mov_b32 s42, 819200
    s_mov_b32 s43, 0x20000
    s_lshl_b32 s28, s52, 3
    s_add_u32 s28, s28, s53
    s_lshr_b32 s25, s28, 1
    s_mul_i32 s47, s25, 6400
    s_add_u32 s52, s47, 6272
    s_barrier
    ds_read_b128 v[4:7], v236
    ds_read_b64_tr_b16 v[212:213], v248 offset:0
    ds_read_b64_tr_b16 v[214:215], v248 offset:640
    ds_read_b64_tr_b16 v[216:217], v249 offset:0
    ds_read_b64_tr_b16 v[218:219], v249 offset:640
    ds_read_b64_tr_b16 v[220:221], v240
    ds_read_b64_tr_b16 v[222:223], v241
    ds_read_b128 v[8:11], v237
    ds_read_b64_tr_b16 v[224:225], v248 offset:2560
    ds_read_b64_tr_b16 v[226:227], v248 offset:3200
    ds_read_b64_tr_b16 v[228:229], v249 offset:2560
    ds_read_b64_tr_b16 v[230:231], v249 offset:3200
    ds_read_b64_tr_b16 v[232:233], v242
    ds_read_b64_tr_b16 v[234:235], v243
    s_waitcnt lgkmcnt(7)
    v_mfma_f32_32x32x16_bf16 v[164:179], v[4:7], v[212:215], v[164:179]
    ds_read_b128 v[12:15], v238
    ds_read_b64_tr_b16 v[152:153], v248 offset:5120
    ds_read_b64_tr_b16 v[154:155], v248 offset:5760
    ds_read_b64_tr_b16 v[156:157], v249 offset:5120
    v_mfma_f32_32x32x16_bf16 v[180:195], v[4:7], v[216:219], v[180:195]
    ds_read_b64_tr_b16 v[158:159], v249 offset:5760
    ds_read_b64_tr_b16 v[160:161], v244
    ds_read_b64_tr_b16 v[162:163], v245
    v_mfma_f32_32x32x16_bf16 v[196:211], v[4:7], v[220:223], v[196:211]
    s_waitcnt lgkmcnt(7)
    v_mfma_f32_32x32x16_bf16 v[164:179], v[8:11], v[224:227], v[164:179]
    ds_read_b128 v[16:19], v239
    ds_read_b64_tr_b16 v[212:213], v248 offset:7680
    ds_read_b64_tr_b16 v[214:215], v248 offset:8320
    ds_read_b64_tr_b16 v[216:217], v249 offset:7680
    v_mfma_f32_32x32x16_bf16 v[180:195], v[8:11], v[228:231], v[180:195]
    ds_read_b64_tr_b16 v[218:219], v249 offset:8320
    ds_read_b64_tr_b16 v[220:221], v246
    ds_read_b64_tr_b16 v[222:223], v247
    v_mfma_f32_32x32x16_bf16 v[196:211], v[8:11], v[232:235], v[196:211]
    s_waitcnt lgkmcnt(7)
    v_mfma_f32_32x32x16_bf16 v[164:179], v[12:15], v[152:155], v[164:179]
    s_barrier
    v_add_u32 v236, 29696, v236
    v_add_u32 v237, 29696, v237
    v_add_u32 v238, 29696, v238
    v_add_u32 v239, 29696, v239
    v_add_u32 v248, 29696, v248
    v_add_u32 v249, 29696, v249
    v_add_u32 v240, 29696, v240
    v_add_u32 v241, 29696, v241
    v_add_u32 v242, 29696, v242
    v_add_u32 v243, 29696, v243
    v_add_u32 v244, 29696, v244
    v_add_u32 v245, 29696, v245
    v_add_u32 v246, 29696, v246
    v_add_u32 v247, 29696, v247
    ds_read_b128 v[20:23], v236
    ds_read_b64_tr_b16 v[224:225], v248 offset:0
    ds_read_b64_tr_b16 v[226:227], v248 offset:640
    ds_read_b64_tr_b16 v[228:229], v249 offset:0
    v_mfma_f32_32x32x16_bf16 v[180:195], v[12:15], v[156:159], v[180:195]
    ds_read_b64_tr_b16 v[230:231], v249 offset:640
    ds_read_b64_tr_b16 v[232:233], v240
    ds_read_b64_tr_b16 v[234:235], v241
    v_mfma_f32_32x32x16_bf16 v[196:211], v[12:15], v[160:163], v[196:211]
    s_waitcnt lgkmcnt(7)
    v_mfma_f32_32x32x16_bf16 v[164:179], v[16:19], v[212:215], v[164:179]
    ds_read_b128 v[24:27], v237
    ds_read_b64_tr_b16 v[152:153], v248 offset:2560
    ds_read_b64_tr_b16 v[154:155], v248 offset:3200
    ds_read_b64_tr_b16 v[156:157], v249 offset:2560
    v_mfma_f32_32x32x16_bf16 v[180:195], v[16:19], v[216:219], v[180:195]
    ds_read_b64_tr_b16 v[158:159], v249 offset:3200
    ds_read_b64_tr_b16 v[160:161], v242
    ds_read_b64_tr_b16 v[162:163], v243
    v_mfma_f32_32x32x16_bf16 v[196:211], v[16:19], v[220:223], v[196:211]
    s_waitcnt lgkmcnt(7)
    v_mfma_f32_32x32x16_bf16 v[164:179], v[20:23], v[224:227], v[164:179]
    ds_read_b128 v[28:31], v238
    ds_read_b64_tr_b16 v[212:213], v248 offset:5120
    ds_read_b64_tr_b16 v[214:215], v248 offset:5760
    ds_read_b64_tr_b16 v[216:217], v249 offset:5120
    v_mfma_f32_32x32x16_bf16 v[180:195], v[20:23], v[228:231], v[180:195]
    ds_read_b64_tr_b16 v[218:219], v249 offset:5760
    ds_read_b64_tr_b16 v[220:221], v244
    ds_read_b64_tr_b16 v[222:223], v245
    v_mfma_f32_32x32x16_bf16 v[196:211], v[20:23], v[232:235], v[196:211]
    s_waitcnt lgkmcnt(7)
    v_mfma_f32_32x32x16_bf16 v[164:179], v[24:27], v[152:155], v[164:179]
    ds_read_b128 v[32:35], v239
    ds_read_b64_tr_b16 v[224:225], v248 offset:7680
    ds_read_b64_tr_b16 v[226:227], v248 offset:8320
    ds_read_b64_tr_b16 v[228:229], v249 offset:7680
    v_mfma_f32_32x32x16_bf16 v[180:195], v[24:27], v[156:159], v[180:195]
    ds_read_b64_tr_b16 v[230:231], v249 offset:8320
    ds_read_b64_tr_b16 v[232:233], v246
    ds_read_b64_tr_b16 v[234:235], v247
    v_mfma_f32_32x32x16_bf16 v[196:211], v[24:27], v[160:163], v[196:211]
    s_waitcnt lgkmcnt(7)
    v_mfma_f32_32x32x16_bf16 v[164:179], v[28:31], v[212:215], v[164:179]
    s_barrier
    v_add_u32 v236, 29696, v236
    v_add_u32 v237, 29696, v237
    v_add_u32 v238, 29696, v238
    v_add_u32 v239, 29696, v239
    v_add_u32 v248, 29696, v248
    v_add_u32 v249, 29696, v249
    v_add_u32 v240, 29696, v240
    v_add_u32 v241, 29696, v241
    v_add_u32 v242, 29696, v242
    v_add_u32 v243, 29696, v243
    v_add_u32 v244, 29696, v244
    v_add_u32 v245, 29696, v245
    v_add_u32 v246, 29696, v246
    v_add_u32 v247, 29696, v247
    ds_read_b128 v[36:39], v236
    ds_read_b64_tr_b16 v[152:153], v248 offset:0
    ds_read_b64_tr_b16 v[154:155], v248 offset:640
    ds_read_b64_tr_b16 v[156:157], v249 offset:0
    v_mfma_f32_32x32x16_bf16 v[180:195], v[28:31], v[216:219], v[180:195]
    ds_read_b64_tr_b16 v[158:159], v249 offset:640
    ds_read_b64_tr_b16 v[160:161], v240
    ds_read_b64_tr_b16 v[162:163], v241
    v_mfma_f32_32x32x16_bf16 v[196:211], v[28:31], v[220:223], v[196:211]
    s_waitcnt lgkmcnt(7)
    v_mfma_f32_32x32x16_bf16 v[164:179], v[32:35], v[224:227], v[164:179]
    ds_read_b128 v[40:43], v237
    ds_read_b64_tr_b16 v[212:213], v248 offset:2560
    ds_read_b64_tr_b16 v[214:215], v248 offset:3200
    ds_read_b64_tr_b16 v[216:217], v249 offset:2560
    v_mfma_f32_32x32x16_bf16 v[180:195], v[32:35], v[228:231], v[180:195]
    ds_read_b64_tr_b16 v[218:219], v249 offset:3200
    ds_read_b64_tr_b16 v[220:221], v242
    ds_read_b64_tr_b16 v[222:223], v243
    v_mfma_f32_32x32x16_bf16 v[196:211], v[32:35], v[232:235], v[196:211]
    s_waitcnt lgkmcnt(7)
    v_mfma_f32_32x32x16_bf16 v[164:179], v[36:39], v[152:155], v[164:179]
    ds_read_b128 v[44:47], v238
    ds_read_b64_tr_b16 v[224:225], v248 offset:5120
    ds_read_b64_tr_b16 v[226:227], v248 offset:5760
    ds_read_b64_tr_b16 v[228:229], v249 offset:5120
    v_mfma_f32_32x32x16_bf16 v[180:195], v[36:39], v[156:159], v[180:195]
    ds_read_b64_tr_b16 v[230:231], v249 offset:5760
    ds_read_b64_tr_b16 v[232:233], v244
    ds_read_b64_tr_b16 v[234:235], v245
    v_mfma_f32_32x32x16_bf16 v[196:211], v[36:39], v[160:163], v[196:211]
    s_waitcnt lgkmcnt(7)
    v_mfma_f32_32x32x16_bf16 v[164:179], v[40:43], v[212:215], v[164:179]
    ds_read_b128 v[48:51], v239
    ds_read_b64_tr_b16 v[152:153], v248 offset:7680
    ds_read_b64_tr_b16 v[154:155], v248 offset:8320
    ds_read_b64_tr_b16 v[156:157], v249 offset:7680
    v_mfma_f32_32x32x16_bf16 v[180:195], v[40:43], v[216:219], v[180:195]
    ds_read_b64_tr_b16 v[158:159], v249 offset:8320
    ds_read_b64_tr_b16 v[160:161], v246
    ds_read_b64_tr_b16 v[162:163], v247
    v_mfma_f32_32x32x16_bf16 v[196:211], v[40:43], v[220:223], v[196:211]
    s_waitcnt lgkmcnt(7)
    v_mfma_f32_32x32x16_bf16 v[164:179], v[44:47], v[224:227], v[164:179]
    s_barrier
    v_add_u32 v236, 29696, v236
    v_add_u32 v237, 29696, v237
    v_add_u32 v238, 29696, v238
    v_add_u32 v239, 29696, v239
    v_add_u32 v248, 29696, v248
    v_add_u32 v249, 29696, v249
    v_add_u32 v240, 29696, v240
    v_add_u32 v241, 29696, v241
    v_add_u32 v242, 29696, v242
    v_add_u32 v243, 29696, v243
    v_add_u32 v244, 29696, v244
    v_add_u32 v245, 29696, v245
    v_add_u32 v246, 29696, v246
    v_add_u32 v247, 29696, v247
    ds_read_b128 v[52:55], v236
    ds_read_b64_tr_b16 v[212:213], v248 offset:0
    ds_read_b64_tr_b16 v[214:215], v248 offset:640
    ds_read_b64_tr_b16 v[216:217], v249 offset:0
    v_mfma_f32_32x32x16_bf16 v[180:195], v[44:47], v[228:231], v[180:195]
    ds_read_b64_tr_b16 v[218:219], v249 offset:640
    ds_read_b64_tr_b16 v[220:221], v240
    ds_read_b64_tr_b16 v[222:223], v241
    v_mfma_f32_32x32x16_bf16 v[196:211], v[44:47], v[232:235], v[196:211]
    s_waitcnt lgkmcnt(7)
    v_mfma_f32_32x32x16_bf16 v[164:179], v[48:51], v[152:155], v[164:179]
    ds_read_b128 v[56:59], v237
    ds_read_b64_tr_b16 v[224:225], v248 offset:2560
    ds_read_b64_tr_b16 v[226:227], v248 offset:3200
    ds_read_b64_tr_b16 v[228:229], v249 offset:2560
    v_mfma_f32_32x32x16_bf16 v[180:195], v[48:51], v[156:159], v[180:195]
    ds_read_b64_tr_b16 v[230:231], v249 offset:3200
    ds_read_b64_tr_b16 v[232:233], v242
    ds_read_b64_tr_b16 v[234:235], v243
    v_mfma_f32_32x32x16_bf16 v[196:211], v[48:51], v[160:163], v[196:211]
    s_waitcnt lgkmcnt(7)
    v_mfma_f32_32x32x16_bf16 v[164:179], v[52:55], v[212:215], v[164:179]
    ds_read_b128 v[60:63], v238
    ds_read_b64_tr_b16 v[152:153], v248 offset:5120
    ds_read_b64_tr_b16 v[154:155], v248 offset:5760
    ds_read_b64_tr_b16 v[156:157], v249 offset:5120
    v_mfma_f32_32x32x16_bf16 v[180:195], v[52:55], v[216:219], v[180:195]
    ds_read_b64_tr_b16 v[158:159], v249 offset:5760
    ds_read_b64_tr_b16 v[160:161], v244
    ds_read_b64_tr_b16 v[162:163], v245
    v_mfma_f32_32x32x16_bf16 v[196:211], v[52:55], v[220:223], v[196:211]
    s_waitcnt lgkmcnt(7)
    v_mfma_f32_32x32x16_bf16 v[164:179], v[56:59], v[224:227], v[164:179]
    ds_read_b128 v[64:67], v239
    ds_read_b64_tr_b16 v[212:213], v248 offset:7680
    ds_read_b64_tr_b16 v[214:215], v248 offset:8320
    ds_read_b64_tr_b16 v[216:217], v249 offset:7680
    v_mfma_f32_32x32x16_bf16 v[180:195], v[56:59], v[228:231], v[180:195]
    ds_read_b64_tr_b16 v[218:219], v249 offset:8320
    ds_read_b64_tr_b16 v[220:221], v246
    ds_read_b64_tr_b16 v[222:223], v247
    v_mfma_f32_32x32x16_bf16 v[196:211], v[56:59], v[232:235], v[196:211]
    s_waitcnt lgkmcnt(7)
    v_mfma_f32_32x32x16_bf16 v[164:179], v[60:63], v[152:155], v[164:179]
    s_barrier
    v_add_u32 v236, 29696, v236
    v_add_u32 v237, 29696, v237
    v_add_u32 v238, 29696, v238
    v_add_u32 v239, 29696, v239
    v_add_u32 v248, 29696, v248
    v_add_u32 v249, 29696, v249
    v_add_u32 v240, 29696, v240
    v_add_u32 v241, 29696, v241
    v_add_u32 v242, 29696, v242
    v_add_u32 v243, 29696, v243
    v_add_u32 v244, 29696, v244
    v_add_u32 v245, 29696, v245
    v_add_u32 v246, 29696, v246
    v_add_u32 v247, 29696, v247
    ds_read_b128 v[68:71], v236
    ds_read_b64_tr_b16 v[224:225], v248 offset:0
    ds_read_b64_tr_b16 v[226:227], v248 offset:640
    ds_read_b64_tr_b16 v[228:229], v249 offset:0
    v_mfma_f32_32x32x16_bf16 v[180:195], v[60:63], v[156:159], v[180:195]
    ds_read_b64_tr_b16 v[230:231], v249 offset:640
    ds_read_b64_tr_b16 v[232:233], v240
    ds_read_b64_tr_b16 v[234:235], v241
    v_mfma_f32_32x32x16_bf16 v[196:211], v[60:63], v[160:163], v[196:211]
    s_waitcnt lgkmcnt(7)
    v_mfma_f32_32x32x16_bf16 v[164:179], v[64:67], v[212:215], v[164:179]
    ds_read_b128 v[72:75], v237
    ds_read_b64_tr_b16 v[152:153], v248 offset:2560
    ds_read_b64_tr_b16 v[154:155], v248 offset:3200
    ds_read_b64_tr_b16 v[156:157], v249 offset:2560
    v_mfma_f32_32x32x16_bf16 v[180:195], v[64:67], v[216:219], v[180:195]
    ds_read_b64_tr_b16 v[158:159], v249 offset:3200
    ds_read_b64_tr_b16 v[160:161], v242
    ds_read_b64_tr_b16 v[162:163], v243
    v_mfma_f32_32x32x16_bf16 v[196:211], v[64:67], v[220:223], v[196:211]
    s_waitcnt lgkmcnt(7)
    v_mfma_f32_32x32x16_bf16 v[164:179], v[68:71], v[224:227], v[164:179]
    ds_read_b128 v[76:79], v238
    ds_read_b64_tr_b16 v[212:213], v248 offset:5120
    ds_read_b64_tr_b16 v[214:215], v248 offset:5760
    ds_read_b64_tr_b16 v[216:217], v249 offset:5120
    v_mfma_f32_32x32x16_bf16 v[180:195], v[68:71], v[228:231], v[180:195]
    ds_read_b64_tr_b16 v[218:219], v249 offset:5760
    ds_read_b64_tr_b16 v[220:221], v244
    ds_read_b64_tr_b16 v[222:223], v245
    v_mfma_f32_32x32x16_bf16 v[196:211], v[68:71], v[232:235], v[196:211]
    s_waitcnt lgkmcnt(7)
    v_mfma_f32_32x32x16_bf16 v[164:179], v[72:75], v[152:155], v[164:179]
    ds_read_b128 v[80:83], v239
    ds_read_b64_tr_b16 v[224:225], v248 offset:7680
    ds_read_b64_tr_b16 v[226:227], v248 offset:8320
    ds_read_b64_tr_b16 v[228:229], v249 offset:7680
    v_mfma_f32_32x32x16_bf16 v[180:195], v[72:75], v[156:159], v[180:195]
    ds_read_b64_tr_b16 v[230:231], v249 offset:8320
    ds_read_b64_tr_b16 v[232:233], v246
    ds_read_b64_tr_b16 v[234:235], v247
    v_mfma_f32_32x32x16_bf16 v[196:211], v[72:75], v[160:163], v[196:211]
    s_waitcnt lgkmcnt(7)
    v_mfma_f32_32x32x16_bf16 v[164:179], v[76:79], v[212:215], v[164:179]
    s_barrier
    v_subrev_u32 v236, 118784, v236
    v_subrev_u32 v237, 118784, v237
    v_subrev_u32 v238, 118784, v238
    v_subrev_u32 v239, 118784, v239
    v_subrev_u32 v248, 118784, v248
    v_subrev_u32 v249, 118784, v249
    v_subrev_u32 v240, 118784, v240
    v_subrev_u32 v241, 118784, v241
    v_subrev_u32 v242, 118784, v242
    v_subrev_u32 v243, 118784, v243
    v_subrev_u32 v244, 118784, v244
    v_subrev_u32 v245, 118784, v245
    v_subrev_u32 v246, 118784, v246
    v_subrev_u32 v247, 118784, v247
    ds_read_b128 v[84:87], v236
    ds_read_b64_tr_b16 v[152:153], v248 offset:0
    ds_read_b64_tr_b16 v[154:155], v248 offset:640
    ds_read_b64_tr_b16 v[156:157], v249 offset:0
    v_mfma_f32_32x32x16_bf16 v[180:195], v[76:79], v[216:219], v[180:195]
    ds_read_b64_tr_b16 v[158:159], v249 offset:640
    ds_read_b64_tr_b16 v[160:161], v240
    ds_read_b64_tr_b16 v[162:163], v241
    v_mfma_f32_32x32x16_bf16 v[196:211], v[76:79], v[220:223], v[196:211]
    s_waitcnt lgkmcnt(7)
    v_mfma_f32_32x32x16_bf16 v[164:179], v[80:83], v[224:227], v[164:179]
    ds_read_b128 v[88:91], v237
    ds_read_b64_tr_b16 v[212:213], v248 offset:2560
    ds_read_b64_tr_b16 v[214:215], v248 offset:3200
    ds_read_b64_tr_b16 v[216:217], v249 offset:2560
    v_mfma_f32_32x32x16_bf16 v[180:195], v[80:83], v[228:231], v[180:195]
    ds_read_b64_tr_b16 v[218:219], v249 offset:3200
    ds_read_b64_tr_b16 v[220:221], v242
    ds_read_b64_tr_b16 v[222:223], v243
    v_mfma_f32_32x32x16_bf16 v[196:211], v[80:83], v[232:235], v[196:211]
    s_waitcnt lgkmcnt(7)
    v_mfma_f32_32x32x16_bf16 v[164:179], v[84:87], v[152:155], v[164:179]
    ds_read_b128 v[92:95], v238
    ds_read_b64_tr_b16 v[224:225], v248 offset:5120
    ds_read_b64_tr_b16 v[226:227], v248 offset:5760
    ds_read_b64_tr_b16 v[228:229], v249 offset:5120
    v_mfma_f32_32x32x16_bf16 v[180:195], v[84:87], v[156:159], v[180:195]
    ds_read_b64_tr_b16 v[230:231], v249 offset:5760
    ds_read_b64_tr_b16 v[232:233], v244
    ds_read_b64_tr_b16 v[234:235], v245
    v_mfma_f32_32x32x16_bf16 v[196:211], v[84:87], v[160:163], v[196:211]
    s_waitcnt lgkmcnt(7)
    v_mfma_f32_32x32x16_bf16 v[164:179], v[88:91], v[212:215], v[164:179]
    ds_read_b128 v[96:99], v239
    ds_read_b64_tr_b16 v[152:153], v248 offset:7680
    ds_read_b64_tr_b16 v[154:155], v248 offset:8320
    ds_read_b64_tr_b16 v[156:157], v249 offset:7680
    v_mfma_f32_32x32x16_bf16 v[180:195], v[88:91], v[216:219], v[180:195]
    ds_read_b64_tr_b16 v[158:159], v249 offset:8320
    ds_read_b64_tr_b16 v[160:161], v246
    ds_read_b64_tr_b16 v[162:163], v247
    v_mfma_f32_32x32x16_bf16 v[196:211], v[88:91], v[220:223], v[196:211]
    s_waitcnt lgkmcnt(7)
    v_mfma_f32_32x32x16_bf16 v[164:179], v[92:95], v[224:227], v[164:179]
    s_barrier
    v_add_u32 v236, 29696, v236
    v_add_u32 v237, 29696, v237
    v_add_u32 v238, 29696, v238
    v_add_u32 v239, 29696, v239
    v_add_u32 v248, 29696, v248
    v_add_u32 v249, 29696, v249
    v_add_u32 v240, 29696, v240
    v_add_u32 v241, 29696, v241
    v_add_u32 v242, 29696, v242
    v_add_u32 v243, 29696, v243
    v_add_u32 v244, 29696, v244
    v_add_u32 v245, 29696, v245
    v_add_u32 v246, 29696, v246
    v_add_u32 v247, 29696, v247
    ds_read_b128 v[100:103], v236
    ds_read_b64_tr_b16 v[212:213], v248 offset:0
    ds_read_b64_tr_b16 v[214:215], v248 offset:640
    ds_read_b64_tr_b16 v[216:217], v249 offset:0
    v_mfma_f32_32x32x16_bf16 v[180:195], v[92:95], v[228:231], v[180:195]
    ds_read_b64_tr_b16 v[218:219], v249 offset:640
    ds_read_b64_tr_b16 v[220:221], v240
    ds_read_b64_tr_b16 v[222:223], v241
    v_mfma_f32_32x32x16_bf16 v[196:211], v[92:95], v[232:235], v[196:211]
    s_waitcnt lgkmcnt(7)
    v_mfma_f32_32x32x16_bf16 v[164:179], v[96:99], v[152:155], v[164:179]
    ds_read_b128 v[104:107], v237
    ds_read_b64_tr_b16 v[224:225], v248 offset:2560
    ds_read_b64_tr_b16 v[226:227], v248 offset:3200
    ds_read_b64_tr_b16 v[228:229], v249 offset:2560
    v_mfma_f32_32x32x16_bf16 v[180:195], v[96:99], v[156:159], v[180:195]
    ds_read_b64_tr_b16 v[230:231], v249 offset:3200
    ds_read_b64_tr_b16 v[232:233], v242
    ds_read_b64_tr_b16 v[234:235], v243
    v_mfma_f32_32x32x16_bf16 v[196:211], v[96:99], v[160:163], v[196:211]
    s_waitcnt lgkmcnt(7)
    v_mfma_f32_32x32x16_bf16 v[164:179], v[100:103], v[212:215], v[164:179]
    ds_read_b128 v[108:111], v238
    ds_read_b64_tr_b16 v[152:153], v248 offset:5120
    ds_read_b64_tr_b16 v[154:155], v248 offset:5760
    ds_read_b64_tr_b16 v[156:157], v249 offset:5120
    v_mfma_f32_32x32x16_bf16 v[180:195], v[100:103], v[216:219], v[180:195]
    ds_read_b64_tr_b16 v[158:159], v249 offset:5760
    ds_read_b64_tr_b16 v[160:161], v244
    ds_read_b64_tr_b16 v[162:163], v245
    v_mfma_f32_32x32x16_bf16 v[196:211], v[100:103], v[220:223], v[196:211]
    s_waitcnt lgkmcnt(7)
    v_mfma_f32_32x32x16_bf16 v[164:179], v[104:107], v[224:227], v[164:179]
    ds_read_b128 v[112:115], v239
    ds_read_b64_tr_b16 v[212:213], v248 offset:7680
    ds_read_b64_tr_b16 v[214:215], v248 offset:8320
    ds_read_b64_tr_b16 v[216:217], v249 offset:7680
    v_mfma_f32_32x32x16_bf16 v[180:195], v[104:107], v[228:231], v[180:195]
    ds_read_b64_tr_b16 v[218:219], v249 offset:8320
    ds_read_b64_tr_b16 v[220:221], v246
    ds_read_b64_tr_b16 v[222:223], v247
    v_mfma_f32_32x32x16_bf16 v[196:211], v[104:107], v[232:235], v[196:211]
    s_waitcnt lgkmcnt(7)
    v_mfma_f32_32x32x16_bf16 v[164:179], v[108:111], v[152:155], v[164:179]
    s_barrier
    v_add_u32 v236, 29696, v236
    v_add_u32 v237, 29696, v237
    v_add_u32 v238, 29696, v238
    v_add_u32 v239, 29696, v239
    v_add_u32 v248, 29696, v248
    v_add_u32 v249, 29696, v249
    v_add_u32 v240, 29696, v240
    v_add_u32 v241, 29696, v241
    v_add_u32 v242, 29696, v242
    v_add_u32 v243, 29696, v243
    v_add_u32 v244, 29696, v244
    v_add_u32 v245, 29696, v245
    v_add_u32 v246, 29696, v246
    v_add_u32 v247, 29696, v247
    ds_read_b128 v[116:119], v236
    ds_read_b64_tr_b16 v[224:225], v248 offset:0
    ds_read_b64_tr_b16 v[226:227], v248 offset:640
    ds_read_b64_tr_b16 v[228:229], v249 offset:0
    v_mfma_f32_32x32x16_bf16 v[180:195], v[108:111], v[156:159], v[180:195]
    ds_read_b64_tr_b16 v[230:231], v249 offset:640
    ds_read_b64_tr_b16 v[232:233], v240
    ds_read_b64_tr_b16 v[234:235], v241
    v_mfma_f32_32x32x16_bf16 v[196:211], v[108:111], v[160:163], v[196:211]
    s_waitcnt lgkmcnt(7)
    v_mfma_f32_32x32x16_bf16 v[164:179], v[112:115], v[212:215], v[164:179]
    ds_read_b128 v[120:123], v237
    ds_read_b64_tr_b16 v[152:153], v248 offset:2560
    ds_read_b64_tr_b16 v[154:155], v248 offset:3200
    ds_read_b64_tr_b16 v[156:157], v249 offset:2560
    v_mfma_f32_32x32x16_bf16 v[180:195], v[112:115], v[216:219], v[180:195]
    ds_read_b64_tr_b16 v[158:159], v249 offset:3200
    ds_read_b64_tr_b16 v[160:161], v242
    ds_read_b64_tr_b16 v[162:163], v243
    v_mfma_f32_32x32x16_bf16 v[196:211], v[112:115], v[220:223], v[196:211]
    s_waitcnt lgkmcnt(7)
    v_mfma_f32_32x32x16_bf16 v[164:179], v[116:119], v[224:227], v[164:179]
    ds_read_b128 v[124:127], v238
    ds_read_b64_tr_b16 v[212:213], v248 offset:5120
    ds_read_b64_tr_b16 v[214:215], v248 offset:5760
    ds_read_b64_tr_b16 v[216:217], v249 offset:5120
    v_mfma_f32_32x32x16_bf16 v[180:195], v[116:119], v[228:231], v[180:195]
    ds_read_b64_tr_b16 v[218:219], v249 offset:5760
    ds_read_b64_tr_b16 v[220:221], v244
    ds_read_b64_tr_b16 v[222:223], v245
    v_mfma_f32_32x32x16_bf16 v[196:211], v[116:119], v[232:235], v[196:211]
    s_waitcnt lgkmcnt(7)
    v_mfma_f32_32x32x16_bf16 v[164:179], v[120:123], v[152:155], v[164:179]
    ds_read_b128 v[128:131], v239
    ds_read_b64_tr_b16 v[224:225], v248 offset:7680
    ds_read_b64_tr_b16 v[226:227], v248 offset:8320
    ds_read_b64_tr_b16 v[228:229], v249 offset:7680
    v_mfma_f32_32x32x16_bf16 v[180:195], v[120:123], v[156:159], v[180:195]
    ds_read_b64_tr_b16 v[230:231], v249 offset:8320
    ds_read_b64_tr_b16 v[232:233], v246
    ds_read_b64_tr_b16 v[234:235], v247
    v_mfma_f32_32x32x16_bf16 v[196:211], v[120:123], v[160:163], v[196:211]
    s_waitcnt lgkmcnt(7)
    v_mfma_f32_32x32x16_bf16 v[164:179], v[124:127], v[212:215], v[164:179]
    s_barrier
    v_add_u32 v236, 29696, v236
    v_add_u32 v237, 29696, v237
    v_add_u32 v238, 29696, v238
    v_add_u32 v239, 29696, v239
    v_add_u32 v248, 29696, v248
    v_add_u32 v249, 29696, v249
    v_add_u32 v240, 29696, v240
    v_add_u32 v241, 29696, v241
    v_add_u32 v242, 29696, v242
    v_add_u32 v243, 29696, v243
    v_add_u32 v244, 29696, v244
    v_add_u32 v245, 29696, v245
    v_add_u32 v246, 29696, v246
    v_add_u32 v247, 29696, v247
    ds_read_b128 v[132:135], v236
    ds_read_b64_tr_b16 v[152:153], v248 offset:0
    ds_read_b64_tr_b16 v[154:155], v248 offset:640
    ds_read_b64_tr_b16 v[156:157], v249 offset:0
    v_mfma_f32_32x32x16_bf16 v[180:195], v[124:127], v[216:219], v[180:195]
    ds_read_b64_tr_b16 v[158:159], v249 offset:640
    ds_read_b64_tr_b16 v[160:161], v240
    ds_read_b64_tr_b16 v[162:163], v241
    v_mfma_f32_32x32x16_bf16 v[196:211], v[124:127], v[220:223], v[196:211]
    s_waitcnt lgkmcnt(7)
    v_mfma_f32_32x32x16_bf16 v[164:179], v[128:131], v[224:227], v[164:179]
    ds_read_b128 v[136:139], v237
    ds_read_b64_tr_b16 v[212:213], v248 offset:2560
    ds_read_b64_tr_b16 v[214:215], v248 offset:3200
    ds_read_b64_tr_b16 v[216:217], v249 offset:2560
    v_mfma_f32_32x32x16_bf16 v[180:195], v[128:131], v[228:231], v[180:195]
    ds_read_b64_tr_b16 v[218:219], v249 offset:3200
    ds_read_b64_tr_b16 v[220:221], v242
    ds_read_b64_tr_b16 v[222:223], v243
    v_mfma_f32_32x32x16_bf16 v[196:211], v[128:131], v[232:235], v[196:211]
    s_waitcnt lgkmcnt(7)
    v_mfma_f32_32x32x16_bf16 v[164:179], v[132:135], v[152:155], v[164:179]
    ds_read_b128 v[140:143], v238
    ds_read_b64_tr_b16 v[224:225], v248 offset:5120
    ds_read_b64_tr_b16 v[226:227], v248 offset:5760
    ds_read_b64_tr_b16 v[228:229], v249 offset:5120
    v_mfma_f32_32x32x16_bf16 v[180:195], v[132:135], v[156:159], v[180:195]
    ds_read_b64_tr_b16 v[230:231], v249 offset:5760
    ds_read_b64_tr_b16 v[232:233], v244
    ds_read_b64_tr_b16 v[234:235], v245
    v_mfma_f32_32x32x16_bf16 v[196:211], v[132:135], v[160:163], v[196:211]
    s_waitcnt lgkmcnt(7)
    v_mfma_f32_32x32x16_bf16 v[164:179], v[136:139], v[212:215], v[164:179]
    v_mfma_f32_32x32x16_bf16 v[180:195], v[136:139], v[216:219], v[180:195]
    v_mfma_f32_32x32x16_bf16 v[196:211], v[136:139], v[220:223], v[196:211]
    s_waitcnt lgkmcnt(0)
    v_mfma_f32_32x32x16_bf16 v[164:179], v[140:143], v[224:227], v[164:179]
    ds_read_b128 v[144:147], v239
    ds_read_b64_tr_b16 v[212:213], v248 offset:7680
    ds_read_b64_tr_b16 v[214:215], v248 offset:8320
    ds_read_b64_tr_b16 v[216:217], v249 offset:7680
    v_mfma_f32_32x32x16_bf16 v[180:195], v[140:143], v[228:231], v[180:195]
    ds_read_b64_tr_b16 v[218:219], v249 offset:8320
    ds_read_b64_tr_b16 v[220:221], v246
    ds_read_b64_tr_b16 v[222:223], v247
    v_mfma_f32_32x32x16_bf16 v[196:211], v[140:143], v[232:235], v[196:211]
    s_waitcnt lgkmcnt(0)
    v_mfma_f32_32x32x16_bf16 v[164:179], v[144:147], v[212:215], v[164:179]
    s_barrier
    v_add_u32 v236, 29696, v236
    v_add_u32 v237, 29696, v237
    v_add_u32 v238, 29696, v238
    v_add_u32 v239, 29696, v239
    v_add_u32 v248, 29696, v248
    v_add_u32 v249, 29696, v249
    v_add_u32 v240, 29696, v240
    v_add_u32 v241, 29696, v241
    v_add_u32 v242, 29696, v242
    v_add_u32 v243, 29696, v243
    v_add_u32 v244, 29696, v244
    v_add_u32 v245, 29696, v245
    v_add_u32 v246, 29696, v246
    v_add_u32 v247, 29696, v247
    ds_read_b128 v[148:151], v236
    ds_read_b64_tr_b16 v[224:225], v248 offset:0
    ds_read_b64_tr_b16 v[226:227], v248 offset:640
    ds_read_b64_tr_b16 v[228:229], v249 offset:0
    v_mfma_f32_32x32x16_bf16 v[180:195], v[144:147], v[216:219], v[180:195]
    ds_read_b64_tr_b16 v[230:231], v249 offset:640
    ds_read_b64_tr_b16 v[232:233], v240
    ds_read_b64_tr_b16 v[234:235], v241
    v_mfma_f32_32x32x16_bf16 v[196:211], v[144:147], v[220:223], v[196:211]
    s_waitcnt lgkmcnt(0)
    v_mfma_f32_32x32x16_bf16 v[164:179], v[148:151], v[224:227], v[164:179]
    ds_read_b128 v[152:155], v237
    ds_read_b64_tr_b16 v[212:213], v248 offset:2560
    ds_read_b64_tr_b16 v[214:215], v248 offset:3200
    ds_read_b64_tr_b16 v[216:217], v249 offset:2560
    v_mfma_f32_32x32x16_bf16 v[180:195], v[148:151], v[228:231], v[180:195]
    ds_read_b64_tr_b16 v[218:219], v249 offset:3200
    ds_read_b64_tr_b16 v[220:221], v242
    ds_read_b64_tr_b16 v[222:223], v243
    v_mfma_f32_32x32x16_bf16 v[196:211], v[148:151], v[232:235], v[196:211]
    s_waitcnt lgkmcnt(0)
    v_mfma_f32_32x32x16_bf16 v[164:179], v[152:155], v[212:215], v[164:179]
    ds_read_b128 v[156:159], v238
    ds_read_b64_tr_b16 v[224:225], v248 offset:5120
    ds_read_b64_tr_b16 v[226:227], v248 offset:5760
    ds_read_b64_tr_b16 v[228:229], v249 offset:5120
    v_mfma_f32_32x32x16_bf16 v[180:195], v[152:155], v[216:219], v[180:195]
    ds_read_b64_tr_b16 v[230:231], v249 offset:5760
    ds_read_b64_tr_b16 v[232:233], v244
    ds_read_b64_tr_b16 v[234:235], v245
    v_mfma_f32_32x32x16_bf16 v[196:211], v[152:155], v[220:223], v[196:211]
    s_waitcnt lgkmcnt(0)
    v_mfma_f32_32x32x16_bf16 v[164:179], v[156:159], v[224:227], v[164:179]
    ds_read_b128 v[160:163], v239
    ds_read_b64_tr_b16 v[212:213], v248 offset:7680
    ds_read_b64_tr_b16 v[214:215], v248 offset:8320
    ds_read_b64_tr_b16 v[216:217], v249 offset:7680
    v_mfma_f32_32x32x16_bf16 v[180:195], v[156:159], v[228:231], v[180:195]
    ds_read_b64_tr_b16 v[218:219], v249 offset:8320
    ds_read_b64_tr_b16 v[220:221], v246
    ds_read_b64_tr_b16 v[222:223], v247
    v_mfma_f32_32x32x16_bf16 v[196:211], v[156:159], v[232:235], v[196:211]
    s_waitcnt lgkmcnt(0)
    v_mfma_f32_32x32x16_bf16 v[164:179], v[160:163], v[212:215], v[164:179]
    s_barrier
    v_mfma_f32_32x32x16_bf16 v[180:195], v[160:163], v[216:219], v[180:195]
    v_mfma_f32_32x32x16_bf16 v[196:211], v[160:163], v[220:223], v[196:211]
    v_bfe_u32 v251, v0, 5, 1
    v_bfe_u32 v252, v0, 2, 2
    v_lshl_add_u32 v252, v251, 3, v252
    v_mul_u32_u24 v252, 160, v252
    v_and_b32 v253, 3, v0
    v_bfe_u32 v254, v0, 4, 1
    v_mul_u32_u24 v254, 5, v254
    v_add_u32 v254, v254, v253
    v_lshl_add_u32 v248, v254, 3, v252
    v_add_u32 v249, 80, v248
    v_mul_u32_u24 v253, 5, v253
    v_add_u32 v253, 4, v253
    v_lshl_add_u32 v250, v253, 3, v252
    ds_read_b64_tr_b16 v[212:213], v248 offset:0
    ds_read_b64_tr_b16 v[214:215], v248 offset:640
    ds_read_b64_tr_b16 v[216:217], v248 offset:2560
    ds_read_b64_tr_b16 v[218:219], v248 offset:3200
    ds_read_b64_tr_b16 v[220:221], v248 offset:5120
    ds_read_b64_tr_b16 v[222:223], v248 offset:5760
    ds_read_b64_tr_b16 v[224:225], v248 offset:7680
    ds_read_b64_tr_b16 v[226:227], v248 offset:8320
    v_and_b32 v251, 31, v0
    v_bfe_u32 v252, v0, 5, 1
    v_mul_u32_u24 v252, 320, v252
    s_mov_b32 s32, 163840
    v_add_u32 v253, 0, v251
    v_mul_u32_u24 v254, 3277, v253
    v_lshrrev_b32 v254, 16, v254
    v_mul_u32_u24 v236, 20, v254
    v_sub_u32 v253, v253, v236
    v_mul_lo_u32 v236, v254, s32
    v_lshl_add_u32 v236, v253, 4, v236
    v_add_u32 v236, v236, v252
    v_cvt_pk_bf16_f32 v164, v164, v165
    v_cvt_pk_bf16_f32 v165, v166, v167
    v_cvt_pk_bf16_f32 v166, v168, v169
    v_cvt_pk_bf16_f32 v167, v170, v171
    v_cvt_pk_bf16_f32 v168, v172, v173
    v_cvt_pk_bf16_f32 v169, v174, v175
    v_cvt_pk_bf16_f32 v170, v176, v177
    v_cvt_pk_bf16_f32 v171, v178, v179
    buffer_store_dwordx4 v[164:167], v236, s[4:7], s31 offen offset:1280 sc1
    buffer_store_dwordx4 v[168:171], v236, s[4:7], s31 offen offset:1920 sc1
    s_nop 0
    s_waitcnt lgkmcnt(6)
    v_mfma_f32_32x32x16_bf16 v[164:179], v[212:215], v[4:7], 0
    ds_read_b64_tr_b16 v[228:229], v248 offset:10240
    ds_read_b64_tr_b16 v[230:231], v248 offset:10880
    v_add_u32 v253, 32, v251
    v_mul_u32_u24 v254, 3277, v253
    s_waitcnt lgkmcnt(6)
    v_mfma_f32_32x32x16_bf16 v[164:179], v[216:219], v[8:11], v[164:179]
    ds_read_b64_tr_b16 v[232:233], v248 offset:12800
    ds_read_b64_tr_b16 v[234:235], v248 offset:13440
    v_lshrrev_b32 v254, 16, v254
    v_mul_u32_u24 v237, 20, v254
    s_waitcnt lgkmcnt(6)
    v_mfma_f32_32x32x16_bf16 v[164:179], v[220:223], v[12:15], v[164:179]
    ds_read_b64_tr_b16 v[212:213], v248 offset:15360
    ds_read_b64_tr_b16 v[214:215], v248 offset:16000
    v_sub_u32 v253, v253, v237
    v_mul_lo_u32 v237, v254, s32
    s_waitcnt lgkmcnt(6)
    v_mfma_f32_32x32x16_bf16 v[164:179], v[224:227], v[16:19], v[164:179]
    ds_read_b64_tr_b16 v[216:217], v248 offset:17920
    ds_read_b64_tr_b16 v[218:219], v248 offset:18560
    v_lshl_add_u32 v237, v253, 4, v237
    v_add_u32 v237, v237, v252
    s_waitcnt lgkmcnt(6)
    v_mfma_f32_32x32x16_bf16 v[164:179], v[228:231], v[20:23], v[164:179]
    ds_read_b64_tr_b16 v[220:221], v249 offset:0
    ds_read_b64_tr_b16 v[222:223], v249 offset:640
    v_cvt_pk_bf16_f32 v180, v180, v181
    v_cvt_pk_bf16_f32 v181, v182, v183
    s_waitcnt lgkmcnt(6)
    v_mfma_f32_32x32x16_bf16 v[164:179], v[232:235], v[24:27], v[164:179]
    ds_read_b64_tr_b16 v[224:225], v249 offset:2560
    ds_read_b64_tr_b16 v[226:227], v249 offset:3200
    v_cvt_pk_bf16_f32 v182, v184, v185
    v_cvt_pk_bf16_f32 v183, v186, v187
    s_waitcnt lgkmcnt(6)
    v_mfma_f32_32x32x16_bf16 v[164:179], v[212:215], v[28:31], v[164:179]
    ds_read_b64_tr_b16 v[228:229], v249 offset:5120
    ds_read_b64_tr_b16 v[230:231], v249 offset:5760
    v_cvt_pk_bf16_f32 v184, v188, v189
    v_cvt_pk_bf16_f32 v185, v190, v191
    s_waitcnt lgkmcnt(6)
    v_mfma_f32_32x32x16_bf16 v[164:179], v[216:219], v[32:35], v[164:179]
    ds_read_b64_tr_b16 v[232:233], v249 offset:7680
    ds_read_b64_tr_b16 v[234:235], v249 offset:8320
    v_cvt_pk_bf16_f32 v186, v192, v193
    v_cvt_pk_bf16_f32 v187, v194, v195
    buffer_store_dwordx4 v[180:183], v237, s[4:7], s31 offen offset:1280 sc1
    buffer_store_dwordx4 v[184:187], v237, s[4:7], s31 offen offset:1920 sc1
    s_nop 0
    s_waitcnt lgkmcnt(6)
    v_mfma_f32_32x32x16_bf16 v[180:195], v[220:223], v[4:7], 0
    ds_read_b64_tr_b16 v[212:213], v249 offset:10240
    ds_read_b64_tr_b16 v[214:215], v249 offset:10880
    v_add_u32 v253, 64, v251
    v_mul_u32_u24 v254, 3277, v253
    s_waitcnt lgkmcnt(6)
    v_mfma_f32_32x32x16_bf16 v[180:195], v[224:227], v[8:11], v[180:195]
    ds_read_b64_tr_b16 v[216:217], v249 offset:12800
    ds_read_b64_tr_b16 v[218:219], v249 offset:13440
    v_lshrrev_b32 v254, 16, v254
    v_mul_u32_u24 v238, 20, v254
    v_sub_u32 v253, v253, v238
    s_waitcnt lgkmcnt(6)
    v_mfma_f32_32x32x16_bf16 v[180:195], v[228:231], v[12:15], v[180:195]
    ds_read_b64_tr_b16 v[220:221], v249 offset:15360
    ds_read_b64_tr_b16 v[222:223], v249 offset:16000
    v_mul_lo_u32 v238, v254, s32
    v_lshl_add_u32 v238, v253, 4, v238
    s_waitcnt lgkmcnt(6)
    v_mfma_f32_32x32x16_bf16 v[180:195], v[232:235], v[16:19], v[180:195]
    ds_read_b64_tr_b16 v[224:225], v249 offset:17920
    ds_read_b64_tr_b16 v[226:227], v249 offset:18560
    v_add_u32 v238, v238, v252
    v_cvt_pk_bf16_f32 v196, v196, v197
    v_cvt_pk_bf16_f32 v197, v198, v199
    s_waitcnt lgkmcnt(6)
    v_mfma_f32_32x32x16_bf16 v[180:195], v[212:215], v[20:23], v[180:195]
    ds_read_b64_tr_b16 v[228:229], v250 offset:0
    ds_read_b64_tr_b16 v[230:231], v250 offset:640
    v_cvt_pk_bf16_f32 v198, v200, v201
    v_cvt_pk_bf16_f32 v199, v202, v203
    s_waitcnt lgkmcnt(6)
    v_mfma_f32_32x32x16_bf16 v[180:195], v[216:219], v[24:27], v[180:195]
    ds_read_b64_tr_b16 v[232:233], v250 offset:2560
    ds_read_b64_tr_b16 v[234:235], v250 offset:3200
    v_cvt_pk_bf16_f32 v200, v204, v205
    v_cvt_pk_bf16_f32 v201, v206, v207
    v_cvt_pk_bf16_f32 v202, v208, v209
    s_waitcnt lgkmcnt(6)
    v_mfma_f32_32x32x16_bf16 v[180:195], v[220:223], v[28:31], v[180:195]
    ds_read_b64_tr_b16 v[212:213], v250 offset:5120
    ds_read_b64_tr_b16 v[214:215], v250 offset:5760
    v_cvt_pk_bf16_f32 v203, v210, v211
    s_mov_b32 s36, 0xffff
    s_mov_b32 s37, 0xffff
    s_mov_b64 exec, s[36:37]
    buffer_store_dwordx4 v[196:199], v238, s[4:7], s31 offen offset:1280 sc1
    buffer_store_dwordx4 v[200:203], v238, s[4:7], s31 offen offset:1920 sc1
    s_mov_b64 exec, -1
    s_waitcnt lgkmcnt(6)
    v_mfma_f32_32x32x16_bf16 v[180:195], v[224:227], v[32:35], v[180:195]
    ds_read_b64_tr_b16 v[216:217], v250 offset:7680
    ds_read_b64_tr_b16 v[218:219], v250 offset:8320
    v_add_u32 v253, s33, v251
    v_lshl_add_u32 v239, v253, 4, v252
    s_mov_b64 exec, s[38:39]
    buffer_store_dwordx4 v[196:199], v239, s[4:7], s35 offen offset:1280 sc1
    buffer_store_dwordx4 v[200:203], v239, s[4:7], s35 offen offset:1920 sc1
    s_mov_b64 exec, -1
    s_nop 0
    s_waitcnt lgkmcnt(6)
    v_mfma_f32_32x32x16_bf16 v[196:211], v[228:231], v[4:7], 0
    ds_read_b64_tr_b16 v[220:221], v250 offset:10240
    ds_read_b64_tr_b16 v[222:223], v250 offset:10880
    s_waitcnt lgkmcnt(6)
    v_mfma_f32_32x32x16_bf16 v[196:211], v[232:235], v[8:11], v[196:211]
    ds_read_b64_tr_b16 v[224:225], v250 offset:12800
    ds_read_b64_tr_b16 v[226:227], v250 offset:13440
    s_waitcnt lgkmcnt(6)
    v_mfma_f32_32x32x16_bf16 v[196:211], v[212:215], v[12:15], v[196:211]
    ds_read_b64_tr_b16 v[228:229], v250 offset:15360
    ds_read_b64_tr_b16 v[230:231], v250 offset:16000
    s_waitcnt lgkmcnt(6)
    v_mfma_f32_32x32x16_bf16 v[196:211], v[216:219], v[16:19], v[196:211]
    ds_read_b64_tr_b16 v[232:233], v250 offset:17920
    ds_read_b64_tr_b16 v[234:235], v250 offset:18560
    s_waitcnt lgkmcnt(6)
    v_mfma_f32_32x32x16_bf16 v[196:211], v[220:223], v[20:23], v[196:211]
    s_barrier
    v_add_u32 v248, 29696, v248
    v_add_u32 v249, 29696, v249
    v_add_u32 v250, 29696, v250
    s_waitcnt lgkmcnt(4)
    v_mfma_f32_32x32x16_bf16 v[196:211], v[224:227], v[24:27], v[196:211]
    ds_read_b64_tr_b16 v[212:213], v248 offset:2560
    ds_read_b64_tr_b16 v[214:215], v248 offset:3200
    ds_read_b64_tr_b16 v[216:217], v249 offset:2560
    ds_read_b64_tr_b16 v[218:219], v249 offset:3200
    ds_read_b64_tr_b16 v[220:221], v250 offset:2560
    ds_read_b64_tr_b16 v[222:223], v250 offset:3200
    s_waitcnt lgkmcnt(8)
    v_mfma_f32_32x32x16_bf16 v[196:211], v[228:231], v[28:31], v[196:211]
    s_waitcnt lgkmcnt(6)
    v_mfma_f32_32x32x16_bf16 v[196:211], v[232:235], v[32:35], v[196:211]
    ds_read_b64_tr_b16 v[236:237], v248 offset:0
    ds_read_b64_tr_b16 v[238:239], v248 offset:640
    ds_read_b64_tr_b16 v[240:241], v249 offset:0
    ds_read_b64_tr_b16 v[242:243], v249 offset:640
    ds_read_b64_tr_b16 v[244:245], v250 offset:0
    ds_read_b64_tr_b16 v[246:247], v250 offset:640
L_mk_p2:
    s_waitcnt lgkmcnt(0)
    v_mfma_f32_32x32x16_bf16 v[164:179], v[236:239], v[36:39], v[164:179]
    ds_read_b64_tr_b16 v[224:225], v248 offset:5120
    ds_read_b64_tr_b16 v[226:227], v248 offset:5760
    ds_read_b64_tr_b16 v[228:229], v249 offset:5120
    v_mfma_f32_32x32x16_bf16 v[180:195], v[240:243], v[36:39], v[180:195]
    ds_read_b64_tr_b16 v[230:231], v249 offset:5760
    ds_read_b64_tr_b16 v[232:233], v250 offset:5120
    ds_read_b64_tr_b16 v[234:235], v250 offset:5760
    v_mfma_f32_32x32x16_bf16 v[196:211], v[244:247], v[36:39], v[196:211]
    s_waitcnt lgkmcnt(6)
    v_mfma_f32_32x32x16_bf16 v[164:179], v[212:215], v[40:43], v[164:179]
    ds_read_b64_tr_b16 v[236:237], v248 offset:7680
    ds_read_b64_tr_b16 v[238:239], v248 offset:8320
    ds_read_b64_tr_b16 v[240:241], v249 offset:7680
    v_mfma_f32_32x32x16_bf16 v[180:195], v[216:219], v[40:43], v[180:195]
    ds_read_b64_tr_b16 v[242:243], v249 offset:8320
    ds_read_b64_tr_b16 v[244:245], v250 offset:7680
    ds_read_b64_tr_b16 v[246:247], v250 offset:8320
    v_mfma_f32_32x32x16_bf16 v[196:211], v[220:223], v[40:43], v[196:211]
    s_waitcnt lgkmcnt(6)
    v_mfma_f32_32x32x16_bf16 v[164:179], v[224:227], v[44:47], v[164:179]
    ds_read_b64_tr_b16 v[212:213], v248 offset:10240
    ds_read_b64_tr_b16 v[214:215], v248 offset:10880
    ds_read_b64_tr_b16 v[216:217], v249 offset:10240
    v_mfma_f32_32x32x16_bf16 v[180:195], v[228:231], v[44:47], v[180:195]
    ds_read_b64_tr_b16 v[218:219], v249 offset:10880
    ds_read_b64_tr_b16 v[220:221], v250 offset:10240
    ds_read_b64_tr_b16 v[222:223], v250 offset:10880
    v_mfma_f32_32x32x16_bf16 v[196:211], v[232:235], v[44:47], v[196:211]
    s_waitcnt lgkmcnt(6)
    v_mfma_f32_32x32x16_bf16 v[164:179], v[236:239], v[48:51], v[164:179]
    ds_read_b64_tr_b16 v[224:225], v248 offset:12800
    ds_read_b64_tr_b16 v[226:227], v248 offset:13440
    ds_read_b64_tr_b16 v[228:229], v249 offset:12800
    v_mfma_f32_32x32x16_bf16 v[180:195], v[240:243], v[48:51], v[180:195]
    ds_read_b64_tr_b16 v[230:231], v249 offset:13440
    ds_read_b64_tr_b16 v[232:233], v250 offset:12800
    ds_read_b64_tr_b16 v[234:235], v250 offset:13440
    v_mfma_f32_32x32x16_bf16 v[196:211], v[244:247], v[48:51], v[196:211]
    s_waitcnt lgkmcnt(6)
    v_mfma_f32_32x32x16_bf16 v[164:179], v[212:215], v[52:55], v[164:179]
    ds_read_b64_tr_b16 v[236:237], v248 offset:15360
    ds_read_b64_tr_b16 v[238:239], v248 offset:16000
    ds_read_b64_tr_b16 v[240:241], v249 offset:15360
    v_mfma_f32_32x32x16_bf16 v[180:195], v[216:219], v[52:55], v[180:195]
    ds_read_b64_tr_b16 v[242:243], v249 offset:16000
    ds_read_b64_tr_b16 v[244:245], v250 offset:15360
    ds_read_b64_tr_b16 v[246:247], v250 offset:16000
    v_mfma_f32_32x32x16_bf16 v[196:211], v[220:223], v[52:55], v[196:211]
    s_waitcnt lgkmcnt(6)
    v_mfma_f32_32x32x16_bf16 v[164:179], v[224:227], v[56:59], v[164:179]
    ds_read_b64_tr_b16 v[212:213], v248 offset:17920
    ds_read_b64_tr_b16 v[214:215], v248 offset:18560
    ds_read_b64_tr_b16 v[216:217], v249 offset:17920
    v_mfma_f32_32x32x16_bf16 v[180:195], v[228:231], v[56:59], v[180:195]
    ds_read_b64_tr_b16 v[218:219], v249 offset:18560
    ds_read_b64_tr_b16 v[220:221], v250 offset:17920
    ds_read_b64_tr_b16 v[222:223], v250 offset:18560
    v_mfma_f32_32x32x16_bf16 v[196:211], v[232:235], v[56:59], v[196:211]
    s_waitcnt lgkmcnt(6)
    v_mfma_f32_32x32x16_bf16 v[164:179], v[236:239], v[60:63], v[164:179]
    s_waitcnt vmcnt(0)
    s_barrier
    v_add_u32 v248, 29696, v248
    v_add_u32 v249, 29696, v249
    v_add_u32 v250, 29696, v250
    ds_read_b64_tr_b16 v[224:225], v248 offset:0
    ds_read_b64_tr_b16 v[226:227], v248 offset:640
    ds_read_b64_tr_b16 v[228:229], v249 offset:0
    v_mfma_f32_32x32x16_bf16 v[180:195], v[240:243], v[60:63], v[180:195]
    ds_read_b64_tr_b16 v[230:231], v249 offset:640
    ds_read_b64_tr_b16 v[232:233], v250 offset:0
    ds_read_b64_tr_b16 v[234:235], v250 offset:640
    v_mfma_f32_32x32x16_bf16 v[196:211], v[244:247], v[60:63], v[196:211]
    s_waitcnt lgkmcnt(6)
    v_mfma_f32_32x32x16_bf16 v[164:179], v[212:215], v[64:67], v[164:179]
    ds_read_b64_tr_b16 v[236:237], v248 offset:2560
    ds_read_b64_tr_b16 v[238:239], v248 offset:3200
    ds_read_b64_tr_b16 v[240:241], v249 offset:2560
    v_mfma_f32_32x32x16_bf16 v[180:195], v[216:219], v[64:67], v[180:195]
    ds_read_b64_tr_b16 v[242:243], v249 offset:3200
    ds_read_b64_tr_b16 v[244:245], v250 offset:2560
    ds_read_b64_tr_b16 v[246:247], v250 offset:3200
    v_mfma_f32_32x32x16_bf16 v[196:211], v[220:223], v[64:67], v[196:211]
    s_waitcnt lgkmcnt(6)
    v_mfma_f32_32x32x16_bf16 v[164:179], v[224:227], v[68:71], v[164:179]
    ds_read_b64_tr_b16 v[212:213], v248 offset:5120
    ds_read_b64_tr_b16 v[214:215], v248 offset:5760
    ds_read_b64_tr_b16 v[216:217], v249 offset:5120
    v_mfma_f32_32x32x16_bf16 v[180:195], v[228:231], v[68:71], v[180:195]
    ds_read_b64_tr_b16 v[218:219], v249 offset:5760
    ds_read_b64_tr_b16 v[220:221], v250 offset:5120
    ds_read_b64_tr_b16 v[222:223], v250 offset:5760
    v_mfma_f32_32x32x16_bf16 v[196:211], v[232:235], v[68:71], v[196:211]
    s_waitcnt lgkmcnt(6)
    v_mfma_f32_32x32x16_bf16 v[164:179], v[236:239], v[72:75], v[164:179]
    ds_read_b64_tr_b16 v[224:225], v248 offset:7680
    ds_read_b64_tr_b16 v[226:227], v248 offset:8320
    ds_read_b64_tr_b16 v[228:229], v249 offset:7680
    v_mfma_f32_32x32x16_bf16 v[180:195], v[240:243], v[72:75], v[180:195]
    ds_read_b64_tr_b16 v[230:231], v249 offset:8320
    ds_read_b64_tr_b16 v[232:233], v250 offset:7680
    ds_read_b64_tr_b16 v[234:235], v250 offset:8320
    v_mfma_f32_32x32x16_bf16 v[196:211], v[244:247], v[72:75], v[196:211]
    s_waitcnt lgkmcnt(6)
    v_mfma_f32_32x32x16_bf16 v[164:179], v[212:215], v[76:79], v[164:179]
    ds_read_b64_tr_b16 v[236:237], v248 offset:10240
    ds_read_b64_tr_b16 v[238:239], v248 offset:10880
    ds_read_b64_tr_b16 v[240:241], v249 offset:10240
    v_mfma_f32_32x32x16_bf16 v[180:195], v[216:219], v[76:79], v[180:195]
    ds_read_b64_tr_b16 v[242:243], v249 offset:10880
    ds_read_b64_tr_b16 v[244:245], v250 offset:10240
    ds_read_b64_tr_b16 v[246:247], v250 offset:10880
    v_mfma_f32_32x32x16_bf16 v[196:211], v[220:223], v[76:79], v[196:211]
    s_waitcnt lgkmcnt(6)
    v_mfma_f32_32x32x16_bf16 v[164:179], v[224:227], v[80:83], v[164:179]
    ds_read_b64_tr_b16 v[212:213], v248 offset:12800
    ds_read_b64_tr_b16 v[214:215], v248 offset:13440
    ds_read_b64_tr_b16 v[216:217], v249 offset:12800
    v_mfma_f32_32x32x16_bf16 v[180:195], v[228:231], v[80:83], v[180:195]
    ds_read_b64_tr_b16 v[218:219], v249 offset:13440
    ds_read_b64_tr_b16 v[220:221], v250 offset:12800
    ds_read_b64_tr_b16 v[222:223], v250 offset:13440
    v_mfma_f32_32x32x16_bf16 v[196:211], v[232:235], v[80:83], v[196:211]
    s_waitcnt lgkmcnt(6)
    v_mfma_f32_32x32x16_bf16 v[164:179], v[236:239], v[84:87], v[164:179]
    ds_read_b64_tr_b16 v[224:225], v248 offset:15360
    ds_read_b64_tr_b16 v[226:227], v248 offset:16000
    ds_read_b64_tr_b16 v[228:229], v249 offset:15360
    v_mfma_f32_32x32x16_bf16 v[180:195], v[240:243], v[84:87], v[180:195]
    ds_read_b64_tr_b16 v[230:231], v249 offset:16000
    ds_read_b64_tr_b16 v[232:233], v250 offset:15360
    ds_read_b64_tr_b16 v[234:235], v250 offset:16000
    v_mfma_f32_32x32x16_bf16 v[196:211], v[244:247], v[84:87], v[196:211]
    s_mov_b32 s14, 0x000fffff
    s_mov_b32 s15, 0x000fffff
    s_mov_b32 s16, 0
    s_mov_b32 s17, -1
    s_mov_b32 s20, 0
    s_mov_b32 s18, 0x00100000
    s_mov_b32 s19, 0x00100000
    v_mov_b32 v37, 0x3f803f80
    v_mov_b32 v40, 0
    v_mov_b32 v41, 0
    v_mov_b32 v42, 0
    v_mov_b32 v43, 0
    v_mov_b32 v44, 0
    v_mov_b32 v45, 0
    v_mov_b32 v46, 0
    v_mov_b32 v47, 0
    v_mov_b32 v39, 0x3f803f80
    v_mov_b32 v48, 0
    v_mov_b32 v49, 0
    v_mov_b32 v50, 0
    v_mov_b32 v51, 0
    v_mov_b32 v52, 0
    v_mov_b32 v53, 0
    v_mov_b32 v54, 0
    v_mov_b32 v55, 0
    s_mov_b64 exec, s[18:19]
    v_mov_b32 v40, 0x3f803f80
    v_mov_b32 v41, 0x3f803f80
    v_mov_b32 v42, 0x3f803f80
    v_mov_b32 v43, 0x3f803f80
    v_mov_b32 v44, 0x3f803f80
    v_mov_b32 v45, 0x3f803f80
    v_mov_b32 v46, 0x3f803f80
    v_mov_b32 v47, 0x3f803f80
    v_mov_b32 v48, 0x3f803f80
    v_mov_b32 v49, 0x3f803f80
    v_mov_b32 v50, 0x3f803f80
    v_mov_b32 v51, 0x3f803f80
    v_mov_b32 v52, 0x3f803f80
    v_mov_b32 v53, 0x3f803f80
    v_mov_b32 v54, 0x3f803f80
    v_mov_b32 v55, 0x3f803f80
    s_mov_b64 exec, -1
    s_waitcnt lgkmcnt(6)
    v_mfma_f32_32x32x16_bf16 v[164:179], v[212:215], v[88:91], v[164:179]
    ds_read_b64_tr_b16 v[236:237], v248 offset:17920
    ds_read_b64_tr_b16 v[238:239], v248 offset:18560
    ds_read_b64_tr_b16 v[240:241], v249 offset:17920
    v_mfma_f32_32x32x16_bf16 v[180:195], v[216:219], v[88:91], v[180:195]
    ds_read_b64_tr_b16 v[242:243], v249 offset:18560
    ds_read_b64_tr_b16 v[244:245], v250 offset:17920
    ds_read_b64_tr_b16 v[246:247], v250 offset:18560
    v_mfma_f32_32x32x16_bf16 v[196:211], v[220:223], v[88:91], v[196:211]
    s_waitcnt lgkmcnt(6)
    v_mfma_f32_32x32x16_bf16 v[164:179], v[224:227], v[92:95], v[164:179]
    s_barrier
    v_add_u32 v248, 29696, v248
    v_add_u32 v249, 29696, v249
    v_add_u32 v250, 29696, v250
    ds_read_b64_tr_b16 v[212:213], v248 offset:0
    ds_read_b64_tr_b16 v[214:215], v248 offset:640
    ds_read_b64_tr_b16 v[216:217], v249 offset:0
    v_mfma_f32_32x32x16_bf16 v[180:195], v[228:231], v[92:95], v[180:195]
    ds_read_b64_tr_b16 v[218:219], v249 offset:640
    ds_read_b64_tr_b16 v[220:221], v250 offset:0
    ds_read_b64_tr_b16 v[222:223], v250 offset:640
    v_mfma_f32_32x32x16_bf16 v[196:211], v[232:235], v[92:95], v[196:211]
    s_waitcnt lgkmcnt(6)
    v_mfma_f32_32x32x16_bf16 v[164:179], v[236:239], v[96:99], v[164:179]
    ds_read_b64_tr_b16 v[224:225], v248 offset:2560
    ds_read_b64_tr_b16 v[226:227], v248 offset:3200
    ds_read_b64_tr_b16 v[228:229], v249 offset:2560
    v_mfma_f32_32x32x16_bf16 v[180:195], v[240:243], v[96:99], v[180:195]
    ds_read_b64_tr_b16 v[230:231], v249 offset:3200
    ds_read_b64_tr_b16 v[232:233], v250 offset:2560
    ds_read_b64_tr_b16 v[234:235], v250 offset:3200
    v_mfma_f32_32x32x16_bf16 v[196:211], v[244:247], v[96:99], v[196:211]
    s_waitcnt lgkmcnt(6)
    v_mfma_f32_32x32x16_bf16 v[164:179], v[212:215], v[100:103], v[164:179]
    ds_read_b64_tr_b16 v[236:237], v248 offset:5120
    ds_read_b64_tr_b16 v[238:239], v248 offset:5760
    ds_read_b64_tr_b16 v[240:241], v249 offset:5120
    v_mfma_f32_32x32x16_bf16 v[180:195], v[216:219], v[100:103], v[180:195]
    ds_read_b64_tr_b16 v[242:243], v249 offset:5760
    ds_read_b64_tr_b16 v[244:245], v250 offset:5120
    ds_read_b64_tr_b16 v[246:247], v250 offset:5760
    v_mfma_f32_32x32x16_bf16 v[196:211], v[220:223], v[100:103], v[196:211]
    s_waitcnt lgkmcnt(6)
    v_mfma_f32_32x32x16_bf16 v[164:179], v[224:227], v[104:107], v[164:179]
    ds_read_b64_tr_b16 v[212:213], v248 offset:7680
    ds_read_b64_tr_b16 v[214:215], v248 offset:8320
    ds_read_b64_tr_b16 v[216:217], v249 offset:7680
    v_mfma_f32_32x32x16_bf16 v[180:195], v[228:231], v[104:107], v[180:195]
    ds_read_b64_tr_b16 v[218:219], v249 offset:8320
    ds_read_b64_tr_b16 v[220:221], v250 offset:7680
    ds_read_b64_tr_b16 v[222:223], v250 offset:8320
    v_mfma_f32_32x32x16_bf16 v[196:211], v[232:235], v[104:107], v[196:211]
    s_waitcnt lgkmcnt(6)
    v_mfma_f32_32x32x16_bf16 v[164:179], v[236:239], v[108:111], v[164:179]
    ds_read_b64_tr_b16 v[224:225], v248 offset:10240
    ds_read_b64_tr_b16 v[226:227], v248 offset:10880
    ds_read_b64_tr_b16 v[228:229], v249 offset:10240
    v_mfma_f32_32x32x16_bf16 v[180:195], v[240:243], v[108:111], v[180:195]
    ds_read_b64_tr_b16 v[230:231], v249 offset:10880
    ds_read_b64_tr_b16 v[232:233], v250 offset:10240
    ds_read_b64_tr_b16 v[234:235], v250 offset:10880
    v_mfma_f32_32x32x16_bf16 v[196:211], v[244:247], v[108:111], v[196:211]
    s_waitcnt lgkmcnt(6)
    v_mfma_f32_32x32x16_bf16 v[164:179], v[212:215], v[112:115], v[164:179]
    ds_read_b64_tr_b16 v[236:237], v248 offset:12800
    ds_read_b64_tr_b16 v[238:239], v248 offset:13440
    ds_read_b64_tr_b16 v[240:241], v249 offset:12800
    v_mfma_f32_32x32x16_bf16 v[180:195], v[216:219], v[112:115], v[180:195]
    ds_read_b64_tr_b16 v[242:243], v249 offset:13440
    ds_read_b64_tr_b16 v[244:245], v250 offset:12800
    ds_read_b64_tr_b16 v[246:247], v250 offset:13440
    v_mfma_f32_32x32x16_bf16 v[196:211], v[220:223], v[112:115], v[196:211]
    s_waitcnt lgkmcnt(6)
    v_mfma_f32_32x32x16_bf16 v[164:179], v[224:227], v[116:119], v[164:179]
    ds_read_b64_tr_b16 v[212:213], v248 offset:15360
    ds_read_b64_tr_b16 v[214:215], v248 offset:16000
    ds_read_b64_tr_b16 v[216:217], v249 offset:15360
    v_mfma_f32_32x32x16_bf16 v[180:195], v[228:231], v[116:119], v[180:195]
    ds_read_b64_tr_b16 v[218:219], v249 offset:16000
    ds_read_b64_tr_b16 v[220:221], v250 offset:15360
    ds_read_b64_tr_b16 v[222:223], v250 offset:16000
    v_mfma_f32_32x32x16_bf16 v[196:211], v[232:235], v[116:119], v[196:211]
    s_waitcnt lgkmcnt(6)
    v_mfma_f32_32x32x16_bf16 v[164:179], v[236:239], v[120:123], v[164:179]
    ds_read_b64_tr_b16 v[224:225], v248 offset:17920
    ds_read_b64_tr_b16 v[226:227], v248 offset:18560
    ds_read_b64_tr_b16 v[228:229], v249 offset:17920
    v_mfma_f32_32x32x16_bf16 v[180:195], v[240:243], v[120:123], v[180:195]
    ds_read_b64_tr_b16 v[230:231], v249 offset:18560
    ds_read_b64_tr_b16 v[232:233], v250 offset:17920
    ds_read_b64_tr_b16 v[234:235], v250 offset:18560
    v_mfma_f32_32x32x16_bf16 v[196:211], v[244:247], v[120:123], v[196:211]
    s_waitcnt lgkmcnt(6)
    v_mfma_f32_32x32x16_bf16 v[164:179], v[212:215], v[124:127], v[164:179]
    s_barrier
    v_add_u32 v248, 29696, v248
    v_add_u32 v249, 29696, v249
    v_add_u32 v250, 29696, v250
    ds_read_b64_tr_b16 v[236:237], v248 offset:0
    ds_read_b64_tr_b16 v[238:239], v248 offset:640
    ds_read_b64_tr_b16 v[240:241], v249 offset:0
    v_mfma_f32_32x32x16_bf16 v[180:195], v[216:219], v[124:127], v[180:195]
    ds_read_b64_tr_b16 v[242:243], v249 offset:640
    ds_read_b64_tr_b16 v[244:245], v250 offset:0
    ds_read_b64_tr_b16 v[246:247], v250 offset:640
    v_mfma_f32_32x32x16_bf16 v[196:211], v[220:223], v[124:127], v[196:211]
    s_waitcnt lgkmcnt(6)
    v_mfma_f32_32x32x16_bf16 v[164:179], v[224:227], v[128:131], v[164:179]
    ds_read_b64_tr_b16 v[212:213], v248 offset:2560
    ds_read_b64_tr_b16 v[214:215], v248 offset:3200
    ds_read_b64_tr_b16 v[216:217], v249 offset:2560
    v_mfma_f32_32x32x16_bf16 v[180:195], v[228:231], v[128:131], v[180:195]
    ds_read_b64_tr_b16 v[218:219], v249 offset:3200
    ds_read_b64_tr_b16 v[220:221], v250 offset:2560
    ds_read_b64_tr_b16 v[222:223], v250 offset:3200
    v_mfma_f32_32x32x16_bf16 v[196:211], v[232:235], v[128:131], v[196:211]
    s_waitcnt lgkmcnt(6)
    v_mfma_f32_32x32x16_bf16 v[164:179], v[236:239], v[132:135], v[164:179]
    ds_read_b64_tr_b16 v[224:225], v248 offset:5120
    ds_read_b64_tr_b16 v[226:227], v248 offset:5760
    ds_read_b64_tr_b16 v[228:229], v249 offset:5120
    v_mfma_f32_32x32x16_bf16 v[180:195], v[240:243], v[132:135], v[180:195]
    ds_read_b64_tr_b16 v[230:231], v249 offset:5760
    ds_read_b64_tr_b16 v[232:233], v250 offset:5120
    ds_read_b64_tr_b16 v[234:235], v250 offset:5760
    v_mfma_f32_32x32x16_bf16 v[196:211], v[244:247], v[132:135], v[196:211]
    s_waitcnt lgkmcnt(6)
    v_mfma_f32_32x32x16_bf16 v[164:179], v[212:215], v[136:139], v[164:179]
    ds_read_b64_tr_b16 v[236:237], v248 offset:7680
    ds_read_b64_tr_b16 v[238:239], v248 offset:8320
    ds_read_b64_tr_b16 v[240:241], v249 offset:7680
    v_mfma_f32_32x32x16_bf16 v[180:195], v[216:219], v[136:139], v[180:195]
    ds_read_b64_tr_b16 v[242:243], v249 offset:8320
    ds_read_b64_tr_b16 v[244:245], v250 offset:7680
    ds_read_b64_tr_b16 v[246:247], v250 offset:8320
    v_mfma_f32_32x32x16_bf16 v[196:211], v[220:223], v[136:139], v[196:211]
    s_waitcnt lgkmcnt(6)
    v_mfma_f32_32x32x16_bf16 v[164:179], v[224:227], v[140:143], v[164:179]
    ds_read_b64_tr_b16 v[212:213], v248 offset:10240
    ds_read_b64_tr_b16 v[214:215], v248 offset:10880
    ds_read_b64_tr_b16 v[216:217], v249 offset:10240
    v_mfma_f32_32x32x16_bf16 v[180:195], v[228:231], v[140:143], v[180:195]
    ds_read_b64_tr_b16 v[218:219], v249 offset:10880
    ds_read_b64_tr_b16 v[220:221], v250 offset:10240
    ds_read_b64_tr_b16 v[222:223], v250 offset:10880
    v_mfma_f32_32x32x16_bf16 v[196:211], v[232:235], v[140:143], v[196:211]
    s_waitcnt lgkmcnt(6)
    v_mfma_f32_32x32x16_bf16 v[164:179], v[236:239], v[144:147], v[164:179]
    ds_read_b64_tr_b16 v[224:225], v248 offset:12800
    ds_read_b64_tr_b16 v[226:227], v248 offset:13440
    ds_read_b64_tr_b16 v[228:229], v249 offset:12800
    v_mfma_f32_32x32x16_bf16 v[180:195], v[240:243], v[144:147], v[180:195]
    ds_read_b64_tr_b16 v[230:231], v249 offset:13440
    ds_read_b64_tr_b16 v[232:233], v250 offset:12800
    ds_read_b64_tr_b16 v[234:235], v250 offset:13440
    v_mfma_f32_32x32x16_bf16 v[196:211], v[244:247], v[144:147], v[196:211]
    s_waitcnt lgkmcnt(6)
    v_mfma_f32_32x32x16_bf16 v[164:179], v[212:215], v[148:151], v[164:179]
    ds_read_b64_tr_b16 v[236:237], v248 offset:15360
    ds_read_b64_tr_b16 v[238:239], v248 offset:16000
    ds_read_b64_tr_b16 v[240:241], v249 offset:15360
    v_mfma_f32_32x32x16_bf16 v[180:195], v[216:219], v[148:151], v[180:195]
    ds_read_b64_tr_b16 v[242:243], v249 offset:16000
    ds_read_b64_tr_b16 v[244:245], v250 offset:15360
    ds_read_b64_tr_b16 v[246:247], v250 offset:16000
    v_mfma_f32_32x32x16_bf16 v[196:211], v[220:223], v[148:151], v[196:211]
    s_waitcnt lgkmcnt(6)
    v_mfma_f32_32x32x16_bf16 v[164:179], v[224:227], v[152:155], v[164:179]
    ds_read_b64_tr_b16 v[212:213], v248 offset:17920
    ds_read_b64_tr_b16 v[214:215], v248 offset:18560
    ds_read_b64_tr_b16 v[216:217], v249 offset:17920
    v_mfma_f32_32x32x16_bf16 v[180:195], v[228:231], v[152:155], v[180:195]
    ds_read_b64_tr_b16 v[218:219], v249 offset:18560
    ds_read_b64_tr_b16 v[220:221], v250 offset:17920
    ds_read_b64_tr_b16 v[222:223], v250 offset:18560
    v_mfma_f32_32x32x16_bf16 v[196:211], v[232:235], v[152:155], v[196:211]
    s_waitcnt lgkmcnt(6)
    v_mfma_f32_32x32x16_bf16 v[164:179], v[236:239], v[156:159], v[164:179]
    v_mfma_f32_32x32x16_bf16 v[180:195], v[240:243], v[156:159], v[180:195]
    v_mfma_f32_32x32x16_bf16 v[196:211], v[244:247], v[156:159], v[196:211]
    s_waitcnt lgkmcnt(0)
    v_mfma_f32_32x32x16_bf16 v[164:179], v[212:215], v[160:163], v[164:179]
    v_mfma_f32_32x32x16_bf16 v[180:195], v[216:219], v[160:163], v[180:195]
    v_mfma_f32_32x32x16_bf16 v[196:211], v[220:223], v[160:163], v[196:211]
    s_mov_b32 s34, 0x3ea52b5c
    s_mov_b32 s35, 0x3ea52b5c
    s_mul_i32 s33, s8, 1280
    s_add_u32 s33, s33, 49152
    v_and_b32 v251, 63, v0
    v_lshlrev_b32 v251, 4, v251
    v_add_u32 v251, s33, v251
    v_bfe_u32 v252, v0, 5, 1
    v_mul_u32_u24 v252, 5120, v252
    v_and_b32 v253, 31, v0
    v_lshl_add_u32 v252, v253, 3, v252
    v_add_u32 v252, s33, v252
    v_pk_mul_f32 v[164:165], v[164:165], s[34:35]
    v_pk_mul_f32 v[166:167], v[166:167], s[34:35]
    v_pk_mul_f32 v[168:169], v[168:169], s[34:35]
    v_pk_mul_f32 v[170:171], v[170:171], s[34:35]
    v_pk_mul_f32 v[172:173], v[172:173], s[34:35]
    v_pk_mul_f32 v[174:175], v[174:175], s[34:35]
    v_pk_mul_f32 v[176:177], v[176:177], s[34:35]
    v_pk_mul_f32 v[178:179], v[178:179], s[34:35]
    v_cvt_pk_bf16_f32 v212, v164, v165
    v_cvt_pk_bf16_f32 v213, v166, v167
    v_cvt_pk_bf16_f32 v214, v168, v169
    v_cvt_pk_bf16_f32 v215, v170, v171
    v_cvt_pk_bf16_f32 v216, v172, v173
    v_cvt_pk_bf16_f32 v217, v174, v175
    v_cvt_pk_bf16_f32 v218, v176, v177
    v_cvt_pk_bf16_f32 v219, v178, v179
    s_nop 1
    v_permlane32_swap_b32 v212, v214
    v_permlane32_swap_b32 v213, v215
    v_permlane32_swap_b32 v216, v218
    v_permlane32_swap_b32 v217, v219
    ds_write_b128 v251, v[212:215]
    ds_write_b128 v251, v[216:219] offset:5120
    v_pk_mul_f32 v[180:181], v[180:181], s[34:35]
    v_pk_mul_f32 v[182:183], v[182:183], s[34:35]
    v_pk_mul_f32 v[184:185], v[184:185], s[34:35]
    v_pk_mul_f32 v[186:187], v[186:187], s[34:35]
    v_pk_mul_f32 v[188:189], v[188:189], s[34:35]
    v_pk_mul_f32 v[190:191], v[190:191], s[34:35]
    v_pk_mul_f32 v[192:193], v[192:193], s[34:35]
    v_pk_mul_f32 v[194:195], v[194:195], s[34:35]
    v_cvt_pk_bf16_f32 v220, v180, v181
    v_cvt_pk_bf16_f32 v221, v182, v183
    v_cvt_pk_bf16_f32 v222, v184, v185
    v_cvt_pk_bf16_f32 v223, v186, v187
    v_cvt_pk_bf16_f32 v224, v188, v189
    v_cvt_pk_bf16_f32 v225, v190, v191
    v_cvt_pk_bf16_f32 v226, v192, v193
    v_cvt_pk_bf16_f32 v227, v194, v195
    s_nop 1
    v_permlane32_swap_b32 v220, v222
    v_permlane32_swap_b32 v221, v223
    v_permlane32_swap_b32 v224, v226
    v_permlane32_swap_b32 v225, v227
    ds_write_b128 v251, v[220:223] offset:10240
    ds_write_b128 v251, v[224:227] offset:15360
    v_pk_mul_f32 v[196:197], v[196:197], s[34:35]
    v_pk_mul_f32 v[198:199], v[198:199], s[34:35]
    v_pk_mul_f32 v[200:201], v[200:201], s[34:35]
    v_pk_mul_f32 v[202:203], v[202:203], s[34:35]
    v_cvt_pk_bf16_f32 v228, v196, v197
    v_cvt_pk_bf16_f32 v229, v198, v199
    v_cvt_pk_bf16_f32 v230, v200, v201
    v_cvt_pk_bf16_f32 v231, v202, v203
    ds_write_b64 v252, v[228:229] offset:1024
    ds_write_b64 v252, v[230:231] offset:11264
    s_mov_b32 s9, s54
    s_mov_b32 s10, s55
    s_mov_b32 s11, s56
    s_mov_b32 s13, s57
    s_mov_b32 s22, s59
    s_lshl_b32 s28, s56, 8
    s_add_u32 s28, s28, 10649600
    s_add_u32 s29, s28, 8448
    s_mul_i32 s25, s8, 5120
    s_add_u32 s25, s25, 49152
    s_mul_i32 s26, s57, 2560
    s_add_u32 s27, s25, s26
    s_sub_u32 s25, s25, s26
    s_add_u32 s25, s25, 2560
    s_waitcnt lgkmcnt(0)
    s_barrier
L_mk_join:
    v_lshrrev_b32 v171, 2, v1
    buffer_load_dword v176, v171, s[4:7], s28 offen
    buffer_load_dword v177, v171, s[4:7], s29 offen
    s_mov_b32 s23, s22
    buffer_load_dwordx4 v[28:31], v1, s[4:7], s23 offen
    buffer_load_dword v36, v2, s[4:7], s23 offen
    s_mov_b64 exec, s[14:15]
    buffer_load_dwordx4 v[40:43], v3, s[4:7], s23 offen
    buffer_load_dwordx4 v[44:47], v3, s[4:7], s23 offen offset:640
    s_mov_b64 exec, -1
    s_add_u32 s23, s22, 2560
    buffer_load_dwordx4 v[32:35], v1, s[4:7], s23 offen
    buffer_load_dword v38, v2, s[4:7], s23 offen
    s_add_u32 s24, s22, 5120
    v_add_u32 v168, s25, v1
    v_add_u32 v169, s25, v2
    v_add_u32 v172, s27, v1
    v_add_u32 v173, s27, v2
    ds_read_b128 v[4:7], v168 offset:0
    ds_read_b32 v20, v169 offset:0
    ds_read_b128 v[8:11], v168 offset:1280
    ds_read_b32 v22, v169 offset:1280
    ds_read_b128 v[12:15], v172 offset:0
    ds_read_b32 v24, v173 offset:0
    ds_read_b128 v[16:19], v172 offset:1280
    ds_read_b32 v26, v173 offset:1280
    s_mov_b32 s8, s53
    s_waitcnt lgkmcnt(0)
    v_mov_b32 v88, 0
    v_mov_b32 v90, 0
    v_mov_b32 v92, 0
    v_mov_b32 v94, 0
    v_dot2_f32_bf16 v88, v4, v4, v88
    v_dot2_f32_bf16 v90, v8, v8, v90
    v_dot2_f32_bf16 v92, v12, v12, v92
    v_dot2_f32_bf16 v94, v16, v16, v94
    v_dot2_f32_bf16 v88, v5, v5, v88
    v_dot2_f32_bf16 v90, v9, v9, v90
    v_dot2_f32_bf16 v92, v13, v13, v92
    v_dot2_f32_bf16 v94, v17, v17, v94
    v_dot2_f32_bf16 v88, v6, v6, v88
    v_dot2_f32_bf16 v90, v10, v10, v90
    v_dot2_f32_bf16 v92, v14, v14, v92
    v_dot2_f32_bf16 v94, v18, v18, v94
    v_dot2_f32_bf16 v88, v7, v7, v88
    v_dot2_f32_bf16 v90, v11, v11, v90
    v_dot2_f32_bf16 v92, v15, v15, v92
    v_dot2_f32_bf16 v94, v19, v19, v94
    v_dot2_f32_bf16 v88, v20, v20, v88
    v_dot2_f32_bf16 v90, v22, v22, v90
    v_dot2_f32_bf16 v92, v24, v24, v92
    v_dot2_f32_bf16 v94, v26, v26, v94
    s_nop 0
    v_mov_b32 v89, v88
    v_mov_b32 v91, v90
    v_mov_b32 v93, v92
    v_mov_b32 v95, v94
    s_nop 0
    v_permlane32_swap_b32 v88, v89
    v_permlane32_swap_b32 v90, v91
    v_permlane32_swap_b32 v92, v93
    v_permlane32_swap_b32 v94, v95
    s_nop 0
    v_add_f32 v88, v88, v89
    v_add_f32 v90, v90, v91
    v_add_f32 v92, v92, v93
    v_add_f32 v94, v94, v95
    s_waitcnt vmcnt(6)
    s_cmp_eq_u32 s56, 0
    s_cselect_b32 s36, -1, 0
    v_and_b32 v177, s36, v177
    v_add_f32 v176, v176, v177
    s_nop 1
    v_max_f32_dpp v176, v176, v176 quad_perm:[1,0,3,2] row_mask:0xf bank_mask:0xf
    s_nop 1
    v_max_f32_dpp v176, v176, v176 quad_perm:[2,3,0,1] row_mask:0xf bank_mask:0xf
    s_nop 1
    v_max_f32_dpp v176, v176, v176 row_half_mirror row_mask:0xf bank_mask:0xf
    s_nop 1
    v_max_f32_dpp v176, v176, v176 row_mirror row_mask:0xf bank_mask:0xf
    s_nop 1
    v_readlane_b32 s26, v176, 0
    v_readlane_b32 s27, v176, 16
    v_readlane_b32 s28, v176, 32
    v_readlane_b32 s29, v176, 48
    s_nop 1
    s_max_u32 s26, s26, s27
    s_max_u32 s28, s28, s29
    s_max_u32 s26, s26, s28
    v_mul_f32 v88, s26, v88
    v_mul_f32 v90, s26, v90
    v_mul_f32 v92, s26, v92
    v_mul_f32 v94, s26, v94
    v_sqrt_f32 v88, v88
    v_sqrt_f32 v90, v90
    v_sqrt_f32 v92, v92
    v_sqrt_f32 v94, v94
    v_mul_f32 v88, 0x3f83d70a, v88
    v_mul_f32 v90, 0x3f83d70a, v90
    v_mul_f32 v92, 0x3f83d70a, v92
    v_mul_f32 v94, 0x3f83d70a, v94
    v_add_f32 v88, 0x3a83126f, v88
    v_add_f32 v90, 0x3a83126f, v90
    v_add_f32 v92, 0x3a83126f, v92
    v_add_f32 v94, 0x3a83126f, v94
    v_lshrrev_b32 v88, 16, v88
    v_lshrrev_b32 v90, 16, v90
    v_lshrrev_b32 v92, 16, v92
    v_lshrrev_b32 v94, 16, v94
    v_or_b32 v88, 0x8000, v88
    v_or_b32 v90, 0x8000, v90
    v_or_b32 v92, 0x8000, v92
    v_or_b32 v94, 0x8000, v94
    v_cndmask_b32 v21, v88, 0, s[16:17]
    v_cndmask_b32 v23, v90, 0, s[16:17]
    v_cndmask_b32 v25, v92, 0, s[16:17]
    v_cndmask_b32 v27, v94, 0, s[16:17]
L_mk_restart:
    s_setprio 3
    s_mov_b32 s21, 0x07060302
    s_waitcnt vmcnt(4)
    v_mfma_f32_32x32x8_bf16 v[72:87], v[36:37], v[20:21], 0
    v_mfma_f32_32x32x16_bf16 v[72:87], v[28:31], v[4:7], v[72:87]
    s_nop 11
    v_exp_f32 v72, v72
    v_mfma_f32_32x32x8_bf16 v[88:103], v[36:37], v[22:23], 0
    v_exp_f32 v73, v73
    v_exp_f32 v74, v74
    v_cvt_pk_bf16_f32 v56, v72, v73
    v_exp_f32 v75, v75
    v_exp_f32 v76, v76
    v_mfma_f32_32x32x16_bf16 v[88:103], v[28:31], v[8:11], v[88:103]
    v_cvt_pk_bf16_f32 v57, v74, v75
    v_exp_f32 v77, v77
    v_exp_f32 v78, v78
    v_cvt_pk_bf16_f32 v58, v76, v77
    v_exp_f32 v79, v79
    v_exp_f32 v80, v80
    s_load_dword s3, s[100:101], s47
    s_add_u32 s47, s47, 128
    s_min_u32 s47, s47, s52
    v_cvt_pk_bf16_f32 v59, v78, v79
    v_exp_f32 v81, v81
    v_exp_f32 v82, v82
    v_cvt_pk_bf16_f32 v60, v80, v81
    v_exp_f32 v83, v83
    v_exp_f32 v84, v84
    v_cvt_pk_bf16_f32 v61, v82, v83
    v_exp_f32 v85, v85
    v_exp_f32 v86, v86
    v_cvt_pk_bf16_f32 v62, v84, v85
    v_exp_f32 v87, v87
    v_exp_f32 v88, v88
    v_cvt_pk_bf16_f32 v63, v86, v87
    v_mfma_f32_32x32x8_bf16 v[72:87], v[36:37], v[24:25], 0
    v_exp_f32 v89, v89
    v_exp_f32 v90, v90
    v_cvt_pk_bf16_f32 v64, v88, v89
    v_exp_f32 v91, v91
    v_exp_f32 v92, v92
    v_mfma_f32_32x32x16_bf16 v[72:87], v[28:31], v[12:15], v[72:87]
    v_cvt_pk_bf16_f32 v65, v90, v91
    v_exp_f32 v93, v93
    v_exp_f32 v94, v94
    v_cvt_pk_bf16_f32 v66, v92, v93
    v_exp_f32 v95, v95
    v_exp_f32 v96, v96
    s_waitcnt vmcnt(2)
    v_mfma_f32_32x32x16_bf16 v[104:119], v[40:43], v[56:59], 0
    s_load_dword s3, s[100:101], s47
    s_add_u32 s47, s47, 128
    s_min_u32 s47, s47, s52
    v_cvt_pk_bf16_f32 v67, v94, v95
    v_exp_f32 v97, v97
    v_exp_f32 v98, v98
    v_cvt_pk_bf16_f32 v68, v96, v97
    v_exp_f32 v99, v99
    v_exp_f32 v100, v100
    v_mfma_f32_32x32x16_bf16 v[104:119], v[44:47], v[60:63], v[104:119]
    s_mov_b64 exec, s[14:15]
    buffer_load_dwordx4 v[48:51], v3, s[4:7], s23 offen
    buffer_load_dwordx4 v[52:55], v3, s[4:7], s23 offen offset:640
    s_mov_b64 exec, -1
    s_add_u32 s23, s23, 2560
    v_cvt_pk_bf16_f32 v69, v98, v99
    v_exp_f32 v101, v101
    v_exp_f32 v102, v102
    v_cvt_pk_bf16_f32 v70, v100, v101
    v_exp_f32 v103, v103
    v_exp_f32 v72, v72
    v_cvt_pk_bf16_f32 v71, v102, v103
    v_mfma_f32_32x32x8_bf16 v[88:103], v[36:37], v[26:27], 0
    v_exp_f32 v73, v73
    v_exp_f32 v74, v74
    v_cvt_pk_bf16_f32 v56, v72, v73
    v_exp_f32 v75, v75
    v_exp_f32 v76, v76
    v_mfma_f32_32x32x16_bf16 v[88:103], v[28:31], v[16:19], v[88:103]
    v_cvt_pk_bf16_f32 v57, v74, v75
    v_exp_f32 v77, v77
    v_exp_f32 v78, v78
    v_cvt_pk_bf16_f32 v58, v76, v77
    v_exp_f32 v79, v79
    v_exp_f32 v80, v80
    v_mfma_f32_32x32x16_bf16 v[120:135], v[40:43], v[64:67], 0
    s_load_dword s3, s[100:101], s47
    s_add_u32 s47, s47, 128
    s_min_u32 s47, s47, s52
    v_cvt_pk_bf16_f32 v59, v78, v79
    v_exp_f32 v81, v81
    v_exp_f32 v82, v82
    v_cvt_pk_bf16_f32 v60, v80, v81
    v_exp_f32 v83, v83
    v_exp_f32 v84, v84
    v_mfma_f32_32x32x16_bf16 v[120:135], v[44:47], v[68:71], v[120:135]
    v_cvt_pk_bf16_f32 v61, v82, v83
    v_exp_f32 v85, v85
    v_exp_f32 v86, v86
    v_cvt_pk_bf16_f32 v62, v84, v85
    v_exp_f32 v87, v87
    v_exp_f32 v88, v88
    v_cvt_pk_bf16_f32 v63, v86, v87
    s_waitcnt vmcnt(2)
    v_mfma_f32_32x32x8_bf16 v[72:87], v[38:39], v[20:21], 0
    buffer_load_dwordx4 v[28:31], v1, s[4:7], s24 offen
    v_exp_f32 v89, v89
    v_exp_f32 v90, v90
    v_cvt_pk_bf16_f32 v64, v88, v89
    v_exp_f32 v91, v91
    v_exp_f32 v92, v92
    v_mfma_f32_32x32x16_bf16 v[72:87], v[32:35], v[4:7], v[72:87]
    buffer_load_dword v36, v2, s[4:7], s24 offen
    s_add_u32 s24, s24, 2560
    v_cvt_pk_bf16_f32 v65, v90, v91
    v_exp_f32 v93, v93
    v_exp_f32 v94, v94
    v_cvt_pk_bf16_f32 v66, v92, v93
    v_exp_f32 v95, v95
    v_exp_f32 v96, v96
    v_mfma_f32_32x32x16_bf16 v[136:151], v[40:43], v[56:59], 0
    s_load_dword s3, s[100:101], s47
    s_add_u32 s47, s47, 128
    s_min_u32 s47, s47, s52
    v_cvt_pk_bf16_f32 v67, v94, v95
    v_exp_f32 v97, v97
    v_exp_f32 v98, v98
    v_cvt_pk_bf16_f32 v68, v96, v97
    v_exp_f32 v99, v99
    v_exp_f32 v100, v100
    v_mfma_f32_32x32x16_bf16 v[136:151], v[44:47], v[60:63], v[136:151]
    v_cvt_pk_bf16_f32 v69, v98, v99
    v_exp_f32 v101, v101
    v_exp_f32 v102, v102
    v_cvt_pk_bf16_f32 v70, v100, v101
    v_exp_f32 v103, v103
    v_exp_f32 v72, v72
    v_cvt_pk_bf16_f32 v71, v102, v103
    v_mfma_f32_32x32x8_bf16 v[88:103], v[38:39], v[22:23], 0
    v_exp_f32 v73, v73
    v_exp_f32 v74, v74
    v_cvt_pk_bf16_f32 v56, v72, v73
    v_exp_f32 v75, v75
    v_exp_f32 v76, v76
    v_mfma_f32_32x32x16_bf16 v[88:103], v[32:35], v[8:11], v[88:103]
    v_cvt_pk_bf16_f32 v57, v74, v75
    v_exp_f32 v77, v77
    v_exp_f32 v78, v78
    v_cvt_pk_bf16_f32 v58, v76, v77
    v_exp_f32 v79, v79
    v_exp_f32 v80, v80
    v_mfma_f32_32x32x16_bf16 v[152:167], v[40:43], v[64:67], 0
    s_load_dword s3, s[100:101], s47
    s_add_u32 s47, s47, 128
    s_min_u32 s47, s47, s52
    v_cvt_pk_bf16_f32 v59, v78, v79
    v_exp_f32 v81, v81
    v_exp_f32 v82, v82
    v_cvt_pk_bf16_f32 v60, v80, v81
    v_exp_f32 v83, v83
    v_exp_f32 v84, v84
    v_mfma_f32_32x32x16_bf16 v[152:167], v[44:47], v[68:71], v[152:167]
    v_cvt_pk_bf16_f32 v61, v82, v83
    v_exp_f32 v85, v85
    v_exp_f32 v86, v86
    v_cvt_pk_bf16_f32 v62, v84, v85
    v_exp_f32 v87, v87
    v_exp_f32 v88, v88
    v_cvt_pk_bf16_f32 v63, v86, v87
    v_mfma_f32_32x32x8_bf16 v[72:87], v[38:39], v[24:25], 0
    v_exp_f32 v89, v89
    v_exp_f32 v90, v90
    v_cvt_pk_bf16_f32 v64, v88, v89
    v_exp_f32 v91, v91
    v_exp_f32 v92, v92
    v_mfma_f32_32x32x16_bf16 v[72:87], v[32:35], v[12:15], v[72:87]
    v_cvt_pk_bf16_f32 v65, v90, v91
    v_exp_f32 v93, v93
    v_exp_f32 v94, v94
    v_cvt_pk_bf16_f32 v66, v92, v93
    v_exp_f32 v95, v95
    v_exp_f32 v96, v96
    s_waitcnt vmcnt(2)
    v_mfma_f32_32x32x16_bf16 v[104:119], v[48:51], v[56:59], v[104:119]
    s_load_dword s3, s[100:101], s47
    s_add_u32 s47, s47, 128
    s_min_u32 s47, s47, s52
    v_cvt_pk_bf16_f32 v67, v94, v95
    v_exp_f32 v97, v97
    v_exp_f32 v98, v98
    v_cvt_pk_bf16_f32 v68, v96, v97
    v_exp_f32 v99, v99
    v_exp_f32 v100, v100
    v_mfma_f32_32x32x16_bf16 v[104:119], v[52:55], v[60:63], v[104:119]
    s_mov_b64 exec, s[14:15]
    buffer_load_dwordx4 v[40:43], v3, s[4:7], s23 offen
    buffer_load_dwordx4 v[44:47], v3, s[4:7], s23 offen offset:640
    s_mov_b64 exec, -1
    s_add_u32 s23, s23, 2560
    v_cvt_pk_bf16_f32 v69, v98, v99
    v_exp_f32 v101, v101
    v_exp_f32 v102, v102
    v_cvt_pk_bf16_f32 v70, v100, v101
    v_exp_f32 v103, v103
    v_exp_f32 v72, v72
    v_cvt_pk_bf16_f32 v71, v102, v103
    v_mfma_f32_32x32x8_bf16 v[88:103], v[38:39], v[26:27], 0
    v_exp_f32 v73, v73
    v_exp_f32 v74, v74
    v_cvt_pk_bf16_f32 v56, v72, v73
    v_exp_f32 v75, v75
    v_exp_f32 v76, v76
    v_mfma_f32_32x32x16_bf16 v[88:103], v[32:35], v[16:19], v[88:103]
    v_cvt_pk_bf16_f32 v57, v74, v75
    v_exp_f32 v77, v77
    v_exp_f32 v78, v78
    v_cvt_pk_bf16_f32 v58, v76, v77
    v_exp_f32 v79, v79
    v_exp_f32 v80, v80
    v_mfma_f32_32x32x16_bf16 v[120:135], v[48:51], v[64:67], v[120:135]
    s_load_dword s3, s[100:101], s47
    s_add_u32 s47, s47, 128
    s_min_u32 s47, s47, s52
    v_cvt_pk_bf16_f32 v59, v78, v79
    v_exp_f32 v81, v81
    v_exp_f32 v82, v82
    v_cvt_pk_bf16_f32 v60, v80, v81
    v_exp_f32 v83, v83
    v_exp_f32 v84, v84
    v_mfma_f32_32x32x16_bf16 v[120:135], v[52:55], v[68:71], v[120:135]
    v_cvt_pk_bf16_f32 v61, v82, v83
    v_exp_f32 v85, v85
    v_exp_f32 v86, v86
    v_cvt_pk_bf16_f32 v62, v84, v85
    v_exp_f32 v87, v87
    v_exp_f32 v88, v88
    v_cvt_pk_bf16_f32 v63, v86, v87
    s_waitcnt vmcnt(2)
    v_mfma_f32_32x32x8_bf16 v[72:87], v[36:37], v[20:21], 0
    buffer_load_dwordx4 v[32:35], v1, s[4:7], s24 offen
    v_exp_f32 v89, v89
    v_exp_f32 v90, v90
    v_cvt_pk_bf16_f32 v64, v88, v89
    v_exp_f32 v91, v91
    v_exp_f32 v92, v92
    v_mfma_f32_32x32x16_bf16 v[72:87], v[28:31], v[4:7], v[72:87]
    buffer_load_dword v38, v2, s[4:7], s24 offen
    s_add_u32 s24, s24, 2560
    v_cvt_pk_bf16_f32 v65, v90, v91
    v_exp_f32 v93, v93
    v_exp_f32 v94, v94
    v_cvt_pk_bf16_f32 v66, v92, v93
    v_exp_f32 v95, v95
    v_exp_f32 v96, v96
    v_mfma_f32_32x32x16_bf16 v[136:151], v[48:51], v[56:59], v[136:151]
    s_load_dword s3, s[100:101], s47
    s_add_u32 s47, s47, 128
    s_min_u32 s47, s47, s52
    v_cvt_pk_bf16_f32 v67, v94, v95
    v_exp_f32 v97, v97
    v_exp_f32 v98, v98
    v_cvt_pk_bf16_f32 v68, v96, v97
    v_exp_f32 v99, v99
    v_exp_f32 v100, v100
    v_mfma_f32_32x32x16_bf16 v[136:151], v[52:55], v[60:63], v[136:151]
    v_cvt_pk_bf16_f32 v69, v98, v99
    v_exp_f32 v101, v101
    v_exp_f32 v102, v102
    v_cvt_pk_bf16_f32 v70, v100, v101
    v_exp_f32 v103, v103
    v_exp_f32 v72, v72
    v_cvt_pk_bf16_f32 v71, v102, v103
    v_mfma_f32_32x32x8_bf16 v[88:103], v[36:37], v[22:23], 0
    v_exp_f32 v73, v73
    v_exp_f32 v74, v74
    v_cvt_pk_bf16_f32 v56, v72, v73
    v_exp_f32 v75, v75
    v_exp_f32 v76, v76
    v_mfma_f32_32x32x16_bf16 v[88:103], v[28:31], v[8:11], v[88:103]
    v_cvt_pk_bf16_f32 v57, v74, v75
    v_exp_f32 v77, v77
    v_exp_f32 v78, v78
    v_cvt_pk_bf16_f32 v58, v76, v77
    v_exp_f32 v79, v79
    v_exp_f32 v80, v80
    v_mfma_f32_32x32x16_bf16 v[152:167], v[48:51], v[64:67], v[152:167]
    s_load_dword s3, s[100:101], s47
    s_add_u32 s47, s47, 128
    s_min_u32 s47, s47, s52
    v_cvt_pk_bf16_f32 v59, v78, v79
    v_exp_f32 v81, v81
    v_exp_f32 v82, v82
    v_cvt_pk_bf16_f32 v60, v80, v81
    v_exp_f32 v83, v83
    v_exp_f32 v84, v84
    v_mfma_f32_32x32x16_bf16 v[152:167], v[52:55], v[68:71], v[152:167]
    v_cvt_pk_bf16_f32 v61, v82, v83
    v_exp_f32 v85, v85
    v_exp_f32 v86, v86
    v_cvt_pk_bf16_f32 v62, v84, v85
    v_exp_f32 v87, v87
    v_exp_f32 v88, v88
    v_cvt_pk_bf16_f32 v63, v86, v87
    v_mfma_f32_32x32x8_bf16 v[72:87], v[36:37], v[24:25], 0
    v_exp_f32 v89, v89
    v_exp_f32 v90, v90
    v_cvt_pk_bf16_f32 v64, v88, v89
    v_exp_f32 v91, v91
    v_exp_f32 v92, v92
    v_mfma_f32_32x32x16_bf16 v[72:87], v[28:31], v[12:15], v[72:87]
    v_cvt_pk_bf16_f32 v65, v90, v91
    v_exp_f32 v93, v93
    v_exp_f32 v94, v94
    v_cvt_pk_bf16_f32 v66, v92, v93
    v_exp_f32 v95, v95
    v_exp_f32 v96, v96
    s_waitcnt vmcnt(2)
    v_mfma_f32_32x32x16_bf16 v[104:119], v[40:43], v[56:59], v[104:119]
    s_load_dword s3, s[100:101], s47
    s_add_u32 s47, s47, 128
    s_min_u32 s47, s47, s52
    v_cvt_pk_bf16_f32 v67, v94, v95
    v_exp_f32 v97, v97
    v_exp_f32 v98, v98
    v_cvt_pk_bf16_f32 v68, v96, v97
    v_exp_f32 v99, v99
    v_exp_f32 v100, v100
    v_mfma_f32_32x32x16_bf16 v[104:119], v[44:47], v[60:63], v[104:119]
    s_mov_b64 exec, s[14:15]
    buffer_load_dwordx4 v[48:51], v3, s[4:7], s23 offen
    buffer_load_dwordx4 v[52:55], v3, s[4:7], s23 offen offset:640
    s_mov_b64 exec, -1
    s_add_u32 s23, s23, 2560
    v_cvt_pk_bf16_f32 v69, v98, v99
    v_exp_f32 v101, v101
    v_exp_f32 v102, v102
    v_cvt_pk_bf16_f32 v70, v100, v101
    v_exp_f32 v103, v103
    v_exp_f32 v72, v72
    v_cvt_pk_bf16_f32 v71, v102, v103
    v_mfma_f32_32x32x8_bf16 v[88:103], v[36:37], v[26:27], 0
    v_exp_f32 v73, v73
    v_exp_f32 v74, v74
    v_cvt_pk_bf16_f32 v56, v72, v73
    v_exp_f32 v75, v75
    v_exp_f32 v76, v76
    v_mfma_f32_32x32x16_bf16 v[88:103], v[28:31], v[16:19], v[88:103]
    v_cvt_pk_bf16_f32 v57, v74, v75
    v_exp_f32 v77, v77
    v_exp_f32 v78, v78
    v_cvt_pk_bf16_f32 v58, v76, v77
    v_exp_f32 v79, v79
    v_exp_f32 v80, v80
    v_mfma_f32_32x32x16_bf16 v[120:135], v[40:43], v[64:67], v[120:135]
    s_load_dword s3, s[100:101], s47
    s_add_u32 s47, s47, 128
    s_min_u32 s47, s47, s52
    v_cvt_pk_bf16_f32 v59, v78, v79
    v_exp_f32 v81, v81
    v_exp_f32 v82, v82
    v_cvt_pk_bf16_f32 v60, v80, v81
    v_exp_f32 v83, v83
    v_exp_f32 v84, v84
    v_mfma_f32_32x32x16_bf16 v[120:135], v[44:47], v[68:71], v[120:135]
    v_cvt_pk_bf16_f32 v61, v82, v83
    v_exp_f32 v85, v85
    v_exp_f32 v86, v86
    v_cvt_pk_bf16_f32 v62, v84, v85
    v_exp_f32 v87, v87
    v_exp_f32 v88, v88
    v_cvt_pk_bf16_f32 v63, v86, v87
    s_waitcnt vmcnt(2)
    v_mfma_f32_32x32x8_bf16 v[72:87], v[38:39], v[20:21], 0
    buffer_load_dwordx4 v[28:31], v1, s[4:7], s24 offen
    v_exp_f32 v89, v89
    v_exp_f32 v90, v90
    v_cvt_pk_bf16_f32 v64, v88, v89
    v_exp_f32 v91, v91
    v_exp_f32 v92, v92
    v_mfma_f32_32x32x16_bf16 v[72:87], v[32:35], v[4:7], v[72:87]
    buffer_load_dword v36, v2, s[4:7], s24 offen
    s_add_u32 s24, s24, 2560
    v_cvt_pk_bf16_f32 v65, v90, v91
    v_exp_f32 v93, v93
    v_exp_f32 v94, v94
    v_cvt_pk_bf16_f32 v66, v92, v93
    v_exp_f32 v95, v95
    v_exp_f32 v96, v96
    v_mfma_f32_32x32x16_bf16 v[136:151], v[40:43], v[56:59], v[136:151]
    s_load_dword s3, s[100:101], s47
    s_add_u32 s47, s47, 128
    s_min_u32 s47, s47, s52
    v_cvt_pk_bf16_f32 v67, v94, v95
    v_exp_f32 v97, v97
    v_exp_f32 v98, v98
    v_cvt_pk_bf16_f32 v68, v96, v97
    v_exp_f32 v99, v99
    v_exp_f32 v100, v100
    v_mfma_f32_32x32x16_bf16 v[136:151], v[44:47], v[60:63], v[136:151]
    v_cvt_pk_bf16_f32 v69, v98, v99
    v_exp_f32 v101, v101
    v_exp_f32 v102, v102
    v_cvt_pk_bf16_f32 v70, v100, v101
    v_exp_f32 v103, v103
    v_exp_f32 v72, v72
    v_cvt_pk_bf16_f32 v71, v102, v103
    v_mfma_f32_32x32x8_bf16 v[88:103], v[38:39], v[22:23], 0
    v_exp_f32 v73, v73
    v_exp_f32 v74, v74
    v_cvt_pk_bf16_f32 v56, v72, v73
    v_exp_f32 v75, v75
    v_exp_f32 v76, v76
    v_mfma_f32_32x32x16_bf16 v[88:103], v[32:35], v[8:11], v[88:103]
    v_cvt_pk_bf16_f32 v57, v74, v75
    v_exp_f32 v77, v77
    v_exp_f32 v78, v78
    v_cvt_pk_bf16_f32 v58, v76, v77
    v_exp_f32 v79, v79
    v_exp_f32 v80, v80
    v_mfma_f32_32x32x16_bf16 v[152:167], v[40:43], v[64:67], v[152:167]
    s_load_dword s3, s[100:101], s47
    s_add_u32 s47, s47, 128
    s_min_u32 s47, s47, s52
    v_cvt_pk_bf16_f32 v59, v78, v79
    v_exp_f32 v81, v81
    v_exp_f32 v82, v82
    v_cvt_pk_bf16_f32 v60, v80, v81
    v_exp_f32 v83, v83
    v_exp_f32 v84, v84
    v_mfma_f32_32x32x16_bf16 v[152:167], v[44:47], v[68:71], v[152:167]
    v_cvt_pk_bf16_f32 v61, v82, v83
    v_exp_f32 v85, v85
    v_exp_f32 v86, v86
    v_cvt_pk_bf16_f32 v62, v84, v85
    v_exp_f32 v87, v87
    v_exp_f32 v88, v88
    v_cvt_pk_bf16_f32 v63, v86, v87
    v_mfma_f32_32x32x8_bf16 v[72:87], v[38:39], v[24:25], 0
    v_exp_f32 v89, v89
    v_exp_f32 v90, v90
    v_cvt_pk_bf16_f32 v64, v88, v89
    v_exp_f32 v91, v91
    v_exp_f32 v92, v92
    v_mfma_f32_32x32x16_bf16 v[72:87], v[32:35], v[12:15], v[72:87]
    v_cvt_pk_bf16_f32 v65, v90, v91
    v_exp_f32 v93, v93
    v_exp_f32 v94, v94
    v_cvt_pk_bf16_f32 v66, v92, v93
    v_exp_f32 v95, v95
    v_exp_f32 v96, v96
    s_waitcnt vmcnt(2)
    v_mfma_f32_32x32x16_bf16 v[104:119], v[48:51], v[56:59], v[104:119]
    s_load_dword s3, s[100:101], s47
    s_add_u32 s47, s47, 128
    s_min_u32 s47, s47, s52
    v_cvt_pk_bf16_f32 v67, v94, v95
    v_exp_f32 v97, v97
    v_exp_f32 v98, v98
    v_cvt_pk_bf16_f32 v68, v96, v97
    v_exp_f32 v99, v99
    v_exp_f32 v100, v100
    v_mfma_f32_32x32x16_bf16 v[104:119], v[52:55], v[60:63], v[104:119]
    s_mov_b64 exec, s[14:15]
    buffer_load_dwordx4 v[40:43], v3, s[4:7], s23 offen
    buffer_load_dwordx4 v[44:47], v3, s[4:7], s23 offen offset:640
    s_mov_b64 exec, -1
    s_add_u32 s23, s23, 2560
    v_cvt_pk_bf16_f32 v69, v98, v99
    v_exp_f32 v101, v101
    v_exp_f32 v102, v102
    v_cvt_pk_bf16_f32 v70, v100, v101
    v_exp_f32 v103, v103
    v_exp_f32 v72, v72
    v_cvt_pk_bf16_f32 v71, v102, v103
    v_mfma_f32_32x32x8_bf16 v[88:103], v[38:39], v[26:27], 0
    v_exp_f32 v73, v73
    v_exp_f32 v74, v74
    v_cvt_pk_bf16_f32 v56, v72, v73
    v_exp_f32 v75, v75
    v_exp_f32 v76, v76
    v_mfma_f32_32x32x16_bf16 v[88:103], v[32:35], v[16:19], v[88:103]
    v_cvt_pk_bf16_f32 v57, v74, v75
    v_exp_f32 v77, v77
    v_exp_f32 v78, v78
    v_cvt_pk_bf16_f32 v58, v76, v77
    v_exp_f32 v79, v79
    v_exp_f32 v80, v80
    v_mfma_f32_32x32x16_bf16 v[120:135], v[48:51], v[64:67], v[120:135]
    s_load_dword s3, s[100:101], s47
    s_add_u32 s47, s47, 128
    s_min_u32 s47, s47, s52
    v_cvt_pk_bf16_f32 v59, v78, v79
    v_exp_f32 v81, v81
    v_exp_f32 v82, v82
    v_cvt_pk_bf16_f32 v60, v80, v81
    v_exp_f32 v83, v83
    v_exp_f32 v84, v84
    v_mfma_f32_32x32x16_bf16 v[120:135], v[52:55], v[68:71], v[120:135]
    v_cvt_pk_bf16_f32 v61, v82, v83
    v_exp_f32 v85, v85
    v_exp_f32 v86, v86
    v_cvt_pk_bf16_f32 v62, v84, v85
    v_exp_f32 v87, v87
    v_exp_f32 v88, v88
    v_cvt_pk_bf16_f32 v63, v86, v87
    s_waitcnt vmcnt(2)
    v_mfma_f32_32x32x8_bf16 v[72:87], v[36:37], v[20:21], 0
    buffer_load_dwordx4 v[32:35], v1, s[4:7], s24 offen
    v_exp_f32 v89, v89
    v_exp_f32 v90, v90
    v_cvt_pk_bf16_f32 v64, v88, v89
    v_exp_f32 v91, v91
    v_exp_f32 v92, v92
    v_mfma_f32_32x32x16_bf16 v[72:87], v[28:31], v[4:7], v[72:87]
    buffer_load_dword v38, v2, s[4:7], s24 offen
    s_add_u32 s24, s24, 2560
    v_cvt_pk_bf16_f32 v65, v90, v91
    v_exp_f32 v93, v93
    v_exp_f32 v94, v94
    v_cvt_pk_bf16_f32 v66, v92, v93
    v_exp_f32 v95, v95
    v_exp_f32 v96, v96
    v_mfma_f32_32x32x16_bf16 v[136:151], v[48:51], v[56:59], v[136:151]
    s_load_dword s3, s[100:101], s47
    s_add_u32 s47, s47, 128
    s_min_u32 s47, s47, s52
    v_cvt_pk_bf16_f32 v67, v94, v95
    v_exp_f32 v97, v97
    v_exp_f32 v98, v98
    v_cvt_pk_bf16_f32 v68, v96, v97
    v_exp_f32 v99, v99
    v_exp_f32 v100, v100
    v_mfma_f32_32x32x16_bf16 v[136:151], v[52:55], v[60:63], v[136:151]
    v_cvt_pk_bf16_f32 v69, v98, v99
    v_exp_f32 v101, v101
    v_exp_f32 v102, v102
    v_cvt_pk_bf16_f32 v70, v100, v101
    v_exp_f32 v103, v103
    s_mov_b32 s12, 0
.p2align 6
L_mk_loop:
    v_exp_f32 v72, v72
    v_cvt_pk_bf16_f32 v71, v102, v103
    v_mfma_f32_32x32x8_bf16 v[88:103], v[36:37], v[22:23], 0
    v_exp_f32 v73, v73
    v_exp_f32 v74, v74
    v_cvt_pk_bf16_f32 v56, v72, v73
    v_exp_f32 v75, v75
    v_exp_f32 v76, v76
    v_mfma_f32_32x32x16_bf16 v[88:103], v[28:31], v[8:11], v[88:103]
    v_cvt_pk_bf16_f32 v57, v74, v75
    v_exp_f32 v77, v77
    v_exp_f32 v78, v78
    v_cvt_pk_bf16_f32 v58, v76, v77
    v_exp_f32 v79, v79
    v_exp_f32 v80, v80
    v_mfma_f32_32x32x16_bf16 v[152:167], v[48:51], v[64:67], v[152:167]
    s_load_dword s3, s[100:101], s47
    s_add_u32 s47, s47, 128
    s_min_u32 s47, s47, s52
    v_cvt_pk_bf16_f32 v59, v78, v79
    v_exp_f32 v81, v81
    v_exp_f32 v82, v82
    v_cvt_pk_bf16_f32 v60, v80, v81
    v_exp_f32 v83, v83
    v_exp_f32 v84, v84
    v_mfma_f32_32x32x16_bf16 v[152:167], v[52:55], v[68:71], v[152:167]
    v_cvt_pk_bf16_f32 v61, v82, v83
    v_exp_f32 v85, v85
    v_exp_f32 v86, v86
    v_cvt_pk_bf16_f32 v62, v84, v85
    v_exp_f32 v87, v87
    v_exp_f32 v88, v88
    v_cvt_pk_bf16_f32 v63, v86, v87
    v_mfma_f32_32x32x8_bf16 v[72:87], v[36:37], v[24:25], 0
    v_exp_f32 v89, v89
    v_exp_f32 v90, v90
    v_cvt_pk_bf16_f32 v64, v88, v89
    v_exp_f32 v91, v91
    v_exp_f32 v92, v92
    v_mfma_f32_32x32x16_bf16 v[72:87], v[28:31], v[12:15], v[72:87]
    v_cvt_pk_bf16_f32 v65, v90, v91
    v_exp_f32 v93, v93
    v_exp_f32 v94, v94
    v_cvt_pk_bf16_f32 v66, v92, v93
    v_exp_f32 v95, v95
    v_exp_f32 v96, v96
    s_waitcnt vmcnt(2)
    v_mfma_f32_32x32x16_bf16 v[104:119], v[40:43], v[56:59], v[104:119]
    s_load_dword s3, s[100:101], s47
    s_add_u32 s47, s47, 128
    s_min_u32 s47, s47, s52
    v_cvt_pk_bf16_f32 v67, v94, v95
    v_exp_f32 v97, v97
    v_exp_f32 v98, v98
    v_cvt_pk_bf16_f32 v68, v96, v97
    v_exp_f32 v99, v99
    v_exp_f32 v100, v100
    v_mfma_f32_32x32x16_bf16 v[104:119], v[44:47], v[60:63], v[104:119]
    s_mov_b64 exec, s[14:15]
    buffer_load_dwordx4 v[48:51], v3, s[4:7], s23 offen
    buffer_load_dwordx4 v[52:55], v3, s[4:7], s23 offen offset:640
    s_mov_b64 exec, -1
    s_add_u32 s23, s23, 2560
    v_cvt_pk_bf16_f32 v69, v98, v99
    v_exp_f32 v101, v101
    v_exp_f32 v102, v102
    v_cvt_pk_bf16_f32 v70, v100, v101
    v_exp_f32 v103, v103
    v_exp_f32 v72, v72
    v_cvt_pk_bf16_f32 v71, v102, v103
    v_mfma_f32_32x32x8_bf16 v[88:103], v[36:37], v[26:27], 0
    v_exp_f32 v73, v73
    v_exp_f32 v74, v74
    v_cvt_pk_bf16_f32 v56, v72, v73
    v_exp_f32 v75, v75
    v_exp_f32 v76, v76
    v_mfma_f32_32x32x16_bf16 v[88:103], v[28:31], v[16:19], v[88:103]
    v_cvt_pk_bf16_f32 v57, v74, v75
    v_exp_f32 v77, v77
    v_exp_f32 v78, v78
    v_cvt_pk_bf16_f32 v58, v76, v77
    v_exp_f32 v79, v79
    v_exp_f32 v80, v80
    v_mfma_f32_32x32x16_bf16 v[120:135], v[40:43], v[64:67], v[120:135]
    s_load_dword s3, s[100:101], s47
    s_add_u32 s47, s47, 128
    s_min_u32 s47, s47, s52
    v_cvt_pk_bf16_f32 v59, v78, v79
    v_exp_f32 v81, v81
    v_exp_f32 v82, v82
    v_cvt_pk_bf16_f32 v60, v80, v81
    v_exp_f32 v83, v83
    v_exp_f32 v84, v84
    v_mfma_f32_32x32x16_bf16 v[120:135], v[44:47], v[68:71], v[120:135]
    v_cvt_pk_bf16_f32 v61, v82, v83
    v_exp_f32 v85, v85
    v_exp_f32 v86, v86
    v_cvt_pk_bf16_f32 v62, v84, v85
    v_exp_f32 v87, v87
    v_exp_f32 v88, v88
    v_cvt_pk_bf16_f32 v63, v86, v87
    s_waitcnt vmcnt(2)
    v_mfma_f32_32x32x8_bf16 v[72:87], v[38:39], v[20:21], 0
    buffer_load_dwordx4 v[28:31], v1, s[4:7], s24 offen
    v_exp_f32 v89, v89
    v_exp_f32 v90, v90
    v_cvt_pk_bf16_f32 v64, v88, v89
    v_exp_f32 v91, v91
    v_exp_f32 v92, v92
    v_mfma_f32_32x32x16_bf16 v[72:87], v[32:35], v[4:7], v[72:87]
    buffer_load_dword v36, v2, s[4:7], s24 offen
    s_add_u32 s24, s24, 2560
    v_cvt_pk_bf16_f32 v65, v90, v91
    v_exp_f32 v93, v93
    v_exp_f32 v94, v94
    v_cvt_pk_bf16_f32 v66, v92, v93
    v_exp_f32 v95, v95
    v_exp_f32 v96, v96
    v_mfma_f32_32x32x16_bf16 v[136:151], v[40:43], v[56:59], v[136:151]
    s_load_dword s3, s[100:101], s47
    s_add_u32 s47, s47, 128
    s_min_u32 s47, s47, s52
    v_cvt_pk_bf16_f32 v67, v94, v95
    v_exp_f32 v97, v97
    v_exp_f32 v98, v98
    v_cvt_pk_bf16_f32 v68, v96, v97
    v_exp_f32 v99, v99
    v_exp_f32 v100, v100
    v_mfma_f32_32x32x16_bf16 v[136:151], v[44:47], v[60:63], v[136:151]
    v_cvt_pk_bf16_f32 v69, v98, v99
    v_exp_f32 v101, v101
    v_exp_f32 v102, v102
    v_cvt_pk_bf16_f32 v70, v100, v101
    v_exp_f32 v103, v103
    v_exp_f32 v72, v72
    v_cvt_pk_bf16_f32 v71, v102, v103
    v_mfma_f32_32x32x8_bf16 v[88:103], v[38:39], v[22:23], 0
    v_exp_f32 v73, v73
    v_exp_f32 v74, v74
    v_cvt_pk_bf16_f32 v56, v72, v73
    v_exp_f32 v75, v75
    v_exp_f32 v76, v76
    v_mfma_f32_32x32x16_bf16 v[88:103], v[32:35], v[8:11], v[88:103]
    v_cvt_pk_bf16_f32 v57, v74, v75
    v_exp_f32 v77, v77
    v_exp_f32 v78, v78
    v_cvt_pk_bf16_f32 v58, v76, v77
    v_exp_f32 v79, v79
    v_exp_f32 v80, v80
    v_mfma_f32_32x32x16_bf16 v[152:167], v[40:43], v[64:67], v[152:167]
    s_load_dword s3, s[100:101], s47
    s_add_u32 s47, s47, 128
    s_min_u32 s47, s47, s52
    v_cvt_pk_bf16_f32 v59, v78, v79
    v_exp_f32 v81, v81
    v_exp_f32 v82, v82
    v_cvt_pk_bf16_f32 v60, v80, v81
    v_exp_f32 v83, v83
    v_exp_f32 v84, v84
    v_mfma_f32_32x32x16_bf16 v[152:167], v[44:47], v[68:71], v[152:167]
    v_cvt_pk_bf16_f32 v61, v82, v83
    v_exp_f32 v85, v85
    v_exp_f32 v86, v86
    v_cvt_pk_bf16_f32 v62, v84, v85
    v_exp_f32 v87, v87
    v_exp_f32 v88, v88
    v_cvt_pk_bf16_f32 v63, v86, v87
    v_mfma_f32_32x32x8_bf16 v[72:87], v[38:39], v[24:25], 0
    v_exp_f32 v89, v89
    v_exp_f32 v90, v90
    v_cvt_pk_bf16_f32 v64, v88, v89
    v_exp_f32 v91, v91
    v_exp_f32 v92, v92
    v_mfma_f32_32x32x16_bf16 v[72:87], v[32:35], v[12:15], v[72:87]
    v_cvt_pk_bf16_f32 v65, v90, v91
    v_exp_f32 v93, v93
    v_exp_f32 v94, v94
    v_cvt_pk_bf16_f32 v66, v92, v93
    v_exp_f32 v95, v95
    v_exp_f32 v96, v96
    s_waitcnt vmcnt(2)
    v_mfma_f32_32x32x16_bf16 v[104:119], v[48:51], v[56:59], v[104:119]
    s_load_dword s3, s[100:101], s47
    s_add_u32 s47, s47, 128
    s_min_u32 s47, s47, s52
    v_cvt_pk_bf16_f32 v67, v94, v95
    v_exp_f32 v97, v97
    v_exp_f32 v98, v98
    v_cvt_pk_bf16_f32 v68, v96, v97
    v_exp_f32 v99, v99
    v_exp_f32 v100, v100
    v_mfma_f32_32x32x16_bf16 v[104:119], v[52:55], v[60:63], v[104:119]
    s_mov_b64 exec, s[14:15]
    buffer_load_dwordx4 v[40:43], v3, s[4:7], s23 offen
    buffer_load_dwordx4 v[44:47], v3, s[4:7], s23 offen offset:640
    s_mov_b64 exec, -1
    s_add_u32 s23, s23, 2560
    v_cvt_pk_bf16_f32 v69, v98, v99
    v_exp_f32 v101, v101
    v_exp_f32 v102, v102
    v_cvt_pk_bf16_f32 v70, v100, v101
    v_exp_f32 v103, v103
    v_exp_f32 v72, v72
    v_cvt_pk_bf16_f32 v71, v102, v103
    v_mfma_f32_32x32x8_bf16 v[88:103], v[38:39], v[26:27], 0
    v_exp_f32 v73, v73
    v_exp_f32 v74, v74
    v_cvt_pk_bf16_f32 v56, v72, v73
    v_exp_f32 v75, v75
    v_exp_f32 v76, v76
    v_mfma_f32_32x32x16_bf16 v[88:103], v[32:35], v[16:19], v[88:103]
    v_cvt_pk_bf16_f32 v57, v74, v75
    v_exp_f32 v77, v77
    v_exp_f32 v78, v78
    v_cvt_pk_bf16_f32 v58, v76, v77
    v_exp_f32 v79, v79
    v_exp_f32 v80, v80
    v_mfma_f32_32x32x16_bf16 v[120:135], v[48:51], v[64:67], v[120:135]
    s_load_dword s3, s[100:101], s47
    s_add_u32 s47, s47, 128
    s_min_u32 s47, s47, s52
    v_cvt_pk_bf16_f32 v59, v78, v79
    v_exp_f32 v81, v81
    v_exp_f32 v82, v82
    v_cvt_pk_bf16_f32 v60, v80, v81
    v_exp_f32 v83, v83
    v_exp_f32 v84, v84
    v_mfma_f32_32x32x16_bf16 v[120:135], v[52:55], v[68:71], v[120:135]
    v_cvt_pk_bf16_f32 v61, v82, v83
    v_exp_f32 v85, v85
    v_exp_f32 v86, v86
    v_cvt_pk_bf16_f32 v62, v84, v85
    v_exp_f32 v87, v87
    v_exp_f32 v88, v88
    v_cvt_pk_bf16_f32 v63, v86, v87
    s_waitcnt vmcnt(2)
    v_mfma_f32_32x32x8_bf16 v[72:87], v[36:37], v[20:21], 0
    buffer_load_dwordx4 v[32:35], v1, s[4:7], s24 offen
    v_exp_f32 v89, v89
    v_exp_f32 v90, v90
    v_cvt_pk_bf16_f32 v64, v88, v89
    v_exp_f32 v91, v91
    v_exp_f32 v92, v92
    v_mfma_f32_32x32x16_bf16 v[72:87], v[28:31], v[4:7], v[72:87]
    buffer_load_dword v38, v2, s[4:7], s24 offen
    s_add_u32 s24, s24, 2560
    v_cvt_pk_bf16_f32 v65, v90, v91
    v_exp_f32 v93, v93
    v_exp_f32 v94, v94
    v_cvt_pk_bf16_f32 v66, v92, v93
    v_exp_f32 v95, v95
    v_exp_f32 v96, v96
    v_mfma_f32_32x32x16_bf16 v[136:151], v[48:51], v[56:59], v[136:151]
    s_load_dword s3, s[100:101], s47
    s_add_u32 s47, s47, 128
    s_min_u32 s47, s47, s52
    v_cvt_pk_bf16_f32 v67, v94, v95
    v_exp_f32 v97, v97
    v_exp_f32 v98, v98
    v_cvt_pk_bf16_f32 v68, v96, v97
    v_exp_f32 v99, v99
    v_exp_f32 v100, v100
    v_mfma_f32_32x32x16_bf16 v[136:151], v[52:55], v[60:63], v[136:151]
    v_cvt_pk_bf16_f32 v69, v98, v99
    v_exp_f32 v101, v101
    v_exp_f32 v102, v102
    v_cvt_pk_bf16_f32 v70, v100, v101
    v_exp_f32 v103, v103
    v_exp_f32 v72, v72
    v_cvt_pk_bf16_f32 v71, v102, v103
    v_mfma_f32_32x32x8_bf16 v[88:103], v[36:37], v[22:23], 0
    v_exp_f32 v73, v73
    v_exp_f32 v74, v74
    v_cvt_pk_bf16_f32 v56, v72, v73
    v_exp_f32 v75, v75
    v_exp_f32 v76, v76
    v_mfma_f32_32x32x16_bf16 v[88:103], v[28:31], v[8:11], v[88:103]
    v_cvt_pk_bf16_f32 v57, v74, v75
    v_exp_f32 v77, v77
    v_exp_f32 v78, v78
    v_cvt_pk_bf16_f32 v58, v76, v77
    v_exp_f32 v79, v79
    v_exp_f32 v80, v80
    v_mfma_f32_32x32x16_bf16 v[152:167], v[48:51], v[64:67], v[152:167]
    s_load_dword s3, s[100:101], s47
    s_add_u32 s47, s47, 128
    s_min_u32 s47, s47, s52
    v_cvt_pk_bf16_f32 v59, v78, v79
    v_exp_f32 v81, v81
    v_exp_f32 v82, v82
    v_cvt_pk_bf16_f32 v60, v80, v81
    v_exp_f32 v83, v83
    v_exp_f32 v84, v84
    v_mfma_f32_32x32x16_bf16 v[152:167], v[52:55], v[68:71], v[152:167]
    v_cvt_pk_bf16_f32 v61, v82, v83
    v_exp_f32 v85, v85
    v_exp_f32 v86, v86
    v_cvt_pk_bf16_f32 v62, v84, v85
    v_exp_f32 v87, v87
    v_exp_f32 v88, v88
    v_cvt_pk_bf16_f32 v63, v86, v87
    v_mfma_f32_32x32x8_bf16 v[72:87], v[36:37], v[24:25], 0
    v_exp_f32 v89, v89
    v_exp_f32 v90, v90
    v_cvt_pk_bf16_f32 v64, v88, v89
    v_exp_f32 v91, v91
    v_exp_f32 v92, v92
    v_mfma_f32_32x32x16_bf16 v[72:87], v[28:31], v[12:15], v[72:87]
    v_cvt_pk_bf16_f32 v65, v90, v91
    v_exp_f32 v93, v93
    v_exp_f32 v94, v94
    v_cvt_pk_bf16_f32 v66, v92, v93
    v_exp_f32 v95, v95
    v_exp_f32 v96, v96
    s_waitcnt vmcnt(2)
    v_mfma_f32_32x32x16_bf16 v[104:119], v[40:43], v[56:59], v[104:119]
    s_load_dword s3, s[100:101], s47
    s_add_u32 s47, s47, 128
    s_min_u32 s47, s47, s52
    v_cvt_pk_bf16_f32 v67, v94, v95
    v_exp_f32 v97, v97
    v_exp_f32 v98, v98
    v_cvt_pk_bf16_f32 v68, v96, v97
    v_exp_f32 v99, v99
    v_exp_f32 v100, v100
    v_mfma_f32_32x32x16_bf16 v[104:119], v[44:47], v[60:63], v[104:119]
    s_mov_b64 exec, s[14:15]
    buffer_load_dwordx4 v[48:51], v3, s[4:7], s23 offen
    buffer_load_dwordx4 v[52:55], v3, s[4:7], s23 offen offset:640
    s_mov_b64 exec, -1
    s_add_u32 s23, s23, 2560
    v_cvt_pk_bf16_f32 v69, v98, v99
    v_exp_f32 v101, v101
    v_exp_f32 v102, v102
    v_cvt_pk_bf16_f32 v70, v100, v101
    v_exp_f32 v103, v103
    v_exp_f32 v72, v72
    v_cvt_pk_bf16_f32 v71, v102, v103
    v_mfma_f32_32x32x8_bf16 v[88:103], v[36:37], v[26:27], 0
    v_exp_f32 v73, v73
    v_exp_f32 v74, v74
    v_cvt_pk_bf16_f32 v56, v72, v73
    v_exp_f32 v75, v75
    v_exp_f32 v76, v76
    v_mfma_f32_32x32x16_bf16 v[88:103], v[28:31], v[16:19], v[88:103]
    v_cvt_pk_bf16_f32 v57, v74, v75
    v_exp_f32 v77, v77
    v_exp_f32 v78, v78
    v_cvt_pk_bf16_f32 v58, v76, v77
    v_exp_f32 v79, v79
    v_exp_f32 v80, v80
    v_mfma_f32_32x32x16_bf16 v[120:135], v[40:43], v[64:67], v[120:135]
    s_load_dword s3, s[100:101], s47
    s_add_u32 s47, s47, 128
    s_min_u32 s47, s47, s52
    v_cvt_pk_bf16_f32 v59, v78, v79
    v_exp_f32 v81, v81
    v_exp_f32 v82, v82
    v_cvt_pk_bf16_f32 v60, v80, v81
    v_exp_f32 v83, v83
    v_exp_f32 v84, v84
    v_mfma_f32_32x32x16_bf16 v[120:135], v[44:47], v[68:71], v[120:135]
    v_cvt_pk_bf16_f32 v61, v82, v83
    v_exp_f32 v85, v85
    v_exp_f32 v86, v86
    v_cvt_pk_bf16_f32 v62, v84, v85
    v_exp_f32 v87, v87
    v_exp_f32 v88, v88
    v_cvt_pk_bf16_f32 v63, v86, v87
    s_waitcnt vmcnt(2)
    v_mfma_f32_32x32x8_bf16 v[72:87], v[38:39], v[20:21], 0
    buffer_load_dwordx4 v[28:31], v1, s[4:7], s24 offen
    v_exp_f32 v89, v89
    v_exp_f32 v90, v90
    v_cvt_pk_bf16_f32 v64, v88, v89
    v_exp_f32 v91, v91
    v_exp_f32 v92, v92
    v_mfma_f32_32x32x16_bf16 v[72:87], v[32:35], v[4:7], v[72:87]
    buffer_load_dword v36, v2, s[4:7], s24 offen
    s_add_u32 s24, s24, 2560
    v_cvt_pk_bf16_f32 v65, v90, v91
    v_exp_f32 v93, v93
    v_exp_f32 v94, v94
    v_cvt_pk_bf16_f32 v66, v92, v93
    v_exp_f32 v95, v95
    v_exp_f32 v96, v96
    v_mfma_f32_32x32x16_bf16 v[136:151], v[40:43], v[56:59], v[136:151]
    s_load_dword s3, s[100:101], s47
    s_add_u32 s47, s47, 128
    s_min_u32 s47, s47, s52
    v_cvt_pk_bf16_f32 v67, v94, v95
    v_exp_f32 v97, v97
    v_exp_f32 v98, v98
    v_cvt_pk_bf16_f32 v68, v96, v97
    v_exp_f32 v99, v99
    v_exp_f32 v100, v100
    v_mfma_f32_32x32x16_bf16 v[136:151], v[44:47], v[60:63], v[136:151]
    v_cvt_pk_bf16_f32 v69, v98, v99
    v_exp_f32 v101, v101
    v_exp_f32 v102, v102
    v_cvt_pk_bf16_f32 v70, v100, v101
    v_exp_f32 v103, v103
    v_exp_f32 v72, v72
    v_cvt_pk_bf16_f32 v71, v102, v103
    v_mfma_f32_32x32x8_bf16 v[88:103], v[38:39], v[22:23], 0
    v_exp_f32 v73, v73
    v_exp_f32 v74, v74
    v_cvt_pk_bf16_f32 v56, v72, v73
    v_exp_f32 v75, v75
    v_exp_f32 v76, v76
    v_mfma_f32_32x32x16_bf16 v[88:103], v[32:35], v[8:11], v[88:103]
    v_cvt_pk_bf16_f32 v57, v74, v75
    v_exp_f32 v77, v77
    v_exp_f32 v78, v78
    v_cvt_pk_bf16_f32 v58, v76, v77
    v_exp_f32 v79, v79
    v_exp_f32 v80, v80
    v_mfma_f32_32x32x16_bf16 v[152:167], v[40:43], v[64:67], v[152:167]
    s_load_dword s3, s[100:101], s47
    s_add_u32 s47, s47, 128
    s_min_u32 s47, s47, s52
    v_cvt_pk_bf16_f32 v59, v78, v79
    v_exp_f32 v81, v81
    v_exp_f32 v82, v82
    v_cvt_pk_bf16_f32 v60, v80, v81
    v_exp_f32 v83, v83
    v_exp_f32 v84, v84
    v_mfma_f32_32x32x16_bf16 v[152:167], v[44:47], v[68:71], v[152:167]
    v_cvt_pk_bf16_f32 v61, v82, v83
    v_exp_f32 v85, v85
    v_exp_f32 v86, v86
    v_cvt_pk_bf16_f32 v62, v84, v85
    v_exp_f32 v87, v87
    v_exp_f32 v88, v88
    v_cvt_pk_bf16_f32 v63, v86, v87
    v_mfma_f32_32x32x8_bf16 v[72:87], v[38:39], v[24:25], 0
    v_exp_f32 v89, v89
    v_exp_f32 v90, v90
    v_cvt_pk_bf16_f32 v64, v88, v89
    v_exp_f32 v91, v91
    v_exp_f32 v92, v92
    v_mfma_f32_32x32x16_bf16 v[72:87], v[32:35], v[12:15], v[72:87]
    v_cvt_pk_bf16_f32 v65, v90, v91
    v_exp_f32 v93, v93
    v_exp_f32 v94, v94
    v_cvt_pk_bf16_f32 v66, v92, v93
    v_exp_f32 v95, v95
    v_exp_f32 v96, v96
    s_waitcnt vmcnt(2)
    v_mfma_f32_32x32x16_bf16 v[104:119], v[48:51], v[56:59], v[104:119]
    s_load_dword s3, s[100:101], s47
    s_add_u32 s47, s47, 128
    s_min_u32 s47, s47, s52
    v_cvt_pk_bf16_f32 v67, v94, v95
    v_exp_f32 v97, v97
    v_exp_f32 v98, v98
    v_cvt_pk_bf16_f32 v68, v96, v97
    v_exp_f32 v99, v99
    v_exp_f32 v100, v100
    v_mfma_f32_32x32x16_bf16 v[104:119], v[52:55], v[60:63], v[104:119]
    s_mov_b64 exec, s[14:15]
    buffer_load_dwordx4 v[40:43], v3, s[4:7], s23 offen
    buffer_load_dwordx4 v[44:47], v3, s[4:7], s23 offen offset:640
    s_mov_b64 exec, -1
    s_add_u32 s23, s23, 2560
    v_cvt_pk_bf16_f32 v69, v98, v99
    v_exp_f32 v101, v101
    v_exp_f32 v102, v102
    v_cvt_pk_bf16_f32 v70, v100, v101
    v_exp_f32 v103, v103
    v_exp_f32 v72, v72
    v_cvt_pk_bf16_f32 v71, v102, v103
    v_mfma_f32_32x32x8_bf16 v[88:103], v[38:39], v[26:27], 0
    v_exp_f32 v73, v73
    v_exp_f32 v74, v74
    v_cvt_pk_bf16_f32 v56, v72, v73
    v_exp_f32 v75, v75
    v_exp_f32 v76, v76
    v_mfma_f32_32x32x16_bf16 v[88:103], v[32:35], v[16:19], v[88:103]
    v_cvt_pk_bf16_f32 v57, v74, v75
    v_exp_f32 v77, v77
    v_exp_f32 v78, v78
    v_cvt_pk_bf16_f32 v58, v76, v77
    v_exp_f32 v79, v79
    v_exp_f32 v80, v80
    v_mfma_f32_32x32x16_bf16 v[120:135], v[48:51], v[64:67], v[120:135]
    s_load_dword s3, s[100:101], s47
    s_add_u32 s47, s47, 128
    s_min_u32 s47, s47, s52
    v_cvt_pk_bf16_f32 v59, v78, v79
    v_exp_f32 v81, v81
    v_exp_f32 v82, v82
    v_cvt_pk_bf16_f32 v60, v80, v81
    v_exp_f32 v83, v83
    v_exp_f32 v84, v84
    v_mfma_f32_32x32x16_bf16 v[120:135], v[52:55], v[68:71], v[120:135]
    v_cvt_pk_bf16_f32 v61, v82, v83
    v_exp_f32 v85, v85
    v_exp_f32 v86, v86
    v_cvt_pk_bf16_f32 v62, v84, v85
    v_exp_f32 v87, v87
    v_exp_f32 v88, v88
    v_cvt_pk_bf16_f32 v63, v86, v87
    s_waitcnt vmcnt(2)
    v_mfma_f32_32x32x8_bf16 v[72:87], v[36:37], v[20:21], 0
    buffer_load_dwordx4 v[32:35], v1, s[4:7], s24 offen
    v_exp_f32 v89, v89
    v_exp_f32 v90, v90
    v_cvt_pk_bf16_f32 v64, v88, v89
    v_exp_f32 v91, v91
    v_exp_f32 v92, v92
    v_mfma_f32_32x32x16_bf16 v[72:87], v[28:31], v[4:7], v[72:87]
    buffer_load_dword v38, v2, s[4:7], s24 offen
    s_add_u32 s24, s24, 2560
    v_cvt_pk_bf16_f32 v65, v90, v91
    v_exp_f32 v93, v93
    v_exp_f32 v94, v94
    v_cvt_pk_bf16_f32 v66, v92, v93
    v_exp_f32 v95, v95
    v_exp_f32 v96, v96
    v_mfma_f32_32x32x16_bf16 v[136:151], v[48:51], v[56:59], v[136:151]
    s_load_dword s3, s[100:101], s47
    s_add_u32 s47, s47, 128
    s_min_u32 s47, s47, s52
    v_cvt_pk_bf16_f32 v67, v94, v95
    v_exp_f32 v97, v97
    v_exp_f32 v98, v98
    v_cvt_pk_bf16_f32 v68, v96, v97
    v_exp_f32 v99, v99
    v_exp_f32 v100, v100
    v_mfma_f32_32x32x16_bf16 v[136:151], v[52:55], v[60:63], v[136:151]
    v_cvt_pk_bf16_f32 v69, v98, v99
    v_exp_f32 v101, v101
    v_exp_f32 v102, v102
    v_cvt_pk_bf16_f32 v70, v100, v101
    v_exp_f32 v103, v103
    s_add_u32 s12, s12, 1
    s_cmp_lt_u32 s12, 3
    s_cbranch_scc1 L_mk_loop
    v_and_b32 v168, 63, v0
    v_mul_u32_u24 v168, 48, v168
    v_add_u32 v168, 69632, v168
    ds_read_b128 v[240:243], v168
    ds_read_b128 v[244:247], v168 offset:16
    ds_read_b64 v[248:249], v168 offset:32
    v_exp_f32 v72, v72
    v_cvt_pk_bf16_f32 v71, v102, v103
    v_mfma_f32_32x32x8_bf16 v[88:103], v[36:37], v[22:23], 0
    v_exp_f32 v73, v73
    v_exp_f32 v74, v74
    v_cvt_pk_bf16_f32 v56, v72, v73
    v_exp_f32 v75, v75
    v_exp_f32 v76, v76
    v_mfma_f32_32x32x16_bf16 v[88:103], v[28:31], v[8:11], v[88:103]
    v_cvt_pk_bf16_f32 v57, v74, v75
    v_exp_f32 v77, v77
    v_exp_f32 v78, v78
    v_cvt_pk_bf16_f32 v58, v76, v77
    v_exp_f32 v79, v79
    v_exp_f32 v80, v80
    v_mfma_f32_32x32x16_bf16 v[152:167], v[48:51], v[64:67], v[152:167]
    v_cvt_pk_bf16_f32 v59, v78, v79
    v_exp_f32 v81, v81
    v_exp_f32 v82, v82
    v_cvt_pk_bf16_f32 v60, v80, v81
    v_exp_f32 v83, v83
    v_exp_f32 v84, v84
    v_mfma_f32_32x32x16_bf16 v[152:167], v[52:55], v[68:71], v[152:167]
    v_cvt_pk_bf16_f32 v61, v82, v83
    v_exp_f32 v85, v85
    v_exp_f32 v86, v86
    v_cvt_pk_bf16_f32 v62, v84, v85
    v_exp_f32 v87, v87
    v_exp_f32 v88, v88
    v_cvt_pk_bf16_f32 v63, v86, v87
    v_mfma_f32_32x32x8_bf16 v[72:87], v[36:37], v[24:25], 0
    v_exp_f32 v89, v89
    v_exp_f32 v90, v90
    v_cvt_pk_bf16_f32 v64, v88, v89
    v_exp_f32 v91, v91
    v_exp_f32 v92, v92
    v_mfma_f32_32x32x16_bf16 v[72:87], v[28:31], v[12:15], v[72:87]
    v_cvt_pk_bf16_f32 v65, v90, v91
    v_exp_f32 v93, v93
    v_exp_f32 v94, v94
    v_cvt_pk_bf16_f32 v66, v92, v93
    v_exp_f32 v95, v95
    v_exp_f32 v96, v96
    s_waitcnt vmcnt(2)
    v_mfma_f32_32x32x16_bf16 v[104:119], v[40:43], v[56:59], v[104:119]
    v_cvt_pk_bf16_f32 v67, v94, v95
    v_exp_f32 v97, v97
    v_exp_f32 v98, v98
    v_cvt_pk_bf16_f32 v68, v96, v97
    v_exp_f32 v99, v99
    v_exp_f32 v100, v100
    v_mfma_f32_32x32x16_bf16 v[104:119], v[44:47], v[60:63], v[104:119]
    s_mov_b64 exec, s[14:15]
    buffer_load_dwordx4 v[48:51], v3, s[4:7], s23 offen
    buffer_load_dwordx4 v[52:55], v3, s[4:7], s23 offen offset:640
    s_mov_b64 exec, -1
    s_add_u32 s23, s23, 2560
    v_cvt_pk_bf16_f32 v69, v98, v99
    v_exp_f32 v101, v101
    v_exp_f32 v102, v102
    v_cvt_pk_bf16_f32 v70, v100, v101
    v_exp_f32 v103, v103
    v_exp_f32 v72, v72
    v_cvt_pk_bf16_f32 v71, v102, v103
    v_mfma_f32_32x32x8_bf16 v[88:103], v[36:37], v[26:27], 0
    v_exp_f32 v73, v73
    v_exp_f32 v74, v74
    v_cvt_pk_bf16_f32 v56, v72, v73
    v_exp_f32 v75, v75
    v_exp_f32 v76, v76
    v_mfma_f32_32x32x16_bf16 v[88:103], v[28:31], v[16:19], v[88:103]
    v_cvt_pk_bf16_f32 v57, v74, v75
    v_exp_f32 v77, v77
    v_exp_f32 v78, v78
    v_cvt_pk_bf16_f32 v58, v76, v77
    v_exp_f32 v79, v79
    v_exp_f32 v80, v80
    v_mfma_f32_32x32x16_bf16 v[120:135], v[40:43], v[64:67], v[120:135]
    s_waitcnt lgkmcnt(0)
    s_add_u32 m0, s44, 81920
    s_add_u32 s39, s98, 0
    s_and_b32 s39, s39, 7
    s_mul_i32 s39, s39, 102400
    s_add_u32 s39, s39, s45
    buffer_load_dwordx4 v240, s[40:43], s39 offen lds
    s_add_u32 m0, s44, 82944
    s_add_u32 s39, s98, 0
    s_and_b32 s39, s39, 7
    s_mul_i32 s39, s39, 102400
    s_add_u32 s39, s39, s45
    buffer_load_dwordx4 v241, s[40:43], s39 offen lds
    v_cvt_pk_bf16_f32 v59, v78, v79
    v_exp_f32 v81, v81
    v_exp_f32 v82, v82
    v_cvt_pk_bf16_f32 v60, v80, v81
    v_exp_f32 v83, v83
    v_exp_f32 v84, v84
    v_mfma_f32_32x32x16_bf16 v[120:135], v[44:47], v[68:71], v[120:135]
    v_cvt_pk_bf16_f32 v61, v82, v83
    v_exp_f32 v85, v85
    v_exp_f32 v86, v86
    v_cvt_pk_bf16_f32 v62, v84, v85
    v_exp_f32 v87, v87
    v_exp_f32 v88, v88
    v_cvt_pk_bf16_f32 v63, v86, v87
    s_waitcnt vmcnt(4)
    v_mfma_f32_32x32x8_bf16 v[72:87], v[38:39], v[20:21], 0
    buffer_load_dwordx4 v[28:31], v1, s[4:7], s24 offen
    v_exp_f32 v89, v89
    v_exp_f32 v90, v90
    v_cvt_pk_bf16_f32 v64, v88, v89
    v_exp_f32 v91, v91
    v_exp_f32 v92, v92
    v_mfma_f32_32x32x16_bf16 v[72:87], v[32:35], v[4:7], v[72:87]
    buffer_load_dword v36, v2, s[4:7], s24 offen
    s_add_u32 s24, s24, 2560
    v_cvt_pk_bf16_f32 v65, v90, v91
    v_exp_f32 v93, v93
    v_exp_f32 v94, v94
    v_cvt_pk_bf16_f32 v66, v92, v93
    v_exp_f32 v95, v95
    v_exp_f32 v96, v96
    v_mfma_f32_32x32x16_bf16 v[136:151], v[40:43], v[56:59], v[136:151]
    v_cvt_pk_bf16_f32 v67, v94, v95
    v_exp_f32 v97, v97
    v_exp_f32 v98, v98
    v_cvt_pk_bf16_f32 v68, v96, v97
    v_exp_f32 v99, v99
    v_exp_f32 v100, v100
    v_mfma_f32_32x32x16_bf16 v[136:151], v[44:47], v[60:63], v[136:151]
    v_cvt_pk_bf16_f32 v69, v98, v99
    v_exp_f32 v101, v101
    v_exp_f32 v102, v102
    v_cvt_pk_bf16_f32 v70, v100, v101
    v_exp_f32 v103, v103
    v_exp_f32 v72, v72
    v_cvt_pk_bf16_f32 v71, v102, v103
    v_mfma_f32_32x32x8_bf16 v[88:103], v[38:39], v[22:23], 0
    v_exp_f32 v73, v73
    v_exp_f32 v74, v74
    v_cvt_pk_bf16_f32 v56, v72, v73
    v_exp_f32 v75, v75
    v_exp_f32 v76, v76
    v_mfma_f32_32x32x16_bf16 v[88:103], v[32:35], v[8:11], v[88:103]
    v_cvt_pk_bf16_f32 v57, v74, v75
    v_exp_f32 v77, v77
    v_exp_f32 v78, v78
    v_cvt_pk_bf16_f32 v58, v76, v77
    v_exp_f32 v79, v79
    v_exp_f32 v80, v80
    v_mfma_f32_32x32x16_bf16 v[152:167], v[40:43], v[64:67], v[152:167]
    v_cvt_pk_bf16_f32 v59, v78, v79
    v_exp_f32 v81, v81
    v_exp_f32 v82, v82
    v_cvt_pk_bf16_f32 v60, v80, v81
    v_exp_f32 v83, v83
    v_exp_f32 v84, v84
    v_mfma_f32_32x32x16_bf16 v[152:167], v[44:47], v[68:71], v[152:167]
    v_cvt_pk_bf16_f32 v61, v82, v83
    v_exp_f32 v85, v85
    v_exp_f32 v86, v86
    v_cvt_pk_bf16_f32 v62, v84, v85
    v_exp_f32 v87, v87
    v_exp_f32 v88, v88
    v_cvt_pk_bf16_f32 v63, v86, v87
    v_mfma_f32_32x32x8_bf16 v[72:87], v[38:39], v[24:25], 0
    v_exp_f32 v89, v89
    v_exp_f32 v90, v90
    v_cvt_pk_bf16_f32 v64, v88, v89
    v_exp_f32 v91, v91
    v_exp_f32 v92, v92
    v_mfma_f32_32x32x16_bf16 v[72:87], v[32:35], v[12:15], v[72:87]
    v_cvt_pk_bf16_f32 v65, v90, v91
    v_exp_f32 v93, v93
    v_exp_f32 v94, v94
    v_cvt_pk_bf16_f32 v66, v92, v93
    v_exp_f32 v95, v95
    v_exp_f32 v96, v96
    s_waitcnt vmcnt(4)
    v_mfma_f32_32x32x16_bf16 v[104:119], v[48:51], v[56:59], v[104:119]
    v_cvt_pk_bf16_f32 v67, v94, v95
    v_exp_f32 v97, v97
    v_exp_f32 v98, v98
    v_cvt_pk_bf16_f32 v68, v96, v97
    v_exp_f32 v99, v99
    v_exp_f32 v100, v100
    v_mfma_f32_32x32x16_bf16 v[104:119], v[52:55], v[60:63], v[104:119]
    s_mov_b64 exec, s[14:15]
    buffer_load_dwordx4 v[40:43], v3, s[4:7], s23 offen
    buffer_load_dwordx4 v[44:47], v3, s[4:7], s23 offen offset:640
    s_mov_b64 exec, -1
    s_add_u32 s23, s23, 2560
    v_cvt_pk_bf16_f32 v69, v98, v99
    v_exp_f32 v101, v101
    v_exp_f32 v102, v102
    v_cvt_pk_bf16_f32 v70, v100, v101
    v_exp_f32 v103, v103
    v_exp_f32 v72, v72
    v_cvt_pk_bf16_f32 v71, v102, v103
    v_mfma_f32_32x32x8_bf16 v[88:103], v[38:39], v[26:27], 0
    v_exp_f32 v73, v73
    v_exp_f32 v74, v74
    v_cvt_pk_bf16_f32 v56, v72, v73
    v_exp_f32 v75, v75
    v_exp_f32 v76, v76
    v_mfma_f32_32x32x16_bf16 v[88:103], v[32:35], v[16:19], v[88:103]
    v_cvt_pk_bf16_f32 v57, v74, v75
    v_exp_f32 v77, v77
    v_exp_f32 v78, v78
    v_cvt_pk_bf16_f32 v58, v76, v77
    v_exp_f32 v79, v79
    v_exp_f32 v80, v80
    v_mfma_f32_32x32x16_bf16 v[120:135], v[48:51], v[64:67], v[120:135]
    s_add_u32 m0, s44, 83968
    s_add_u32 s39, s98, 0
    s_and_b32 s39, s39, 7
    s_mul_i32 s39, s39, 102400
    s_add_u32 s39, s39, s45
    buffer_load_dwordx4 v242, s[40:43], s39 offen lds
    s_add_u32 m0, s44, 84992
    s_add_u32 s39, s98, 0
    s_and_b32 s39, s39, 7
    s_mul_i32 s39, s39, 102400
    s_add_u32 s39, s39, s45
    buffer_load_dwordx4 v243, s[40:43], s39 offen lds
    v_cvt_pk_bf16_f32 v59, v78, v79
    v_exp_f32 v81, v81
    v_exp_f32 v82, v82
    v_cvt_pk_bf16_f32 v60, v80, v81
    v_exp_f32 v83, v83
    v_exp_f32 v84, v84
    v_mfma_f32_32x32x16_bf16 v[120:135], v[52:55], v[68:71], v[120:135]
    v_cvt_pk_bf16_f32 v61, v82, v83
    v_exp_f32 v85, v85
    v_exp_f32 v86, v86
    v_cvt_pk_bf16_f32 v62, v84, v85
    v_exp_f32 v87, v87
    v_exp_f32 v88, v88
    v_cvt_pk_bf16_f32 v63, v86, v87
    s_waitcnt vmcnt(4)
    v_mfma_f32_32x32x8_bf16 v[72:87], v[36:37], v[20:21], 0
    buffer_load_dwordx4 v[32:35], v1, s[4:7], s24 offen
    v_exp_f32 v89, v89
    v_exp_f32 v90, v90
    v_cvt_pk_bf16_f32 v64, v88, v89
    v_exp_f32 v91, v91
    v_exp_f32 v92, v92
    v_mfma_f32_32x32x16_bf16 v[72:87], v[28:31], v[4:7], v[72:87]
    buffer_load_dword v38, v2, s[4:7], s24 offen
    s_add_u32 s24, s24, 2560
    v_cvt_pk_bf16_f32 v65, v90, v91
    v_exp_f32 v93, v93
    v_exp_f32 v94, v94
    v_cvt_pk_bf16_f32 v66, v92, v93
    v_exp_f32 v95, v95
    v_exp_f32 v96, v96
    v_mfma_f32_32x32x16_bf16 v[136:151], v[48:51], v[56:59], v[136:151]
    v_cvt_pk_bf16_f32 v67, v94, v95
    v_exp_f32 v97, v97
    v_exp_f32 v98, v98
    v_cvt_pk_bf16_f32 v68, v96, v97
    v_exp_f32 v99, v99
    v_exp_f32 v100, v100
    v_mfma_f32_32x32x16_bf16 v[136:151], v[52:55], v[60:63], v[136:151]
    v_cvt_pk_bf16_f32 v69, v98, v99
    v_exp_f32 v101, v101
    v_exp_f32 v102, v102
    v_cvt_pk_bf16_f32 v70, v100, v101
    v_exp_f32 v103, v103
    v_exp_f32 v72, v72
    v_cvt_pk_bf16_f32 v71, v102, v103
    v_mfma_f32_32x32x8_bf16 v[88:103], v[36:37], v[22:23], 0
    v_exp_f32 v73, v73
    v_exp_f32 v74, v74
    v_cvt_pk_bf16_f32 v56, v72, v73
    v_exp_f32 v75, v75
    v_exp_f32 v76, v76
    v_mfma_f32_32x32x16_bf16 v[88:103], v[28:31], v[8:11], v[88:103]
    v_cvt_pk_bf16_f32 v57, v74, v75
    v_exp_f32 v77, v77
    v_exp_f32 v78, v78
    v_cvt_pk_bf16_f32 v58, v76, v77
    v_exp_f32 v79, v79
    v_exp_f32 v80, v80
    v_mfma_f32_32x32x16_bf16 v[152:167], v[48:51], v[64:67], v[152:167]
    v_cvt_pk_bf16_f32 v59, v78, v79
    v_exp_f32 v81, v81
    v_exp_f32 v82, v82
    v_cvt_pk_bf16_f32 v60, v80, v81
    v_exp_f32 v83, v83
    v_exp_f32 v84, v84
    v_mfma_f32_32x32x16_bf16 v[152:167], v[52:55], v[68:71], v[152:167]
    v_cvt_pk_bf16_f32 v61, v82, v83
    v_exp_f32 v85, v85
    v_exp_f32 v86, v86
    v_cvt_pk_bf16_f32 v62, v84, v85
    v_exp_f32 v87, v87
    v_exp_f32 v88, v88
    v_cvt_pk_bf16_f32 v63, v86, v87
    v_mfma_f32_32x32x8_bf16 v[72:87], v[36:37], v[24:25], 0
    v_exp_f32 v89, v89
    v_exp_f32 v90, v90
    v_cvt_pk_bf16_f32 v64, v88, v89
    v_exp_f32 v91, v91
    v_exp_f32 v92, v92
    v_mfma_f32_32x32x16_bf16 v[72:87], v[28:31], v[12:15], v[72:87]
    v_cvt_pk_bf16_f32 v65, v90, v91
    v_exp_f32 v93, v93
    v_exp_f32 v94, v94
    v_cvt_pk_bf16_f32 v66, v92, v93
    v_exp_f32 v95, v95
    v_exp_f32 v96, v96
    s_waitcnt vmcnt(4)
    v_mfma_f32_32x32x16_bf16 v[104:119], v[40:43], v[56:59], v[104:119]
    v_cvt_pk_bf16_f32 v67, v94, v95
    v_exp_f32 v97, v97
    v_exp_f32 v98, v98
    v_cvt_pk_bf16_f32 v68, v96, v97
    v_exp_f32 v99, v99
    v_exp_f32 v100, v100
    v_mfma_f32_32x32x16_bf16 v[104:119], v[44:47], v[60:63], v[104:119]
    s_mov_b64 exec, s[14:15]
    buffer_load_dwordx4 v[48:51], v3, s[4:7], s23 offen
    buffer_load_dwordx4 v[52:55], v3, s[4:7], s23 offen offset:640
    s_mov_b64 exec, -1
    s_add_u32 s23, s23, 2560
    v_cvt_pk_bf16_f32 v69, v98, v99
    v_exp_f32 v101, v101
    v_exp_f32 v102, v102
    v_cvt_pk_bf16_f32 v70, v100, v101
    v_exp_f32 v103, v103
    v_exp_f32 v72, v72
    v_cvt_pk_bf16_f32 v71, v102, v103
    v_mfma_f32_32x32x8_bf16 v[88:103], v[36:37], v[26:27], 0
    v_exp_f32 v73, v73
    v_exp_f32 v74, v74
    v_cvt_pk_bf16_f32 v56, v72, v73
    v_exp_f32 v75, v75
    v_exp_f32 v76, v76
    v_mfma_f32_32x32x16_bf16 v[88:103], v[28:31], v[16:19], v[88:103]
    v_cvt_pk_bf16_f32 v57, v74, v75
    v_exp_f32 v77, v77
    v_exp_f32 v78, v78
    v_cvt_pk_bf16_f32 v58, v76, v77
    v_exp_f32 v79, v79
    v_exp_f32 v80, v80
    v_mfma_f32_32x32x16_bf16 v[120:135], v[40:43], v[64:67], v[120:135]
    s_add_u32 m0, s44, 86016
    s_add_u32 s39, s98, 0
    s_and_b32 s39, s39, 7
    s_mul_i32 s39, s39, 102400
    s_add_u32 s39, s39, s45
    buffer_load_dwordx4 v244, s[40:43], s39 offen lds
    s_add_u32 m0, s44, 122880
    s_add_u32 s39, s98, 2
    s_and_b32 s39, s39, 7
    s_mul_i32 s39, s39, 102400
    s_add_u32 s39, s39, s45
    buffer_load_dwordx4 v240, s[40:43], s39 offen lds
    v_cvt_pk_bf16_f32 v59, v78, v79
    v_exp_f32 v81, v81
    v_exp_f32 v82, v82
    v_cvt_pk_bf16_f32 v60, v80, v81
    v_exp_f32 v83, v83
    v_exp_f32 v84, v84
    v_mfma_f32_32x32x16_bf16 v[120:135], v[44:47], v[68:71], v[120:135]
    v_cvt_pk_bf16_f32 v61, v82, v83
    v_exp_f32 v85, v85
    v_exp_f32 v86, v86
    v_cvt_pk_bf16_f32 v62, v84, v85
    v_exp_f32 v87, v87
    v_exp_f32 v88, v88
    v_cvt_pk_bf16_f32 v63, v86, v87
    s_waitcnt vmcnt(4)
    v_mfma_f32_32x32x8_bf16 v[72:87], v[38:39], v[20:21], 0
    buffer_load_dwordx4 v[28:31], v1, s[4:7], s24 offen
    v_exp_f32 v89, v89
    v_exp_f32 v90, v90
    v_cvt_pk_bf16_f32 v64, v88, v89
    v_exp_f32 v91, v91
    v_exp_f32 v92, v92
    v_mfma_f32_32x32x16_bf16 v[72:87], v[32:35], v[4:7], v[72:87]
    buffer_load_dword v36, v2, s[4:7], s24 offen
    s_add_u32 s24, s24, 2560
    v_cvt_pk_bf16_f32 v65, v90, v91
    v_exp_f32 v93, v93
    v_exp_f32 v94, v94
    v_cvt_pk_bf16_f32 v66, v92, v93
    v_exp_f32 v95, v95
    v_exp_f32 v96, v96
    v_mfma_f32_32x32x16_bf16 v[136:151], v[40:43], v[56:59], v[136:151]
    v_cvt_pk_bf16_f32 v67, v94, v95
    v_exp_f32 v97, v97
    v_exp_f32 v98, v98
    v_cvt_pk_bf16_f32 v68, v96, v97
    v_exp_f32 v99, v99
    v_exp_f32 v100, v100
    v_mfma_f32_32x32x16_bf16 v[136:151], v[44:47], v[60:63], v[136:151]
    v_cvt_pk_bf16_f32 v69, v98, v99
    v_exp_f32 v101, v101
    v_exp_f32 v102, v102
    v_cvt_pk_bf16_f32 v70, v100, v101
    v_exp_f32 v103, v103
    v_exp_f32 v72, v72
    v_cvt_pk_bf16_f32 v71, v102, v103
    v_mfma_f32_32x32x8_bf16 v[88:103], v[38:39], v[22:23], 0
    v_exp_f32 v73, v73
    v_exp_f32 v74, v74
    v_cvt_pk_bf16_f32 v56, v72, v73
    v_exp_f32 v75, v75
    v_exp_f32 v76, v76
    v_mfma_f32_32x32x16_bf16 v[88:103], v[32:35], v[8:11], v[88:103]
    v_cvt_pk_bf16_f32 v57, v74, v75
    v_exp_f32 v77, v77
    v_exp_f32 v78, v78
    v_cvt_pk_bf16_f32 v58, v76, v77
    v_exp_f32 v79, v79
    v_exp_f32 v80, v80
    v_mfma_f32_32x32x16_bf16 v[152:167], v[40:43], v[64:67], v[152:167]
    v_cvt_pk_bf16_f32 v59, v78, v79
    v_exp_f32 v81, v81
    v_exp_f32 v82, v82
    v_cvt_pk_bf16_f32 v60, v80, v81
    v_exp_f32 v83, v83
    v_exp_f32 v84, v84
    v_mfma_f32_32x32x16_bf16 v[152:167], v[44:47], v[68:71], v[152:167]
    v_cvt_pk_bf16_f32 v61, v82, v83
    v_exp_f32 v85, v85
    v_exp_f32 v86, v86
    v_cvt_pk_bf16_f32 v62, v84, v85
    v_exp_f32 v87, v87
    v_exp_f32 v88, v88
    v_cvt_pk_bf16_f32 v63, v86, v87
    v_mfma_f32_32x32x8_bf16 v[72:87], v[38:39], v[24:25], 0
    v_exp_f32 v89, v89
    v_exp_f32 v90, v90
    v_cvt_pk_bf16_f32 v64, v88, v89
    v_exp_f32 v91, v91
    v_exp_f32 v92, v92
    v_mfma_f32_32x32x16_bf16 v[72:87], v[32:35], v[12:15], v[72:87]
    v_cvt_pk_bf16_f32 v65, v90, v91
    v_exp_f32 v93, v93
    v_exp_f32 v94, v94
    v_cvt_pk_bf16_f32 v66, v92, v93
    v_exp_f32 v95, v95
    v_exp_f32 v96, v96
    s_waitcnt vmcnt(4)
    v_mfma_f32_32x32x16_bf16 v[104:119], v[48:51], v[56:59], v[104:119]
    v_cvt_pk_bf16_f32 v67, v94, v95
    v_exp_f32 v97, v97
    v_exp_f32 v98, v98
    v_cvt_pk_bf16_f32 v68, v96, v97
    v_exp_f32 v99, v99
    v_exp_f32 v100, v100
    v_mfma_f32_32x32x16_bf16 v[104:119], v[52:55], v[60:63], v[104:119]
    s_mov_b64 exec, s[14:15]
    buffer_load_dwordx4 v[40:43], v3, s[4:7], s23 offen
    buffer_load_dwordx4 v[44:47], v3, s[4:7], s23 offen offset:640
    s_mov_b64 exec, -1
    s_add_u32 s23, s23, 2560
    v_cvt_pk_bf16_f32 v69, v98, v99
    v_exp_f32 v101, v101
    v_exp_f32 v102, v102
    v_cvt_pk_bf16_f32 v70, v100, v101
    v_exp_f32 v103, v103
    v_exp_f32 v72, v72
    v_cvt_pk_bf16_f32 v71, v102, v103
    v_mfma_f32_32x32x8_bf16 v[88:103], v[38:39], v[26:27], 0
    v_exp_f32 v73, v73
    v_exp_f32 v74, v74
    v_cvt_pk_bf16_f32 v56, v72, v73
    v_exp_f32 v75, v75
    v_exp_f32 v76, v76
    v_mfma_f32_32x32x16_bf16 v[88:103], v[32:35], v[16:19], v[88:103]
    v_cvt_pk_bf16_f32 v57, v74, v75
    v_exp_f32 v77, v77
    v_exp_f32 v78, v78
    v_cvt_pk_bf16_f32 v58, v76, v77
    v_exp_f32 v79, v79
    v_exp_f32 v80, v80
    v_mfma_f32_32x32x16_bf16 v[120:135], v[48:51], v[64:67], v[120:135]
    s_add_u32 m0, s44, 123904
    s_add_u32 s39, s98, 2
    s_and_b32 s39, s39, 7
    s_mul_i32 s39, s39, 102400
    s_add_u32 s39, s39, s45
    buffer_load_dwordx4 v241, s[40:43], s39 offen lds
    s_add_u32 m0, s44, 124928
    s_add_u32 s39, s98, 2
    s_and_b32 s39, s39, 7
    s_mul_i32 s39, s39, 102400
    s_add_u32 s39, s39, s45
    buffer_load_dwordx4 v242, s[40:43], s39 offen lds
    v_cvt_pk_bf16_f32 v59, v78, v79
    v_exp_f32 v81, v81
    v_exp_f32 v82, v82
    v_cvt_pk_bf16_f32 v60, v80, v81
    v_exp_f32 v83, v83
    v_exp_f32 v84, v84
    v_mfma_f32_32x32x16_bf16 v[120:135], v[52:55], v[68:71], v[120:135]
    v_cvt_pk_bf16_f32 v61, v82, v83
    v_exp_f32 v85, v85
    v_exp_f32 v86, v86
    v_cvt_pk_bf16_f32 v62, v84, v85
    v_exp_f32 v87, v87
    v_exp_f32 v88, v88
    v_cvt_pk_bf16_f32 v63, v86, v87
    s_waitcnt vmcnt(4)
    v_mfma_f32_32x32x8_bf16 v[72:87], v[36:37], v[20:21], 0
    buffer_load_dwordx4 v[32:35], v1, s[4:7], s24 offen
    v_exp_f32 v89, v89
    v_exp_f32 v90, v90
    v_cvt_pk_bf16_f32 v64, v88, v89
    v_exp_f32 v91, v91
    v_exp_f32 v92, v92
    v_mfma_f32_32x32x16_bf16 v[72:87], v[28:31], v[4:7], v[72:87]
    buffer_load_dword v38, v2, s[4:7], s24 offen
    s_add_u32 s24, s24, 2560
    v_cvt_pk_bf16_f32 v65, v90, v91
    v_exp_f32 v93, v93
    v_exp_f32 v94, v94
    v_cvt_pk_bf16_f32 v66, v92, v93
    v_exp_f32 v95, v95
    v_exp_f32 v96, v96
    v_mfma_f32_32x32x16_bf16 v[136:151], v[48:51], v[56:59], v[136:151]
    v_cvt_pk_bf16_f32 v67, v94, v95
    v_exp_f32 v97, v97
    v_exp_f32 v98, v98
    v_cvt_pk_bf16_f32 v68, v96, v97
    v_exp_f32 v99, v99
    v_exp_f32 v100, v100
    v_mfma_f32_32x32x16_bf16 v[136:151], v[52:55], v[60:63], v[136:151]
    v_cvt_pk_bf16_f32 v69, v98, v99
    v_exp_f32 v101, v101
    v_exp_f32 v102, v102
    v_cvt_pk_bf16_f32 v70, v100, v101
    v_exp_f32 v103, v103
    s_setprio 2
    v_exp_f32 v72, v72
    v_cvt_pk_bf16_f32 v71, v102, v103
    v_mfma_f32_32x32x8_bf16 v[88:103], v[36:37], v[22:23], 0
    v_exp_f32 v73, v73
    v_exp_f32 v74, v74
    v_cvt_pk_bf16_f32 v56, v72, v73
    v_exp_f32 v75, v75
    v_exp_f32 v76, v76
    v_mfma_f32_32x32x16_bf16 v[88:103], v[28:31], v[8:11], v[88:103]
    v_cvt_pk_bf16_f32 v57, v74, v75
    v_exp_f32 v77, v77
    v_exp_f32 v78, v78
    v_cvt_pk_bf16_f32 v58, v76, v77
    v_exp_f32 v79, v79
    v_exp_f32 v80, v80
    v_mfma_f32_32x32x16_bf16 v[152:167], v[48:51], v[64:67], v[152:167]
    v_cvt_pk_bf16_f32 v59, v78, v79
    v_exp_f32 v81, v81
    v_exp_f32 v82, v82
    v_cvt_pk_bf16_f32 v60, v80, v81
    v_exp_f32 v83, v83
    v_exp_f32 v84, v84
    v_mfma_f32_32x32x16_bf16 v[152:167], v[52:55], v[68:71], v[152:167]
    v_cvt_pk_bf16_f32 v61, v82, v83
    v_exp_f32 v85, v85
    v_exp_f32 v86, v86
    v_cvt_pk_bf16_f32 v62, v84, v85
    v_exp_f32 v87, v87
    v_exp_f32 v88, v88
    v_cvt_pk_bf16_f32 v63, v86, v87
    v_mfma_f32_32x32x8_bf16 v[72:87], v[36:37], v[24:25], 0
    v_exp_f32 v89, v89
    v_exp_f32 v90, v90
    v_cvt_pk_bf16_f32 v64, v88, v89
    v_exp_f32 v91, v91
    v_exp_f32 v92, v92
    v_mfma_f32_32x32x16_bf16 v[72:87], v[28:31], v[12:15], v[72:87]
    v_cvt_pk_bf16_f32 v65, v90, v91
    v_exp_f32 v93, v93
    v_exp_f32 v94, v94
    v_cvt_pk_bf16_f32 v66, v92, v93
    v_exp_f32 v95, v95
    v_exp_f32 v96, v96
    s_waitcnt vmcnt(4)
    v_mfma_f32_32x32x16_bf16 v[104:119], v[40:43], v[56:59], v[104:119]
    v_cvt_pk_bf16_f32 v67, v94, v95
    v_exp_f32 v97, v97
    v_exp_f32 v98, v98
    v_cvt_pk_bf16_f32 v68, v96, v97
    v_exp_f32 v99, v99
    v_exp_f32 v100, v100
    v_mfma_f32_32x32x16_bf16 v[104:119], v[44:47], v[60:63], v[104:119]
    s_mov_b64 exec, s[14:15]
    buffer_load_dwordx4 v[48:51], v3, s[4:7], s23 offen
    buffer_load_dwordx4 v[52:55], v3, s[4:7], s23 offen offset:640
    s_mov_b64 exec, -1
    s_add_u32 s23, s23, 2560
    v_cvt_pk_bf16_f32 v69, v98, v99
    v_exp_f32 v101, v101
    v_exp_f32 v102, v102
    v_cvt_pk_bf16_f32 v70, v100, v101
    v_exp_f32 v103, v103
    v_exp_f32 v72, v72
    v_cvt_pk_bf16_f32 v71, v102, v103
    v_mfma_f32_32x32x8_bf16 v[88:103], v[36:37], v[26:27], 0
    v_exp_f32 v73, v73
    v_exp_f32 v74, v74
    v_cvt_pk_bf16_f32 v56, v72, v73
    v_exp_f32 v75, v75
    v_exp_f32 v76, v76
    v_mfma_f32_32x32x16_bf16 v[88:103], v[28:31], v[16:19], v[88:103]
    v_cvt_pk_bf16_f32 v57, v74, v75
    v_exp_f32 v77, v77
    v_exp_f32 v78, v78
    v_cvt_pk_bf16_f32 v58, v76, v77
    v_exp_f32 v79, v79
    v_exp_f32 v80, v80
    v_mfma_f32_32x32x16_bf16 v[120:135], v[40:43], v[64:67], v[120:135]
    s_add_u32 m0, s44, 125952
    s_add_u32 s39, s98, 2
    s_and_b32 s39, s39, 7
    s_mul_i32 s39, s39, 102400
    s_add_u32 s39, s39, s45
    buffer_load_dwordx4 v243, s[40:43], s39 offen lds
    s_add_u32 m0, s44, 126976
    s_add_u32 s39, s98, 2
    s_and_b32 s39, s39, 7
    s_mul_i32 s39, s39, 102400
    s_add_u32 s39, s39, s45
    buffer_load_dwordx4 v244, s[40:43], s39 offen lds
    v_cvt_pk_bf16_f32 v59, v78, v79
    v_exp_f32 v81, v81
    v_exp_f32 v82, v82
    v_cvt_pk_bf16_f32 v60, v80, v81
    v_exp_f32 v83, v83
    v_exp_f32 v84, v84
    v_mfma_f32_32x32x16_bf16 v[120:135], v[44:47], v[68:71], v[120:135]
    v_cvt_pk_bf16_f32 v61, v82, v83
    v_exp_f32 v85, v85
    v_exp_f32 v86, v86
    v_cvt_pk_bf16_f32 v62, v84, v85
    v_exp_f32 v87, v87
    v_exp_f32 v88, v88
    v_cvt_pk_bf16_f32 v63, v86, v87
    s_waitcnt vmcnt(4)
    v_mfma_f32_32x32x8_bf16 v[72:87], v[38:39], v[20:21], 0
    buffer_load_dwordx4 v[28:31], v1, s[4:7], s24 offen
    v_exp_f32 v89, v89
    v_exp_f32 v90, v90
    v_cvt_pk_bf16_f32 v64, v88, v89
    v_exp_f32 v91, v91
    v_exp_f32 v92, v92
    v_mfma_f32_32x32x16_bf16 v[72:87], v[32:35], v[4:7], v[72:87]
    buffer_load_dword v36, v2, s[4:7], s24 offen
    s_add_u32 s24, s24, 2560
    v_cvt_pk_bf16_f32 v65, v90, v91
    v_exp_f32 v93, v93
    v_exp_f32 v94, v94
    v_cvt_pk_bf16_f32 v66, v92, v93
    v_exp_f32 v95, v95
    v_exp_f32 v96, v96
    v_mfma_f32_32x32x16_bf16 v[136:151], v[40:43], v[56:59], v[136:151]
    v_cvt_pk_bf16_f32 v67, v94, v95
    v_exp_f32 v97, v97
    v_exp_f32 v98, v98
    v_cvt_pk_bf16_f32 v68, v96, v97
    v_exp_f32 v99, v99
    v_exp_f32 v100, v100
    v_mfma_f32_32x32x16_bf16 v[136:151], v[44:47], v[60:63], v[136:151]
    v_cvt_pk_bf16_f32 v69, v98, v99
    v_exp_f32 v101, v101
    v_exp_f32 v102, v102
    v_cvt_pk_bf16_f32 v70, v100, v101
    v_exp_f32 v103, v103
    v_exp_f32 v72, v72
    v_cvt_pk_bf16_f32 v71, v102, v103
    v_mfma_f32_32x32x8_bf16 v[88:103], v[38:39], v[22:23], 0
    v_exp_f32 v73, v73
    v_exp_f32 v74, v74
    v_cvt_pk_bf16_f32 v56, v72, v73
    v_exp_f32 v75, v75
    v_exp_f32 v76, v76
    v_mfma_f32_32x32x16_bf16 v[88:103], v[32:35], v[8:11], v[88:103]
    v_cvt_pk_bf16_f32 v57, v74, v75
    v_exp_f32 v77, v77
    v_exp_f32 v78, v78
    v_cvt_pk_bf16_f32 v58, v76, v77
    v_exp_f32 v79, v79
    v_exp_f32 v80, v80
    v_mfma_f32_32x32x16_bf16 v[152:167], v[40:43], v[64:67], v[152:167]
    v_cvt_pk_bf16_f32 v59, v78, v79
    v_exp_f32 v81, v81
    v_exp_f32 v82, v82
    v_cvt_pk_bf16_f32 v60, v80, v81
    v_exp_f32 v83, v83
    v_exp_f32 v84, v84
    v_mfma_f32_32x32x16_bf16 v[152:167], v[44:47], v[68:71], v[152:167]
    v_cvt_pk_bf16_f32 v61, v82, v83
    v_exp_f32 v85, v85
    v_exp_f32 v86, v86
    v_cvt_pk_bf16_f32 v62, v84, v85
    v_exp_f32 v87, v87
    v_exp_f32 v88, v88
    v_cvt_pk_bf16_f32 v63, v86, v87
    v_mfma_f32_32x32x8_bf16 v[72:87], v[38:39], v[24:25], 0
    v_exp_f32 v89, v89
    v_exp_f32 v90, v90
    v_cvt_pk_bf16_f32 v64, v88, v89
    v_exp_f32 v91, v91
    v_exp_f32 v92, v92
    v_mfma_f32_32x32x16_bf16 v[72:87], v[32:35], v[12:15], v[72:87]
    v_cvt_pk_bf16_f32 v65, v90, v91
    v_exp_f32 v93, v93
    v_exp_f32 v94, v94
    v_cvt_pk_bf16_f32 v66, v92, v93
    v_exp_f32 v95, v95
    v_exp_f32 v96, v96
    s_waitcnt vmcnt(4)
    v_mfma_f32_32x32x16_bf16 v[104:119], v[48:51], v[56:59], v[104:119]
    v_cvt_pk_bf16_f32 v67, v94, v95
    v_exp_f32 v97, v97
    v_exp_f32 v98, v98
    v_cvt_pk_bf16_f32 v68, v96, v97
    v_exp_f32 v99, v99
    v_exp_f32 v100, v100
    v_mfma_f32_32x32x16_bf16 v[104:119], v[52:55], v[60:63], v[104:119]
    s_mov_b64 exec, s[14:15]
    buffer_load_dwordx4 v[40:43], v3, s[4:7], s23 offen
    buffer_load_dwordx4 v[44:47], v3, s[4:7], s23 offen offset:640
    s_mov_b64 exec, -1
    s_add_u32 s23, s23, 2560
    v_cvt_pk_bf16_f32 v69, v98, v99
    v_exp_f32 v101, v101
    v_exp_f32 v102, v102
    v_cvt_pk_bf16_f32 v70, v100, v101
    v_exp_f32 v103, v103
    v_exp_f32 v72, v72
    v_cvt_pk_bf16_f32 v71, v102, v103
    v_mfma_f32_32x32x8_bf16 v[88:103], v[38:39], v[26:27], 0
    v_exp_f32 v73, v73
    v_exp_f32 v74, v74
    v_cvt_pk_bf16_f32 v56, v72, v73
    v_exp_f32 v75, v75
    v_exp_f32 v76, v76
    v_mfma_f32_32x32x16_bf16 v[88:103], v[32:35], v[16:19], v[88:103]
    v_cvt_pk_bf16_f32 v57, v74, v75
    v_exp_f32 v77, v77
    v_exp_f32 v78, v78
    v_cvt_pk_bf16_f32 v58, v76, v77
    v_exp_f32 v79, v79
    v_exp_f32 v80, v80
    v_mfma_f32_32x32x16_bf16 v[120:135], v[48:51], v[64:67], v[120:135]
    s_add_u32 s39, s98, 4
    s_and_b32 s39, s39, 7
    s_mul_i32 s39, s39, 102400
    s_add_u32 s39, s39, s45
    buffer_load_dwordx4 v[180:183], v240, s[40:43], s39 offen
    s_add_u32 s39, s98, 4
    s_and_b32 s39, s39, 7
    s_mul_i32 s39, s39, 102400
    s_add_u32 s39, s39, s45
    buffer_load_dwordx4 v[184:187], v241, s[40:43], s39 offen
    v_cvt_pk_bf16_f32 v59, v78, v79
    v_exp_f32 v81, v81
    v_exp_f32 v82, v82
    v_cvt_pk_bf16_f32 v60, v80, v81
    v_exp_f32 v83, v83
    v_exp_f32 v84, v84
    v_mfma_f32_32x32x16_bf16 v[120:135], v[52:55], v[68:71], v[120:135]
    v_cvt_pk_bf16_f32 v61, v82, v83
    v_exp_f32 v85, v85
    v_exp_f32 v86, v86
    v_cvt_pk_bf16_f32 v62, v84, v85
    v_exp_f32 v87, v87
    v_exp_f32 v88, v88
    v_cvt_pk_bf16_f32 v63, v86, v87
    s_waitcnt vmcnt(4)
    v_mfma_f32_32x32x8_bf16 v[72:87], v[36:37], v[20:21], 0
    buffer_load_dwordx4 v[32:35], v1, s[4:7], s24 offen
    v_exp_f32 v89, v89
    v_exp_f32 v90, v90
    v_cvt_pk_bf16_f32 v64, v88, v89
    v_exp_f32 v91, v91
    v_exp_f32 v92, v92
    v_mfma_f32_32x32x16_bf16 v[72:87], v[28:31], v[4:7], v[72:87]
    buffer_load_dword v38, v2, s[4:7], s24 offen
    s_add_u32 s24, s24, 2560
    v_cvt_pk_bf16_f32 v65, v90, v91
    v_exp_f32 v93, v93
    v_exp_f32 v94, v94
    v_cvt_pk_bf16_f32 v66, v92, v93
    v_exp_f32 v95, v95
    v_exp_f32 v96, v96
    v_mfma_f32_32x32x16_bf16 v[136:151], v[48:51], v[56:59], v[136:151]
    v_cvt_pk_bf16_f32 v67, v94, v95
    v_exp_f32 v97, v97
    v_exp_f32 v98, v98
    v_cvt_pk_bf16_f32 v68, v96, v97
    v_exp_f32 v99, v99
    v_exp_f32 v100, v100
    v_mfma_f32_32x32x16_bf16 v[136:151], v[52:55], v[60:63], v[136:151]
    v_cvt_pk_bf16_f32 v69, v98, v99
    v_exp_f32 v101, v101
    v_exp_f32 v102, v102
    v_cvt_pk_bf16_f32 v70, v100, v101
    v_exp_f32 v103, v103
    v_exp_f32 v72, v72
    v_cvt_pk_bf16_f32 v71, v102, v103
    v_mfma_f32_32x32x8_bf16 v[88:103], v[36:37], v[22:23], 0
    v_exp_f32 v73, v73
    v_exp_f32 v74, v74
    v_cvt_pk_bf16_f32 v56, v72, v73
    v_exp_f32 v75, v75
    v_exp_f32 v76, v76
    v_mfma_f32_32x32x16_bf16 v[88:103], v[28:31], v[8:11], v[88:103]
    v_cvt_pk_bf16_f32 v57, v74, v75
    v_exp_f32 v77, v77
    v_exp_f32 v78, v78
    v_cvt_pk_bf16_f32 v58, v76, v77
    v_exp_f32 v79, v79
    v_exp_f32 v80, v80
    v_mfma_f32_32x32x16_bf16 v[152:167], v[48:51], v[64:67], v[152:167]
    v_cvt_pk_bf16_f32 v59, v78, v79
    v_exp_f32 v81, v81
    v_exp_f32 v82, v82
    v_cvt_pk_bf16_f32 v60, v80, v81
    v_exp_f32 v83, v83
    v_exp_f32 v84, v84
    v_mfma_f32_32x32x16_bf16 v[152:167], v[52:55], v[68:71], v[152:167]
    v_cvt_pk_bf16_f32 v61, v82, v83
    v_exp_f32 v85, v85
    v_exp_f32 v86, v86
    v_cvt_pk_bf16_f32 v62, v84, v85
    v_exp_f32 v87, v87
    v_exp_f32 v88, v88
    v_cvt_pk_bf16_f32 v63, v86, v87
    v_mfma_f32_32x32x8_bf16 v[72:87], v[36:37], v[24:25], 0
    v_exp_f32 v89, v89
    v_exp_f32 v90, v90
    v_cvt_pk_bf16_f32 v64, v88, v89
    v_exp_f32 v91, v91
    v_exp_f32 v92, v92
    v_mfma_f32_32x32x16_bf16 v[72:87], v[28:31], v[12:15], v[72:87]
    v_cvt_pk_bf16_f32 v65, v90, v91
    v_exp_f32 v93, v93
    v_exp_f32 v94, v94
    v_cvt_pk_bf16_f32 v66, v92, v93
    v_exp_f32 v95, v95
    v_exp_f32 v96, v96
    s_waitcnt vmcnt(4)
    v_mfma_f32_32x32x16_bf16 v[104:119], v[40:43], v[56:59], v[104:119]
    v_cvt_pk_bf16_f32 v67, v94, v95
    v_exp_f32 v97, v97
    v_exp_f32 v98, v98
    v_cvt_pk_bf16_f32 v68, v96, v97
    v_exp_f32 v99, v99
    v_exp_f32 v100, v100
    v_mfma_f32_32x32x16_bf16 v[104:119], v[44:47], v[60:63], v[104:119]
    s_mov_b64 exec, s[14:15]
    buffer_load_dwordx4 v[48:51], v3, s[4:7], s23 offen
    buffer_load_dwordx4 v[52:55], v3, s[4:7], s23 offen offset:640
    s_mov_b64 exec, -1
    s_add_u32 s23, s23, 2560
    v_cvt_pk_bf16_f32 v69, v98, v99
    v_exp_f32 v101, v101
    v_exp_f32 v102, v102
    v_cvt_pk_bf16_f32 v70, v100, v101
    v_exp_f32 v103, v103
    v_exp_f32 v72, v72
    v_cvt_pk_bf16_f32 v71, v102, v103
    v_mfma_f32_32x32x8_bf16 v[88:103], v[36:37], v[26:27], 0
    v_exp_f32 v73, v73
    v_exp_f32 v74, v74
    v_cvt_pk_bf16_f32 v56, v72, v73
    v_exp_f32 v75, v75
    v_exp_f32 v76, v76
    v_mfma_f32_32x32x16_bf16 v[88:103], v[28:31], v[16:19], v[88:103]
    v_cvt_pk_bf16_f32 v57, v74, v75
    v_exp_f32 v77, v77
    v_exp_f32 v78, v78
    v_cvt_pk_bf16_f32 v58, v76, v77
    v_exp_f32 v79, v79
    v_exp_f32 v80, v80
    v_mfma_f32_32x32x16_bf16 v[120:135], v[40:43], v[64:67], v[120:135]
    s_add_u32 s39, s98, 4
    s_and_b32 s39, s39, 7
    s_mul_i32 s39, s39, 102400
    s_add_u32 s39, s39, s45
    buffer_load_dwordx4 v[188:191], v242, s[40:43], s39 offen
    s_add_u32 s39, s98, 4
    s_and_b32 s39, s39, 7
    s_mul_i32 s39, s39, 102400
    s_add_u32 s39, s39, s45
    buffer_load_dwordx4 v[192:195], v243, s[40:43], s39 offen
    v_cvt_pk_bf16_f32 v59, v78, v79
    v_exp_f32 v81, v81
    v_exp_f32 v82, v82
    v_cvt_pk_bf16_f32 v60, v80, v81
    v_exp_f32 v83, v83
    v_exp_f32 v84, v84
    v_mfma_f32_32x32x16_bf16 v[120:135], v[44:47], v[68:71], v[120:135]
    v_cvt_pk_bf16_f32 v61, v82, v83
    v_exp_f32 v85, v85
    v_exp_f32 v86, v86
    v_cvt_pk_bf16_f32 v62, v84, v85
    v_exp_f32 v87, v87
    v_exp_f32 v88, v88
    v_cvt_pk_bf16_f32 v63, v86, v87
    s_waitcnt vmcnt(4)
    v_mfma_f32_32x32x8_bf16 v[72:87], v[38:39], v[20:21], 0
    buffer_load_dwordx4 v[28:31], v1, s[4:7], s24 offen
    v_exp_f32 v89, v89
    v_exp_f32 v90, v90
    v_cvt_pk_bf16_f32 v64, v88, v89
    v_exp_f32 v91, v91
    v_exp_f32 v92, v92
    v_mfma_f32_32x32x16_bf16 v[72:87], v[32:35], v[4:7], v[72:87]
    buffer_load_dword v36, v2, s[4:7], s24 offen
    s_add_u32 s24, s24, 2560
    v_cvt_pk_bf16_f32 v65, v90, v91
    v_exp_f32 v93, v93
    v_exp_f32 v94, v94
    v_cvt_pk_bf16_f32 v66, v92, v93
    v_exp_f32 v95, v95
    v_exp_f32 v96, v96
    v_mfma_f32_32x32x16_bf16 v[136:151], v[40:43], v[56:59], v[136:151]
    v_cvt_pk_bf16_f32 v67, v94, v95
    v_exp_f32 v97, v97
    v_exp_f32 v98, v98
    v_cvt_pk_bf16_f32 v68, v96, v97
    v_exp_f32 v99, v99
    v_exp_f32 v100, v100
    v_mfma_f32_32x32x16_bf16 v[136:151], v[44:47], v[60:63], v[136:151]
    v_cvt_pk_bf16_f32 v69, v98, v99
    v_exp_f32 v101, v101
    v_exp_f32 v102, v102
    v_cvt_pk_bf16_f32 v70, v100, v101
    v_exp_f32 v103, v103
    v_exp_f32 v72, v72
    v_cvt_pk_bf16_f32 v71, v102, v103
    v_mfma_f32_32x32x8_bf16 v[88:103], v[38:39], v[22:23], 0
    v_exp_f32 v73, v73
    v_exp_f32 v74, v74
    v_cvt_pk_bf16_f32 v56, v72, v73
    v_exp_f32 v75, v75
    v_exp_f32 v76, v76
    v_mfma_f32_32x32x16_bf16 v[88:103], v[32:35], v[8:11], v[88:103]
    v_cvt_pk_bf16_f32 v57, v74, v75
    v_exp_f32 v77, v77
    v_exp_f32 v78, v78
    v_cvt_pk_bf16_f32 v58, v76, v77
    v_exp_f32 v79, v79
    v_exp_f32 v80, v80
    v_mfma_f32_32x32x16_bf16 v[152:167], v[40:43], v[64:67], v[152:167]
    v_cvt_pk_bf16_f32 v59, v78, v79
    v_exp_f32 v81, v81
    v_exp_f32 v82, v82
    v_cvt_pk_bf16_f32 v60, v80, v81
    v_exp_f32 v83, v83
    v_exp_f32 v84, v84
    v_mfma_f32_32x32x16_bf16 v[152:167], v[44:47], v[68:71], v[152:167]
    v_cvt_pk_bf16_f32 v61, v82, v83
    v_exp_f32 v85, v85
    v_exp_f32 v86, v86
    v_cvt_pk_bf16_f32 v62, v84, v85
    v_exp_f32 v87, v87
    v_exp_f32 v88, v88
    v_cvt_pk_bf16_f32 v63, v86, v87
    v_mfma_f32_32x32x8_bf16 v[72:87], v[38:39], v[24:25], 0
    v_exp_f32 v89, v89
    v_exp_f32 v90, v90
    v_cvt_pk_bf16_f32 v64, v88, v89
    v_exp_f32 v91, v91
    v_exp_f32 v92, v92
    v_mfma_f32_32x32x16_bf16 v[72:87], v[32:35], v[12:15], v[72:87]
    v_cvt_pk_bf16_f32 v65, v90, v91
    v_exp_f32 v93, v93
    v_exp_f32 v94, v94
    v_cvt_pk_bf16_f32 v66, v92, v93
    v_exp_f32 v95, v95
    v_exp_f32 v96, v96
    s_waitcnt vmcnt(4)
    v_mfma_f32_32x32x16_bf16 v[104:119], v[48:51], v[56:59], v[104:119]
    v_cvt_pk_bf16_f32 v67, v94, v95
    v_exp_f32 v97, v97
    v_exp_f32 v98, v98
    v_cvt_pk_bf16_f32 v68, v96, v97
    v_exp_f32 v99, v99
    v_exp_f32 v100, v100
    v_mfma_f32_32x32x16_bf16 v[104:119], v[52:55], v[60:63], v[104:119]
    s_mov_b64 exec, s[14:15]
    buffer_load_dwordx4 v[40:43], v3, s[4:7], s23 offen
    buffer_load_dwordx4 v[44:47], v3, s[4:7], s23 offen offset:640
    s_mov_b64 exec, -1
    s_add_u32 s23, s23, 2560
    v_cvt_pk_bf16_f32 v69, v98, v99
    v_exp_f32 v101, v101
    v_exp_f32 v102, v102
    v_cvt_pk_bf16_f32 v70, v100, v101
    v_exp_f32 v103, v103
    v_exp_f32 v72, v72
    v_cvt_pk_bf16_f32 v71, v102, v103
    v_mfma_f32_32x32x8_bf16 v[88:103], v[38:39], v[26:27], 0
    v_exp_f32 v73, v73
    v_exp_f32 v74, v74
    v_cvt_pk_bf16_f32 v56, v72, v73
    v_exp_f32 v75, v75
    v_exp_f32 v76, v76
    v_mfma_f32_32x32x16_bf16 v[88:103], v[32:35], v[16:19], v[88:103]
    v_cvt_pk_bf16_f32 v57, v74, v75
    v_exp_f32 v77, v77
    v_exp_f32 v78, v78
    v_cvt_pk_bf16_f32 v58, v76, v77
    v_exp_f32 v79, v79
    v_exp_f32 v80, v80
    v_mfma_f32_32x32x16_bf16 v[120:135], v[48:51], v[64:67], v[120:135]
    s_add_u32 s39, s98, 4
    s_and_b32 s39, s39, 7
    s_mul_i32 s39, s39, 102400
    s_add_u32 s39, s39, s45
    buffer_load_dwordx4 v[196:199], v244, s[40:43], s39 offen
    s_add_u32 s39, s98, 6
    s_and_b32 s39, s39, 7
    s_mul_i32 s39, s39, 102400
    s_add_u32 s39, s39, s45
    buffer_load_dwordx4 v[200:203], v240, s[40:43], s39 offen
    v_cvt_pk_bf16_f32 v59, v78, v79
    v_exp_f32 v81, v81
    v_exp_f32 v82, v82
    v_cvt_pk_bf16_f32 v60, v80, v81
    v_exp_f32 v83, v83
    v_exp_f32 v84, v84
    v_mfma_f32_32x32x16_bf16 v[120:135], v[52:55], v[68:71], v[120:135]
    v_cvt_pk_bf16_f32 v61, v82, v83
    v_exp_f32 v85, v85
    v_exp_f32 v86, v86
    v_cvt_pk_bf16_f32 v62, v84, v85
    v_exp_f32 v87, v87
    v_exp_f32 v88, v88
    v_cvt_pk_bf16_f32 v63, v86, v87
    s_waitcnt vmcnt(4)
    v_mfma_f32_32x32x8_bf16 v[72:87], v[36:37], v[20:21], 0
    buffer_load_dwordx4 v[32:35], v1, s[4:7], s24 offen
    v_exp_f32 v89, v89
    v_exp_f32 v90, v90
    v_cvt_pk_bf16_f32 v64, v88, v89
    v_exp_f32 v91, v91
    v_exp_f32 v92, v92
    v_mfma_f32_32x32x16_bf16 v[72:87], v[28:31], v[4:7], v[72:87]
    buffer_load_dword v38, v2, s[4:7], s24 offen
    s_add_u32 s24, s24, 2560
    v_cvt_pk_bf16_f32 v65, v90, v91
    v_exp_f32 v93, v93
    v_exp_f32 v94, v94
    v_cvt_pk_bf16_f32 v66, v92, v93
    v_exp_f32 v95, v95
    v_exp_f32 v96, v96
    v_mfma_f32_32x32x16_bf16 v[136:151], v[48:51], v[56:59], v[136:151]
    v_cvt_pk_bf16_f32 v67, v94, v95
    v_exp_f32 v97, v97
    v_exp_f32 v98, v98
    v_cvt_pk_bf16_f32 v68, v96, v97
    v_exp_f32 v99, v99
    v_exp_f32 v100, v100
    v_mfma_f32_32x32x16_bf16 v[136:151], v[52:55], v[60:63], v[136:151]
    v_cvt_pk_bf16_f32 v69, v98, v99
    v_exp_f32 v101, v101
    v_exp_f32 v102, v102
    v_cvt_pk_bf16_f32 v70, v100, v101
    v_exp_f32 v103, v103
    v_exp_f32 v72, v72
    v_cvt_pk_bf16_f32 v71, v102, v103
    v_mfma_f32_32x32x8_bf16 v[88:103], v[36:37], v[22:23], 0
    v_exp_f32 v73, v73
    v_exp_f32 v74, v74
    v_cvt_pk_bf16_f32 v56, v72, v73
    v_exp_f32 v75, v75
    v_exp_f32 v76, v76
    v_mfma_f32_32x32x16_bf16 v[88:103], v[28:31], v[8:11], v[88:103]
    v_cvt_pk_bf16_f32 v57, v74, v75
    v_exp_f32 v77, v77
    v_exp_f32 v78, v78
    v_cvt_pk_bf16_f32 v58, v76, v77
    v_exp_f32 v79, v79
    v_exp_f32 v80, v80
    v_mfma_f32_32x32x16_bf16 v[152:167], v[48:51], v[64:67], v[152:167]
    v_cvt_pk_bf16_f32 v59, v78, v79
    v_exp_f32 v81, v81
    v_exp_f32 v82, v82
    v_cvt_pk_bf16_f32 v60, v80, v81
    v_exp_f32 v83, v83
    v_exp_f32 v84, v84
    v_mfma_f32_32x32x16_bf16 v[152:167], v[52:55], v[68:71], v[152:167]
    v_cvt_pk_bf16_f32 v61, v82, v83
    v_exp_f32 v85, v85
    v_exp_f32 v86, v86
    v_cvt_pk_bf16_f32 v62, v84, v85
    v_exp_f32 v87, v87
    v_exp_f32 v88, v88
    v_cvt_pk_bf16_f32 v63, v86, v87
    v_mfma_f32_32x32x8_bf16 v[72:87], v[36:37], v[24:25], 0
    v_exp_f32 v89, v89
    v_exp_f32 v90, v90
    v_cvt_pk_bf16_f32 v64, v88, v89
    v_exp_f32 v91, v91
    v_exp_f32 v92, v92
    v_mfma_f32_32x32x16_bf16 v[72:87], v[28:31], v[12:15], v[72:87]
    v_cvt_pk_bf16_f32 v65, v90, v91
    v_exp_f32 v93, v93
    v_exp_f32 v94, v94
    v_cvt_pk_bf16_f32 v66, v92, v93
    v_exp_f32 v95, v95
    v_exp_f32 v96, v96
    s_waitcnt vmcnt(4)
    v_mfma_f32_32x32x16_bf16 v[104:119], v[40:43], v[56:59], v[104:119]
    v_cvt_pk_bf16_f32 v67, v94, v95
    v_exp_f32 v97, v97
    v_exp_f32 v98, v98
    v_cvt_pk_bf16_f32 v68, v96, v97
    v_exp_f32 v99, v99
    v_exp_f32 v100, v100
    v_mfma_f32_32x32x16_bf16 v[104:119], v[44:47], v[60:63], v[104:119]
    s_mov_b64 exec, s[14:15]
    buffer_load_dwordx4 v[48:51], v3, s[4:7], s23 offen
    buffer_load_dwordx4 v[52:55], v3, s[4:7], s23 offen offset:640
    s_mov_b64 exec, -1
    s_add_u32 s23, s23, 2560
    v_cvt_pk_bf16_f32 v69, v98, v99
    v_exp_f32 v101, v101
    v_exp_f32 v102, v102
    v_cvt_pk_bf16_f32 v70, v100, v101
    v_exp_f32 v103, v103
    v_exp_f32 v72, v72
    v_cvt_pk_bf16_f32 v71, v102, v103
    v_mfma_f32_32x32x8_bf16 v[88:103], v[36:37], v[26:27], 0
    v_exp_f32 v73, v73
    v_exp_f32 v74, v74
    v_cvt_pk_bf16_f32 v56, v72, v73
    v_exp_f32 v75, v75
    v_exp_f32 v76, v76
    v_mfma_f32_32x32x16_bf16 v[88:103], v[28:31], v[16:19], v[88:103]
    v_cvt_pk_bf16_f32 v57, v74, v75
    v_exp_f32 v77, v77
    v_exp_f32 v78, v78
    v_cvt_pk_bf16_f32 v58, v76, v77
    v_exp_f32 v79, v79
    v_exp_f32 v80, v80
    v_mfma_f32_32x32x16_bf16 v[120:135], v[40:43], v[64:67], v[120:135]
    s_add_u32 s39, s98, 6
    s_and_b32 s39, s39, 7
    s_mul_i32 s39, s39, 102400
    s_add_u32 s39, s39, s45
    buffer_load_dwordx4 v[204:207], v241, s[40:43], s39 offen
    s_add_u32 s39, s98, 6
    s_and_b32 s39, s39, 7
    s_mul_i32 s39, s39, 102400
    s_add_u32 s39, s39, s45
    buffer_load_dwordx4 v[208:211], v242, s[40:43], s39 offen
    v_cvt_pk_bf16_f32 v59, v78, v79
    v_exp_f32 v81, v81
    v_exp_f32 v82, v82
    v_cvt_pk_bf16_f32 v60, v80, v81
    v_exp_f32 v83, v83
    v_exp_f32 v84, v84
    v_mfma_f32_32x32x16_bf16 v[120:135], v[44:47], v[68:71], v[120:135]
    v_cvt_pk_bf16_f32 v61, v82, v83
    v_exp_f32 v85, v85
    v_exp_f32 v86, v86
    v_cvt_pk_bf16_f32 v62, v84, v85
    v_exp_f32 v87, v87
    v_exp_f32 v88, v88
    v_cvt_pk_bf16_f32 v63, v86, v87
    s_waitcnt vmcnt(4)
    v_mfma_f32_32x32x8_bf16 v[72:87], v[38:39], v[20:21], 0
    buffer_load_dwordx4 v[28:31], v1, s[4:7], s24 offen
    v_exp_f32 v89, v89
    v_exp_f32 v90, v90
    v_cvt_pk_bf16_f32 v64, v88, v89
    v_exp_f32 v91, v91
    v_exp_f32 v92, v92
    v_mfma_f32_32x32x16_bf16 v[72:87], v[32:35], v[4:7], v[72:87]
    buffer_load_dword v36, v2, s[4:7], s24 offen
    s_add_u32 s24, s24, 2560
    v_cvt_pk_bf16_f32 v65, v90, v91
    v_exp_f32 v93, v93
    v_exp_f32 v94, v94
    v_cvt_pk_bf16_f32 v66, v92, v93
    v_exp_f32 v95, v95
    v_exp_f32 v96, v96
    v_mfma_f32_32x32x16_bf16 v[136:151], v[40:43], v[56:59], v[136:151]
    v_cvt_pk_bf16_f32 v67, v94, v95
    v_exp_f32 v97, v97
    v_exp_f32 v98, v98
    v_cvt_pk_bf16_f32 v68, v96, v97
    v_exp_f32 v99, v99
    v_exp_f32 v100, v100
    v_mfma_f32_32x32x16_bf16 v[136:151], v[44:47], v[60:63], v[136:151]
    v_cvt_pk_bf16_f32 v69, v98, v99
    v_exp_f32 v101, v101
    v_exp_f32 v102, v102
    v_cvt_pk_bf16_f32 v70, v100, v101
    v_exp_f32 v103, v103
    v_exp_f32 v72, v72
    v_cvt_pk_bf16_f32 v71, v102, v103
    v_mfma_f32_32x32x8_bf16 v[88:103], v[38:39], v[22:23], 0
    v_exp_f32 v73, v73
    v_exp_f32 v74, v74
    v_cvt_pk_bf16_f32 v56, v72, v73
    v_exp_f32 v75, v75
    v_exp_f32 v76, v76
    v_mfma_f32_32x32x16_bf16 v[88:103], v[32:35], v[8:11], v[88:103]
    v_cvt_pk_bf16_f32 v57, v74, v75
    v_exp_f32 v77, v77
    v_exp_f32 v78, v78
    v_cvt_pk_bf16_f32 v58, v76, v77
    v_exp_f32 v79, v79
    v_exp_f32 v80, v80
    v_mfma_f32_32x32x16_bf16 v[152:167], v[40:43], v[64:67], v[152:167]
    v_cvt_pk_bf16_f32 v59, v78, v79
    v_exp_f32 v81, v81
    v_exp_f32 v82, v82
    v_cvt_pk_bf16_f32 v60, v80, v81
    v_exp_f32 v83, v83
    v_exp_f32 v84, v84
    v_mfma_f32_32x32x16_bf16 v[152:167], v[44:47], v[68:71], v[152:167]
    v_cvt_pk_bf16_f32 v61, v82, v83
    v_exp_f32 v85, v85
    v_exp_f32 v86, v86
    v_cvt_pk_bf16_f32 v62, v84, v85
    v_exp_f32 v87, v87
    v_exp_f32 v88, v88
    v_cvt_pk_bf16_f32 v63, v86, v87
    v_mfma_f32_32x32x8_bf16 v[72:87], v[38:39], v[24:25], 0
    v_exp_f32 v89, v89
    v_exp_f32 v90, v90
    v_cvt_pk_bf16_f32 v64, v88, v89
    v_exp_f32 v91, v91
    v_exp_f32 v92, v92
    v_mfma_f32_32x32x16_bf16 v[72:87], v[32:35], v[12:15], v[72:87]
    v_cvt_pk_bf16_f32 v65, v90, v91
    v_exp_f32 v93, v93
    v_exp_f32 v94, v94
    v_cvt_pk_bf16_f32 v66, v92, v93
    v_exp_f32 v95, v95
    v_exp_f32 v96, v96
    s_waitcnt vmcnt(4)
    v_mfma_f32_32x32x16_bf16 v[104:119], v[48:51], v[56:59], v[104:119]
    v_cvt_pk_bf16_f32 v67, v94, v95
    v_exp_f32 v97, v97
    v_exp_f32 v98, v98
    v_cvt_pk_bf16_f32 v68, v96, v97
    v_exp_f32 v99, v99
    v_exp_f32 v100, v100
    v_mfma_f32_32x32x16_bf16 v[104:119], v[52:55], v[60:63], v[104:119]
    s_mov_b64 exec, s[14:15]
    buffer_load_dwordx4 v[40:43], v3, s[4:7], s23 offen
    buffer_load_dwordx4 v[44:47], v3, s[4:7], s23 offen offset:640
    s_mov_b64 exec, -1
    s_add_u32 s23, s23, 2560
    v_cvt_pk_bf16_f32 v69, v98, v99
    v_exp_f32 v101, v101
    v_exp_f32 v102, v102
    v_cvt_pk_bf16_f32 v70, v100, v101
    v_exp_f32 v103, v103
    v_exp_f32 v72, v72
    v_cvt_pk_bf16_f32 v71, v102, v103
    v_mfma_f32_32x32x8_bf16 v[88:103], v[38:39], v[26:27], 0
    v_exp_f32 v73, v73
    v_exp_f32 v74, v74
    v_cvt_pk_bf16_f32 v56, v72, v73
    v_exp_f32 v75, v75
    v_exp_f32 v76, v76
    v_mfma_f32_32x32x16_bf16 v[88:103], v[32:35], v[16:19], v[88:103]
    v_cvt_pk_bf16_f32 v57, v74, v75
    v_exp_f32 v77, v77
    v_exp_f32 v78, v78
    v_cvt_pk_bf16_f32 v58, v76, v77
    v_exp_f32 v79, v79
    v_exp_f32 v80, v80
    v_mfma_f32_32x32x16_bf16 v[120:135], v[48:51], v[64:67], v[120:135]
    s_add_u32 s39, s98, 6
    s_and_b32 s39, s39, 7
    s_mul_i32 s39, s39, 102400
    s_add_u32 s39, s39, s45
    buffer_load_dwordx4 v[212:215], v243, s[40:43], s39 offen
    s_add_u32 s39, s98, 6
    s_and_b32 s39, s39, 7
    s_mul_i32 s39, s39, 102400
    s_add_u32 s39, s39, s45
    buffer_load_dwordx4 v[216:219], v244, s[40:43], s39 offen
    v_cvt_pk_bf16_f32 v59, v78, v79
    v_exp_f32 v81, v81
    v_exp_f32 v82, v82
    v_cvt_pk_bf16_f32 v60, v80, v81
    v_exp_f32 v83, v83
    v_exp_f32 v84, v84
    v_mfma_f32_32x32x16_bf16 v[120:135], v[52:55], v[68:71], v[120:135]
    v_cvt_pk_bf16_f32 v61, v82, v83
    v_exp_f32 v85, v85
    v_exp_f32 v86, v86
    v_cvt_pk_bf16_f32 v62, v84, v85
    v_exp_f32 v87, v87
    v_exp_f32 v88, v88
    v_cvt_pk_bf16_f32 v63, v86, v87
    s_waitcnt vmcnt(4)
    v_mfma_f32_32x32x8_bf16 v[72:87], v[36:37], v[20:21], 0
    buffer_load_dwordx4 v[32:35], v1, s[4:7], s24 offen
    v_exp_f32 v89, v89
    v_exp_f32 v90, v90
    v_cvt_pk_bf16_f32 v64, v88, v89
    v_exp_f32 v91, v91
    v_exp_f32 v92, v92
    v_mfma_f32_32x32x16_bf16 v[72:87], v[28:31], v[4:7], v[72:87]
    buffer_load_dword v38, v2, s[4:7], s24 offen
    s_add_u32 s24, s24, 2560
    v_cvt_pk_bf16_f32 v65, v90, v91
    v_exp_f32 v93, v93
    v_exp_f32 v94, v94
    v_cvt_pk_bf16_f32 v66, v92, v93
    v_exp_f32 v95, v95
    v_exp_f32 v96, v96
    v_mfma_f32_32x32x16_bf16 v[136:151], v[48:51], v[56:59], v[136:151]
    v_cvt_pk_bf16_f32 v67, v94, v95
    v_exp_f32 v97, v97
    v_exp_f32 v98, v98
    v_cvt_pk_bf16_f32 v68, v96, v97
    v_exp_f32 v99, v99
    v_exp_f32 v100, v100
    v_mfma_f32_32x32x16_bf16 v[136:151], v[52:55], v[60:63], v[136:151]
    v_cvt_pk_bf16_f32 v69, v98, v99
    v_exp_f32 v101, v101
    v_exp_f32 v102, v102
    v_cvt_pk_bf16_f32 v70, v100, v101
    v_exp_f32 v103, v103
    v_exp_f32 v72, v72
    v_cvt_pk_bf16_f32 v71, v102, v103
    v_mfma_f32_32x32x8_bf16 v[88:103], v[36:37], v[22:23], 0
    v_exp_f32 v73, v73
    v_exp_f32 v74, v74
    v_cvt_pk_bf16_f32 v56, v72, v73
    v_exp_f32 v75, v75
    v_exp_f32 v76, v76
    v_mfma_f32_32x32x16_bf16 v[88:103], v[28:31], v[8:11], v[88:103]
    v_cvt_pk_bf16_f32 v57, v74, v75
    v_exp_f32 v77, v77
    v_exp_f32 v78, v78
    v_cvt_pk_bf16_f32 v58, v76, v77
    v_exp_f32 v79, v79
    v_exp_f32 v80, v80
    v_mfma_f32_32x32x16_bf16 v[152:167], v[48:51], v[64:67], v[152:167]
    v_cvt_pk_bf16_f32 v59, v78, v79
    v_exp_f32 v81, v81
    v_exp_f32 v82, v82
    v_cvt_pk_bf16_f32 v60, v80, v81
    v_exp_f32 v83, v83
    v_exp_f32 v84, v84
    v_mfma_f32_32x32x16_bf16 v[152:167], v[52:55], v[68:71], v[152:167]
    v_cvt_pk_bf16_f32 v61, v82, v83
    v_exp_f32 v85, v85
    v_exp_f32 v86, v86
    v_cvt_pk_bf16_f32 v62, v84, v85
    v_exp_f32 v87, v87
    v_exp_f32 v88, v88
    v_cvt_pk_bf16_f32 v63, v86, v87
    v_mfma_f32_32x32x8_bf16 v[72:87], v[36:37], v[24:25], 0
    v_exp_f32 v89, v89
    v_exp_f32 v90, v90
    v_cvt_pk_bf16_f32 v64, v88, v89
    v_exp_f32 v91, v91
    v_exp_f32 v92, v92
    v_mfma_f32_32x32x16_bf16 v[72:87], v[28:31], v[12:15], v[72:87]
    v_cvt_pk_bf16_f32 v65, v90, v91
    v_exp_f32 v93, v93
    v_exp_f32 v94, v94
    v_cvt_pk_bf16_f32 v66, v92, v93
    v_exp_f32 v95, v95
    v_exp_f32 v96, v96
    s_waitcnt vmcnt(4)
    v_mfma_f32_32x32x16_bf16 v[104:119], v[40:43], v[56:59], v[104:119]
    v_cvt_pk_bf16_f32 v67, v94, v95
    v_exp_f32 v97, v97
    v_exp_f32 v98, v98
    v_cvt_pk_bf16_f32 v68, v96, v97
    v_exp_f32 v99, v99
    v_exp_f32 v100, v100
    v_mfma_f32_32x32x16_bf16 v[104:119], v[44:47], v[60:63], v[104:119]
    s_mov_b64 exec, s[14:15]
    buffer_load_dwordx4 v[48:51], v3, s[4:7], s23 offen
    buffer_load_dwordx4 v[52:55], v3, s[4:7], s23 offen offset:640
    s_mov_b64 exec, -1
    s_add_u32 s23, s23, 2560
    v_cvt_pk_bf16_f32 v69, v98, v99
    v_exp_f32 v101, v101
    v_exp_f32 v102, v102
    v_cvt_pk_bf16_f32 v70, v100, v101
    v_exp_f32 v103, v103
    v_exp_f32 v72, v72
    v_cvt_pk_bf16_f32 v71, v102, v103
    v_mfma_f32_32x32x8_bf16 v[88:103], v[36:37], v[26:27], 0
    v_exp_f32 v73, v73
    v_exp_f32 v74, v74
    v_cvt_pk_bf16_f32 v56, v72, v73
    v_exp_f32 v75, v75
    v_exp_f32 v76, v76
    v_mfma_f32_32x32x16_bf16 v[88:103], v[28:31], v[16:19], v[88:103]
    v_cvt_pk_bf16_f32 v57, v74, v75
    v_exp_f32 v77, v77
    v_exp_f32 v78, v78
    v_cvt_pk_bf16_f32 v58, v76, v77
    v_exp_f32 v79, v79
    v_exp_f32 v80, v80
    v_mfma_f32_32x32x16_bf16 v[120:135], v[40:43], v[64:67], v[120:135]
    buffer_load_dwordx4 v[220:223], v245, s[40:43], s46 offen
    buffer_load_dwordx4 v[224:227], v246, s[40:43], s46 offen
    v_cvt_pk_bf16_f32 v59, v78, v79
    v_exp_f32 v81, v81
    v_exp_f32 v82, v82
    v_cvt_pk_bf16_f32 v60, v80, v81
    v_exp_f32 v83, v83
    v_exp_f32 v84, v84
    v_mfma_f32_32x32x16_bf16 v[120:135], v[44:47], v[68:71], v[120:135]
    v_cvt_pk_bf16_f32 v61, v82, v83
    v_exp_f32 v85, v85
    v_exp_f32 v86, v86
    v_cvt_pk_bf16_f32 v62, v84, v85
    v_exp_f32 v87, v87
    v_exp_f32 v88, v88
    v_cvt_pk_bf16_f32 v63, v86, v87
    s_waitcnt vmcnt(4)
    v_mfma_f32_32x32x8_bf16 v[72:87], v[38:39], v[20:21], 0
    buffer_load_dwordx4 v[28:31], v1, s[4:7], s24 offen
    v_exp_f32 v89, v89
    v_exp_f32 v90, v90
    v_cvt_pk_bf16_f32 v64, v88, v89
    v_exp_f32 v91, v91
    v_exp_f32 v92, v92
    v_mfma_f32_32x32x16_bf16 v[72:87], v[32:35], v[4:7], v[72:87]
    buffer_load_dword v36, v2, s[4:7], s24 offen
    s_add_u32 s24, s24, 2560
    v_cvt_pk_bf16_f32 v65, v90, v91
    v_exp_f32 v93, v93
    v_exp_f32 v94, v94
    v_cvt_pk_bf16_f32 v66, v92, v93
    v_exp_f32 v95, v95
    v_exp_f32 v96, v96
    v_mfma_f32_32x32x16_bf16 v[136:151], v[40:43], v[56:59], v[136:151]
    v_cvt_pk_bf16_f32 v67, v94, v95
    v_exp_f32 v97, v97
    v_exp_f32 v98, v98
    v_cvt_pk_bf16_f32 v68, v96, v97
    v_exp_f32 v99, v99
    v_exp_f32 v100, v100
    v_mfma_f32_32x32x16_bf16 v[136:151], v[44:47], v[60:63], v[136:151]
    v_cvt_pk_bf16_f32 v69, v98, v99
    v_exp_f32 v101, v101
    v_exp_f32 v102, v102
    v_cvt_pk_bf16_f32 v70, v100, v101
    v_exp_f32 v103, v103
    v_exp_f32 v72, v72
    v_cvt_pk_bf16_f32 v71, v102, v103
    v_mfma_f32_32x32x8_bf16 v[88:103], v[38:39], v[22:23], 0
    v_exp_f32 v73, v73
    v_exp_f32 v74, v74
    v_cvt_pk_bf16_f32 v56, v72, v73
    v_exp_f32 v75, v75
    v_exp_f32 v76, v76
    v_mfma_f32_32x32x16_bf16 v[88:103], v[32:35], v[8:11], v[88:103]
    v_cvt_pk_bf16_f32 v57, v74, v75
    v_exp_f32 v77, v77
    v_exp_f32 v78, v78
    v_cvt_pk_bf16_f32 v58, v76, v77
    v_exp_f32 v79, v79
    v_exp_f32 v80, v80
    v_mfma_f32_32x32x16_bf16 v[152:167], v[40:43], v[64:67], v[152:167]
    v_cvt_pk_bf16_f32 v59, v78, v79
    v_exp_f32 v81, v81
    v_exp_f32 v82, v82
    v_cvt_pk_bf16_f32 v60, v80, v81
    v_exp_f32 v83, v83
    v_exp_f32 v84, v84
    v_mfma_f32_32x32x16_bf16 v[152:167], v[44:47], v[68:71], v[152:167]
    v_cvt_pk_bf16_f32 v61, v82, v83
    v_exp_f32 v85, v85
    v_exp_f32 v86, v86
    v_cvt_pk_bf16_f32 v62, v84, v85
    v_exp_f32 v87, v87
    v_exp_f32 v88, v88
    v_cvt_pk_bf16_f32 v63, v86, v87
    v_mfma_f32_32x32x8_bf16 v[72:87], v[38:39], v[24:25], 0
    v_exp_f32 v89, v89
    v_exp_f32 v90, v90
    v_cvt_pk_bf16_f32 v64, v88, v89
    v_exp_f32 v91, v91
    v_exp_f32 v92, v92
    v_mfma_f32_32x32x16_bf16 v[72:87], v[32:35], v[12:15], v[72:87]
    v_cvt_pk_bf16_f32 v65, v90, v91
    v_exp_f32 v93, v93
    v_exp_f32 v94, v94
    v_cvt_pk_bf16_f32 v66, v92, v93
    v_exp_f32 v95, v95
    v_exp_f32 v96, v96
    s_waitcnt vmcnt(4)
    v_mfma_f32_32x32x16_bf16 v[104:119], v[48:51], v[56:59], v[104:119]
    v_cvt_pk_bf16_f32 v67, v94, v95
    v_exp_f32 v97, v97
    v_exp_f32 v98, v98
    v_cvt_pk_bf16_f32 v68, v96, v97
    v_exp_f32 v99, v99
    v_exp_f32 v100, v100
    v_mfma_f32_32x32x16_bf16 v[104:119], v[52:55], v[60:63], v[104:119]
    s_mov_b64 exec, s[14:15]
    buffer_load_dwordx4 v[40:43], v3, s[4:7], s23 offen
    buffer_load_dwordx4 v[44:47], v3, s[4:7], s23 offen offset:640
    s_mov_b64 exec, -1
    s_add_u32 s23, s23, 2560
    v_cvt_pk_bf16_f32 v69, v98, v99
    v_exp_f32 v101, v101
    v_exp_f32 v102, v102
    v_cvt_pk_bf16_f32 v70, v100, v101
    v_exp_f32 v103, v103
    v_exp_f32 v72, v72
    v_cvt_pk_bf16_f32 v71, v102, v103
    v_mfma_f32_32x32x8_bf16 v[88:103], v[38:39], v[26:27], 0
    v_exp_f32 v73, v73
    v_exp_f32 v74, v74
    v_cvt_pk_bf16_f32 v56, v72, v73
    v_exp_f32 v75, v75
    v_exp_f32 v76, v76
    v_mfma_f32_32x32x16_bf16 v[88:103], v[32:35], v[16:19], v[88:103]
    v_cvt_pk_bf16_f32 v57, v74, v75
    v_exp_f32 v77, v77
    v_exp_f32 v78, v78
    v_cvt_pk_bf16_f32 v58, v76, v77
    v_exp_f32 v79, v79
    v_exp_f32 v80, v80
    v_mfma_f32_32x32x16_bf16 v[120:135], v[48:51], v[64:67], v[120:135]
    buffer_load_dwordx4 v[228:231], v247, s[40:43], s46 offen
    buffer_load_dwordx4 v[232:235], v248, s[40:43], s46 offen
    buffer_load_dwordx4 v[236:239], v249, s[40:43], s46 offen
    v_cvt_pk_bf16_f32 v59, v78, v79
    v_exp_f32 v81, v81
    v_exp_f32 v82, v82
    v_cvt_pk_bf16_f32 v60, v80, v81
    v_exp_f32 v83, v83
    v_exp_f32 v84, v84
    v_mfma_f32_32x32x16_bf16 v[120:135], v[52:55], v[68:71], v[120:135]
    v_cvt_pk_bf16_f32 v61, v82, v83
    v_exp_f32 v85, v85
    v_exp_f32 v86, v86
    v_cvt_pk_bf16_f32 v62, v84, v85
    v_exp_f32 v87, v87
    v_exp_f32 v88, v88
    v_cvt_pk_bf16_f32 v63, v86, v87
    s_waitcnt vmcnt(5)
    v_mfma_f32_32x32x8_bf16 v[72:87], v[36:37], v[20:21], 0
    buffer_load_dwordx4 v[32:35], v1, s[4:7], s24 offen
    v_exp_f32 v89, v89
    v_exp_f32 v90, v90
    v_cvt_pk_bf16_f32 v64, v88, v89
    v_exp_f32 v91, v91
    v_exp_f32 v92, v92
    v_mfma_f32_32x32x16_bf16 v[72:87], v[28:31], v[4:7], v[72:87]
    buffer_load_dword v38, v2, s[4:7], s24 offen
    s_add_u32 s24, s24, 2560
    v_cvt_pk_bf16_f32 v65, v90, v91
    v_exp_f32 v93, v93
    v_exp_f32 v94, v94
    v_cvt_pk_bf16_f32 v66, v92, v93
    v_exp_f32 v95, v95
    v_exp_f32 v96, v96
    v_mfma_f32_32x32x16_bf16 v[136:151], v[48:51], v[56:59], v[136:151]
    v_cvt_pk_bf16_f32 v67, v94, v95
    v_exp_f32 v97, v97
    v_exp_f32 v98, v98
    v_cvt_pk_bf16_f32 v68, v96, v97
    v_exp_f32 v99, v99
    v_exp_f32 v100, v100
    v_mfma_f32_32x32x16_bf16 v[136:151], v[52:55], v[60:63], v[136:151]
    v_cvt_pk_bf16_f32 v69, v98, v99
    v_exp_f32 v101, v101
    v_exp_f32 v102, v102
    v_cvt_pk_bf16_f32 v70, v100, v101
    v_exp_f32 v103, v103
    s_setprio 1
    s_mul_i32 s30, s8, 6144
    s_xor_b32 s31, s8, 4
    s_mul_i32 s31, s31, 6144
    v_add_u32 v171, s30, v1
    v_add_u32 v172, s31, v1
    v_exp_f32 v72, v72
    v_cvt_pk_bf16_f32 v71, v102, v103
    v_mfma_f32_32x32x8_bf16 v[88:103], v[36:37], v[22:23], 0
    v_exp_f32 v73, v73
    v_exp_f32 v74, v74
    v_cvt_pk_bf16_f32 v56, v72, v73
    v_exp_f32 v75, v75
    v_exp_f32 v76, v76
    v_mfma_f32_32x32x16_bf16 v[88:103], v[28:31], v[8:11], v[88:103]
    v_cvt_pk_bf16_f32 v57, v74, v75
    v_exp_f32 v77, v77
    v_exp_f32 v78, v78
    v_cvt_pk_bf16_f32 v58, v76, v77
    v_exp_f32 v79, v79
    v_exp_f32 v80, v80
    v_mfma_f32_32x32x16_bf16 v[152:167], v[48:51], v[64:67], v[152:167]
    v_cvt_pk_bf16_f32 v59, v78, v79
    v_exp_f32 v81, v81
    v_exp_f32 v82, v82
    v_cvt_pk_bf16_f32 v60, v80, v81
    v_exp_f32 v83, v83
    v_exp_f32 v84, v84
    v_mfma_f32_32x32x16_bf16 v[152:167], v[52:55], v[68:71], v[152:167]
    v_cvt_pk_bf16_f32 v61, v82, v83
    v_exp_f32 v85, v85
    v_exp_f32 v86, v86
    v_cvt_pk_bf16_f32 v62, v84, v85
    v_exp_f32 v87, v87
    v_exp_f32 v88, v88
    v_cvt_pk_bf16_f32 v63, v86, v87
    v_mfma_f32_32x32x8_bf16 v[72:87], v[36:37], v[24:25], 0
    v_exp_f32 v89, v89
    v_exp_f32 v90, v90
    v_cvt_pk_bf16_f32 v64, v88, v89
    v_exp_f32 v91, v91
    v_exp_f32 v92, v92
    v_mfma_f32_32x32x16_bf16 v[72:87], v[28:31], v[12:15], v[72:87]
    v_cvt_pk_bf16_f32 v65, v90, v91
    v_exp_f32 v93, v93
    v_exp_f32 v94, v94
    v_cvt_pk_bf16_f32 v66, v92, v93
    v_exp_f32 v95, v95
    v_exp_f32 v96, v96
    s_waitcnt vmcnt(2)
    v_mfma_f32_32x32x16_bf16 v[104:119], v[40:43], v[56:59], v[104:119]
    v_cvt_pk_bf16_f32 v67, v94, v95
    v_exp_f32 v97, v97
    v_exp_f32 v98, v98
    v_cvt_pk_bf16_f32 v68, v96, v97
    v_exp_f32 v99, v99
    v_exp_f32 v100, v100
    v_mfma_f32_32x32x16_bf16 v[104:119], v[44:47], v[60:63], v[104:119]
    s_mov_b64 exec, s[14:15]
    buffer_load_dwordx4 v[48:51], v3, s[4:7], s23 offen
    buffer_load_dwordx4 v[52:55], v3, s[4:7], s23 offen offset:640
    s_mov_b64 exec, -1
    s_add_u32 s23, s23, 2560
    v_cvt_pk_bf16_f32 v69, v98, v99
    v_exp_f32 v101, v101
    v_exp_f32 v102, v102
    v_cvt_pk_bf16_f32 v70, v100, v101
    v_exp_f32 v103, v103
    v_exp_f32 v72, v72
    v_cvt_pk_bf16_f32 v71, v102, v103
    v_mfma_f32_32x32x8_bf16 v[88:103], v[36:37], v[26:27], 0
    v_exp_f32 v73, v73
    v_exp_f32 v74, v74
    v_cvt_pk_bf16_f32 v56, v72, v73
    v_exp_f32 v75, v75
    v_exp_f32 v76, v76
    v_mfma_f32_32x32x16_bf16 v[88:103], v[28:31], v[16:19], v[88:103]
    v_cvt_pk_bf16_f32 v57, v74, v75
    v_exp_f32 v77, v77
    v_exp_f32 v78, v78
    v_cvt_pk_bf16_f32 v58, v76, v77
    v_exp_f32 v79, v79
    v_exp_f32 v80, v80
    v_mfma_f32_32x32x16_bf16 v[120:135], v[40:43], v[64:67], v[120:135]
    v_cvt_pk_bf16_f32 v59, v78, v79
    v_exp_f32 v81, v81
    v_exp_f32 v82, v82
    v_cvt_pk_bf16_f32 v60, v80, v81
    v_exp_f32 v83, v83
    v_exp_f32 v84, v84
    v_mfma_f32_32x32x16_bf16 v[120:135], v[44:47], v[68:71], v[120:135]
    v_cvt_pk_bf16_f32 v61, v82, v83
    v_exp_f32 v85, v85
    v_exp_f32 v86, v86
    v_cvt_pk_bf16_f32 v62, v84, v85
    v_exp_f32 v87, v87
    v_exp_f32 v88, v88
    v_cvt_pk_bf16_f32 v63, v86, v87
    s_waitcnt vmcnt(2)
    v_mfma_f32_32x32x8_bf16 v[72:87], v[38:39], v[20:21], 0
    buffer_load_dwordx4 v[28:31], v1, s[4:7], s24 offen
    v_exp_f32 v89, v89
    v_exp_f32 v90, v90
    v_cvt_pk_bf16_f32 v64, v88, v89
    v_exp_f32 v91, v91
    v_exp_f32 v92, v92
    v_mfma_f32_32x32x16_bf16 v[72:87], v[32:35], v[4:7], v[72:87]
    buffer_load_dword v36, v2, s[4:7], s24 offen
    s_add_u32 s24, s24, 2560
    v_cvt_pk_bf16_f32 v65, v90, v91
    v_exp_f32 v93, v93
    v_exp_f32 v94, v94
    v_cvt_pk_bf16_f32 v66, v92, v93
    v_exp_f32 v95, v95
    v_exp_f32 v96, v96
    v_mfma_f32_32x32x16_bf16 v[136:151], v[40:43], v[56:59], v[136:151]
    v_cvt_pk_bf16_f32 v67, v94, v95
    v_exp_f32 v97, v97
    v_exp_f32 v98, v98
    v_cvt_pk_bf16_f32 v68, v96, v97
    v_exp_f32 v99, v99
    v_exp_f32 v100, v100
    v_mfma_f32_32x32x16_bf16 v[136:151], v[44:47], v[60:63], v[136:151]
    v_cvt_pk_bf16_f32 v69, v98, v99
    v_exp_f32 v101, v101
    v_exp_f32 v102, v102
    v_cvt_pk_bf16_f32 v70, v100, v101
    v_exp_f32 v103, v103
    v_exp_f32 v72, v72
    v_cvt_pk_bf16_f32 v71, v102, v103
    v_mfma_f32_32x32x8_bf16 v[88:103], v[38:39], v[22:23], 0
    v_exp_f32 v73, v73
    v_exp_f32 v74, v74
    v_cvt_pk_bf16_f32 v56, v72, v73
    v_exp_f32 v75, v75
    v_exp_f32 v76, v76
    v_mfma_f32_32x32x16_bf16 v[88:103], v[32:35], v[8:11], v[88:103]
    v_cvt_pk_bf16_f32 v57, v74, v75
    v_exp_f32 v77, v77
    v_exp_f32 v78, v78
    v_cvt_pk_bf16_f32 v58, v76, v77
    v_exp_f32 v79, v79
    v_exp_f32 v80, v80
    v_mfma_f32_32x32x16_bf16 v[152:167], v[40:43], v[64:67], v[152:167]
    v_cvt_pk_bf16_f32 v59, v78, v79
    v_exp_f32 v81, v81
    v_exp_f32 v82, v82
    v_cvt_pk_bf16_f32 v60, v80, v81
    v_exp_f32 v83, v83
    v_exp_f32 v84, v84
    v_mfma_f32_32x32x16_bf16 v[152:167], v[44:47], v[68:71], v[152:167]
    v_cvt_pk_bf16_f32 v61, v82, v83
    v_exp_f32 v85, v85
    v_exp_f32 v86, v86
    v_cvt_pk_bf16_f32 v62, v84, v85
    v_exp_f32 v87, v87
    v_exp_f32 v88, v88
    v_cvt_pk_bf16_f32 v63, v86, v87
    v_mfma_f32_32x32x8_bf16 v[72:87], v[38:39], v[24:25], 0
    v_exp_f32 v89, v89
    v_exp_f32 v90, v90
    v_cvt_pk_bf16_f32 v64, v88, v89
    v_exp_f32 v91, v91
    v_exp_f32 v92, v92
    v_mfma_f32_32x32x16_bf16 v[72:87], v[32:35], v[12:15], v[72:87]
    v_cvt_pk_bf16_f32 v65, v90, v91
    v_exp_f32 v93, v93
    v_exp_f32 v94, v94
    v_cvt_pk_bf16_f32 v66, v92, v93
    v_exp_f32 v95, v95
    v_exp_f32 v96, v96
    s_waitcnt vmcnt(2)
    v_mfma_f32_32x32x16_bf16 v[104:119], v[48:51], v[56:59], v[104:119]
    v_cvt_pk_bf16_f32 v67, v94, v95
    v_exp_f32 v97, v97
    v_exp_f32 v98, v98
    v_cvt_pk_bf16_f32 v68, v96, v97
    v_exp_f32 v99, v99
    v_exp_f32 v100, v100
    v_mfma_f32_32x32x16_bf16 v[104:119], v[52:55], v[60:63], v[104:119]
    s_mov_b64 exec, s[14:15]
    buffer_load_dwordx4 v[40:43], v3, s[4:7], s23 offen
    buffer_load_dwordx4 v[44:47], v3, s[4:7], s23 offen offset:640
    s_mov_b64 exec, -1
    s_add_u32 s23, s23, 2560
    v_cvt_pk_bf16_f32 v69, v98, v99
    v_exp_f32 v101, v101
    v_exp_f32 v102, v102
    v_cvt_pk_bf16_f32 v70, v100, v101
    v_exp_f32 v103, v103
    v_exp_f32 v72, v72
    v_cvt_pk_bf16_f32 v71, v102, v103
    v_mfma_f32_32x32x8_bf16 v[88:103], v[38:39], v[26:27], 0
    v_exp_f32 v73, v73
    v_exp_f32 v74, v74
    v_cvt_pk_bf16_f32 v56, v72, v73
    v_exp_f32 v75, v75
    v_exp_f32 v76, v76
    v_mfma_f32_32x32x16_bf16 v[88:103], v[32:35], v[16:19], v[88:103]
    v_cvt_pk_bf16_f32 v57, v74, v75
    v_exp_f32 v77, v77
    v_exp_f32 v78, v78
    v_cvt_pk_bf16_f32 v58, v76, v77
    v_exp_f32 v79, v79
    v_exp_f32 v80, v80
    v_mfma_f32_32x32x16_bf16 v[120:135], v[48:51], v[64:67], v[120:135]
    v_cvt_pk_bf16_f32 v59, v78, v79
    v_exp_f32 v81, v81
    v_exp_f32 v82, v82
    v_cvt_pk_bf16_f32 v60, v80, v81
    v_exp_f32 v83, v83
    v_exp_f32 v84, v84
    v_mfma_f32_32x32x16_bf16 v[120:135], v[52:55], v[68:71], v[120:135]
    v_cvt_pk_bf16_f32 v61, v82, v83
    v_exp_f32 v85, v85
    v_exp_f32 v86, v86
    v_cvt_pk_bf16_f32 v62, v84, v85
    v_exp_f32 v87, v87
    v_exp_f32 v88, v88
    v_cvt_pk_bf16_f32 v63, v86, v87
    s_waitcnt vmcnt(2)
    v_mfma_f32_32x32x8_bf16 v[72:87], v[36:37], v[20:21], 0
    buffer_load_dwordx4 v[32:35], v1, s[4:7], s24 offen
    v_exp_f32 v89, v89
    v_exp_f32 v90, v90
    v_cvt_pk_bf16_f32 v64, v88, v89
    v_exp_f32 v91, v91
    v_exp_f32 v92, v92
    v_mfma_f32_32x32x16_bf16 v[72:87], v[28:31], v[4:7], v[72:87]
    buffer_load_dword v38, v2, s[4:7], s24 offen
    s_add_u32 s24, s24, 2560
    v_cvt_pk_bf16_f32 v65, v90, v91
    v_exp_f32 v93, v93
    v_exp_f32 v94, v94
    v_cvt_pk_bf16_f32 v66, v92, v93
    v_exp_f32 v95, v95
    v_exp_f32 v96, v96
    v_mfma_f32_32x32x16_bf16 v[136:151], v[48:51], v[56:59], v[136:151]
    v_cvt_pk_bf16_f32 v67, v94, v95
    v_exp_f32 v97, v97
    v_exp_f32 v98, v98
    v_cvt_pk_bf16_f32 v68, v96, v97
    v_exp_f32 v99, v99
    v_exp_f32 v100, v100
    v_mfma_f32_32x32x16_bf16 v[136:151], v[52:55], v[60:63], v[136:151]
    v_cvt_pk_bf16_f32 v69, v98, v99
    v_exp_f32 v101, v101
    v_exp_f32 v102, v102
    v_cvt_pk_bf16_f32 v70, v100, v101
    v_exp_f32 v103, v103
    v_exp_f32 v72, v72
    v_cvt_pk_bf16_f32 v71, v102, v103
    v_mfma_f32_32x32x8_bf16 v[88:103], v[36:37], v[22:23], 0
    v_exp_f32 v73, v73
    v_exp_f32 v74, v74
    v_cvt_pk_bf16_f32 v56, v72, v73
    v_exp_f32 v75, v75
    v_exp_f32 v76, v76
    v_mfma_f32_32x32x16_bf16 v[88:103], v[28:31], v[8:11], v[88:103]
    v_cvt_pk_bf16_f32 v57, v74, v75
    v_exp_f32 v77, v77
    v_exp_f32 v78, v78
    v_cvt_pk_bf16_f32 v58, v76, v77
    v_exp_f32 v79, v79
    v_exp_f32 v80, v80
    v_mfma_f32_32x32x16_bf16 v[152:167], v[48:51], v[64:67], v[152:167]
    v_cvt_pk_bf16_f32 v59, v78, v79
    v_exp_f32 v81, v81
    v_exp_f32 v82, v82
    v_cvt_pk_bf16_f32 v60, v80, v81
    v_exp_f32 v83, v83
    v_exp_f32 v84, v84
    v_mfma_f32_32x32x16_bf16 v[152:167], v[52:55], v[68:71], v[152:167]
    v_cvt_pk_bf16_f32 v61, v82, v83
    v_exp_f32 v85, v85
    v_exp_f32 v86, v86
    v_cvt_pk_bf16_f32 v62, v84, v85
    v_exp_f32 v87, v87
    v_exp_f32 v88, v88
    v_cvt_pk_bf16_f32 v63, v86, v87
    v_mfma_f32_32x32x8_bf16 v[72:87], v[36:37], v[24:25], 0
    v_exp_f32 v89, v89
    v_exp_f32 v90, v90
    v_cvt_pk_bf16_f32 v64, v88, v89
    v_exp_f32 v91, v91
    v_exp_f32 v92, v92
    v_mfma_f32_32x32x16_bf16 v[72:87], v[28:31], v[12:15], v[72:87]
    v_cvt_pk_bf16_f32 v65, v90, v91
    v_exp_f32 v93, v93
    v_exp_f32 v94, v94
    v_cvt_pk_bf16_f32 v66, v92, v93
    v_exp_f32 v95, v95
    v_exp_f32 v96, v96
    s_waitcnt vmcnt(2)
    v_mfma_f32_32x32x16_bf16 v[104:119], v[40:43], v[56:59], v[104:119]
    v_cvt_pk_bf16_f32 v67, v94, v95
    v_exp_f32 v97, v97
    v_exp_f32 v98, v98
    v_cvt_pk_bf16_f32 v68, v96, v97
    v_exp_f32 v99, v99
    v_exp_f32 v100, v100
    v_mfma_f32_32x32x16_bf16 v[104:119], v[44:47], v[60:63], v[104:119]
    s_mov_b64 exec, s[14:15]
    buffer_load_dwordx4 v[48:51], v3, s[4:7], s23 offen
    buffer_load_dwordx4 v[52:55], v3, s[4:7], s23 offen offset:640
    s_mov_b64 exec, -1
    s_add_u32 s23, s23, 2560
    v_cvt_pk_bf16_f32 v69, v98, v99
    v_exp_f32 v101, v101
    v_exp_f32 v102, v102
    v_cvt_pk_bf16_f32 v70, v100, v101
    v_exp_f32 v103, v103
    v_exp_f32 v72, v72
    v_cvt_pk_bf16_f32 v71, v102, v103
    v_mfma_f32_32x32x8_bf16 v[88:103], v[36:37], v[26:27], 0
    v_exp_f32 v73, v73
    v_exp_f32 v74, v74
    v_cvt_pk_bf16_f32 v56, v72, v73
    v_exp_f32 v75, v75
    v_exp_f32 v76, v76
    v_mfma_f32_32x32x16_bf16 v[88:103], v[28:31], v[16:19], v[88:103]
    v_cvt_pk_bf16_f32 v57, v74, v75
    v_exp_f32 v77, v77
    v_exp_f32 v78, v78
    v_cvt_pk_bf16_f32 v58, v76, v77
    v_exp_f32 v79, v79
    v_exp_f32 v80, v80
    v_mfma_f32_32x32x16_bf16 v[120:135], v[40:43], v[64:67], v[120:135]
    v_cvt_pk_bf16_f32 v59, v78, v79
    v_exp_f32 v81, v81
    v_exp_f32 v82, v82
    v_cvt_pk_bf16_f32 v60, v80, v81
    v_exp_f32 v83, v83
    v_exp_f32 v84, v84
    v_mfma_f32_32x32x16_bf16 v[120:135], v[44:47], v[68:71], v[120:135]
    v_cvt_pk_bf16_f32 v61, v82, v83
    v_exp_f32 v85, v85
    v_exp_f32 v86, v86
    v_cvt_pk_bf16_f32 v62, v84, v85
    v_exp_f32 v87, v87
    v_exp_f32 v88, v88
    v_cvt_pk_bf16_f32 v63, v86, v87
    s_waitcnt vmcnt(2)
    v_mfma_f32_32x32x8_bf16 v[72:87], v[38:39], v[20:21], 0
    v_exp_f32 v89, v89
    v_exp_f32 v90, v90
    v_cvt_pk_bf16_f32 v64, v88, v89
    v_exp_f32 v91, v91
    v_exp_f32 v92, v92
    v_mfma_f32_32x32x16_bf16 v[72:87], v[32:35], v[4:7], v[72:87]
    v_cvt_pk_bf16_f32 v65, v90, v91
    v_exp_f32 v93, v93
    v_exp_f32 v94, v94
    v_cvt_pk_bf16_f32 v66, v92, v93
    v_exp_f32 v95, v95
    v_exp_f32 v96, v96
    v_mfma_f32_32x32x16_bf16 v[136:151], v[40:43], v[56:59], v[136:151]
    v_cvt_pk_bf16_f32 v67, v94, v95
    v_exp_f32 v97, v97
    v_exp_f32 v98, v98
    v_cvt_pk_bf16_f32 v68, v96, v97
    v_exp_f32 v99, v99
    v_exp_f32 v100, v100
    v_mfma_f32_32x32x16_bf16 v[136:151], v[44:47], v[60:63], v[136:151]
    v_cvt_pk_bf16_f32 v69, v98, v99
    v_exp_f32 v101, v101
    v_exp_f32 v102, v102
    v_cvt_pk_bf16_f32 v70, v100, v101
    v_exp_f32 v103, v103
    s_setprio 0
    v_exp_f32 v72, v72
    v_cvt_pk_bf16_f32 v71, v102, v103
    v_mfma_f32_32x32x8_bf16 v[88:103], v[38:39], v[22:23], 0
    v_exp_f32 v73, v73
    v_exp_f32 v74, v74
    v_cvt_pk_bf16_f32 v56, v72, v73
    v_exp_f32 v75, v75
    v_exp_f32 v76, v76
    v_mfma_f32_32x32x16_bf16 v[88:103], v[32:35], v[8:11], v[88:103]
    v_cvt_pk_bf16_f32 v57, v74, v75
    v_exp_f32 v77, v77
    v_exp_f32 v78, v78
    v_cvt_pk_bf16_f32 v58, v76, v77
    v_exp_f32 v79, v79
    v_exp_f32 v80, v80
    v_mfma_f32_32x32x16_bf16 v[152:167], v[40:43], v[64:67], v[152:167]
    v_cvt_pk_bf16_f32 v59, v78, v79
    v_exp_f32 v81, v81
    v_exp_f32 v82, v82
    v_cvt_pk_bf16_f32 v60, v80, v81
    v_exp_f32 v83, v83
    v_exp_f32 v84, v84
    v_mfma_f32_32x32x16_bf16 v[152:167], v[44:47], v[68:71], v[152:167]
    v_cvt_pk_bf16_f32 v61, v82, v83
    v_exp_f32 v85, v85
    v_exp_f32 v86, v86
    v_cvt_pk_bf16_f32 v62, v84, v85
    v_exp_f32 v87, v87
    v_exp_f32 v88, v88
    v_cvt_pk_bf16_f32 v63, v86, v87
    v_mfma_f32_32x32x8_bf16 v[72:87], v[38:39], v[24:25], 0
    v_exp_f32 v89, v89
    v_exp_f32 v90, v90
    v_cvt_pk_bf16_f32 v64, v88, v89
    v_exp_f32 v91, v91
    v_exp_f32 v92, v92
    v_mfma_f32_32x32x16_bf16 v[72:87], v[32:35], v[12:15], v[72:87]
    v_cvt_pk_bf16_f32 v65, v90, v91
    v_exp_f32 v93, v93
    v_exp_f32 v94, v94
    v_cvt_pk_bf16_f32 v66, v92, v93
    v_exp_f32 v95, v95
    v_exp_f32 v96, v96
    s_waitcnt vmcnt(0)
    v_mfma_f32_32x32x16_bf16 v[104:119], v[48:51], v[56:59], v[104:119]
    v_cvt_pk_bf16_f32 v67, v94, v95
    v_exp_f32 v97, v97
    v_exp_f32 v98, v98
    v_cvt_pk_bf16_f32 v68, v96, v97
    v_exp_f32 v99, v99
    v_exp_f32 v100, v100
    v_mfma_f32_32x32x16_bf16 v[104:119], v[52:55], v[60:63], v[104:119]
    v_cvt_pk_bf16_f32 v69, v98, v99
    v_exp_f32 v101, v101
    v_exp_f32 v102, v102
    v_cvt_pk_bf16_f32 v70, v100, v101
    v_exp_f32 v103, v103
    v_exp_f32 v72, v72
    v_cvt_pk_bf16_f32 v71, v102, v103
    v_mfma_f32_32x32x8_bf16 v[88:103], v[38:39], v[26:27], 0
    v_exp_f32 v73, v73
    v_exp_f32 v74, v74
    v_cvt_pk_bf16_f32 v56, v72, v73
    v_exp_f32 v75, v75
    v_exp_f32 v76, v76
    v_mfma_f32_32x32x16_bf16 v[88:103], v[32:35], v[16:19], v[88:103]
    v_cvt_pk_bf16_f32 v57, v74, v75
    v_exp_f32 v77, v77
    v_exp_f32 v78, v78
    v_cvt_pk_bf16_f32 v58, v76, v77
    v_exp_f32 v79, v79
    v_exp_f32 v80, v80
    v_mfma_f32_32x32x16_bf16 v[120:135], v[48:51], v[64:67], v[120:135]
    v_cvt_pk_bf16_f32 v59, v78, v79
    v_exp_f32 v81, v81
    v_exp_f32 v82, v82
    v_cvt_pk_bf16_f32 v60, v80, v81
    v_exp_f32 v83, v83
    v_exp_f32 v84, v84
    v_mfma_f32_32x32x16_bf16 v[120:135], v[52:55], v[68:71], v[120:135]
    v_cvt_pk_bf16_f32 v61, v82, v83
    v_exp_f32 v85, v85
    v_exp_f32 v86, v86
    v_cvt_pk_bf16_f32 v62, v84, v85
    v_exp_f32 v87, v87
    v_exp_f32 v88, v88
    v_cvt_pk_bf16_f32 v63, v86, v87
    v_exp_f32 v89, v89
    v_exp_f32 v90, v90
    v_cvt_pk_bf16_f32 v64, v88, v89
    v_exp_f32 v91, v91
    v_exp_f32 v92, v92
    v_cvt_pk_bf16_f32 v65, v90, v91
    v_exp_f32 v93, v93
    v_exp_f32 v94, v94
    v_cvt_pk_bf16_f32 v66, v92, v93
    v_exp_f32 v95, v95
    v_exp_f32 v96, v96
    v_mfma_f32_32x32x16_bf16 v[136:151], v[48:51], v[56:59], v[136:151]
    ds_write_b128 v171, v[104:107] offset:0
    ds_write_b128 v171, v[108:111] offset:1024
    ds_write_b128 v171, v[112:115] offset:2048
    v_cvt_pk_bf16_f32 v67, v94, v95
    v_exp_f32 v97, v97
    v_exp_f32 v98, v98
    v_cvt_pk_bf16_f32 v68, v96, v97
    v_exp_f32 v99, v99
    v_exp_f32 v100, v100
    v_mfma_f32_32x32x16_bf16 v[136:151], v[52:55], v[60:63], v[136:151]
    v_cvt_pk_bf16_f32 v69, v98, v99
    v_exp_f32 v101, v101
    v_exp_f32 v102, v102
    v_cvt_pk_bf16_f32 v70, v100, v101
    v_exp_f32 v103, v103
    s_nop 0
    v_cvt_pk_bf16_f32 v71, v102, v103
    s_nop 1
    v_mfma_f32_32x32x16_bf16 v[152:167], v[48:51], v[64:67], v[152:167]
    v_mfma_f32_32x32x16_bf16 v[152:167], v[52:55], v[68:71], v[152:167]
L_mk_c1:
    ds_write_b128 v171, v[120:123] offset:3072
    ds_write_b128 v171, v[124:127] offset:4096
    ds_write_b128 v171, v[128:131] offset:5120
    s_waitcnt lgkmcnt(0)
    s_barrier
    ds_read_b128 v[104:107], v172 offset:0
    ds_read_b128 v[108:111], v172 offset:1024
    ds_read_b128 v[112:115], v172 offset:2048
    ds_read_b128 v[120:123], v172 offset:3072
    ds_read_b128 v[124:127], v172 offset:4096
    ds_read_b128 v[128:131], v172 offset:5120
    s_waitcnt lgkmcnt(3)
    v_add_f32 v104, v136, v104
    v_add_f32 v105, v137, v105
    v_add_f32 v106, v138, v106
    v_add_f32 v107, v139, v107
    v_add_f32 v108, v140, v108
    v_add_f32 v109, v141, v109
    v_add_f32 v110, v142, v110
    v_add_f32 v111, v143, v111
    v_add_f32 v112, v144, v112
    v_add_f32 v113, v145, v113
    v_add_f32 v114, v146, v114
    v_add_f32 v115, v147, v115
    s_waitcnt lgkmcnt(0)
    v_add_f32 v120, v152, v120
    v_add_f32 v121, v153, v121
    v_add_f32 v122, v154, v122
    v_add_f32 v123, v155, v123
    v_add_f32 v124, v156, v124
    v_add_f32 v125, v157, v125
    v_add_f32 v126, v158, v126
    v_add_f32 v127, v159, v127
    v_add_f32 v128, v160, v128
    v_add_f32 v129, v161, v129
    v_add_f32 v130, v162, v130
    v_add_f32 v131, v163, v131
L_mk_cj:
    s_mov_b64 s[30:31], 0
    s_mov_b32 s32, 0x21800000
    v_mov_b32 v62, v112
    v_mov_b32 v63, v112
    v_mov_b32 v70, v128
    v_mov_b32 v71, v128
    v_cmp_nle_f32 vcc, s32, v112
    s_or_b64 s[30:31], s[30:31], vcc
    v_cmp_nle_f32 vcc, s32, v128
    s_or_b64 s[30:31], s[30:31], vcc
    v_permlane32_swap_b32 v63, v62
    v_permlane32_swap_b32 v71, v70
    v_mov_b32 v173, 72704
    v_mov_b32 v174, 1
    s_cmp_eq_u32 s31, 0
    s_cbranch_scc1 L_mk_ok
    ds_write_b32 v173, v174
L_mk_ok:
    v_bfe_u32 v168, v0, 4, 1
    v_mul_u32_u24 v172, 40960, v168
    v_and_b32 v168, 15, v0
    v_lshl_add_u32 v172, v168, 4, v172
    v_bfe_u32 v168, v0, 5, 1
    v_lshl_add_u32 v171, v168, 8, v172
    s_lshl_b32 s21, s10, 2
    s_lshl_b32 s33, s13, 1
    s_add_u32 s21, s21, s33
    s_and_b32 s35, s9, 31
    s_lshr_b32 s36, s9, 5
    s_mul_i32 s36, s36, 80
    s_mul_i32 s33, s21, 81920
    s_add_u32 s33, s33, 10698752
    s_lshr_b32 s37, s35, 1
    s_add_u32 s37, s37, s36
    s_add_u32 s37, s37, 64
    s_lshl_b32 s37, s37, 8
    s_and_b32 s38, s35, 1
    s_lshl_b32 s38, s38, 3
    s_add_u32 s37, s37, s38
    s_add_u32 s34, s33, s37
    s_lshl_b32 s35, s35, 1
    s_add_u32 s35, s35, s36
    s_lshl_b32 s35, s35, 8
    s_add_u32 s33, s33, s35
    v_rcp_f32 v62, v62
    v_rcp_f32 v70, v70
    s_nop 0
    v_mul_f32 v104, v104, v62
    v_mul_f32 v105, v105, v62
    v_mul_f32 v106, v106, v62
    v_mul_f32 v107, v107, v62
    v_mul_f32 v108, v108, v62
    v_mul_f32 v109, v109, v62
    v_mul_f32 v110, v110, v62
    v_mul_f32 v111, v111, v62
    v_mul_f32 v112, v112, v62
    v_mul_f32 v113, v113, v62
    v_mul_f32 v114, v114, v62
    v_mul_f32 v115, v115, v62
    v_cvt_pk_bf16_f32 v56, v104, v105
    v_cvt_pk_bf16_f32 v57, v106, v107
    v_cvt_pk_bf16_f32 v58, v108, v109
    v_cvt_pk_bf16_f32 v59, v110, v111
    v_cvt_pk_bf16_f32 v60, v112, v113
    v_cvt_pk_bf16_f32 v61, v114, v115
    v_permlane32_swap_b32 v56, v58
    v_permlane32_swap_b32 v57, v59
    buffer_store_dwordx4 v[56:59], v171, s[4:7], s33 offen sc1
    s_mov_b64 exec, 0xffffffff
    buffer_store_dwordx2 v[60:61], v172, s[4:7], s34 offen sc1
    s_mov_b64 exec, -1
    s_add_u32 s33, s33, 81920
    s_add_u32 s34, s34, 81920
    v_mul_f32 v120, v120, v70
    v_mul_f32 v121, v121, v70
    v_mul_f32 v122, v122, v70
    v_mul_f32 v123, v123, v70
    v_mul_f32 v124, v124, v70
    v_mul_f32 v125, v125, v70
    v_mul_f32 v126, v126, v70
    v_mul_f32 v127, v127, v70
    v_mul_f32 v128, v128, v70
    v_mul_f32 v129, v129, v70
    v_mul_f32 v130, v130, v70
    v_mul_f32 v131, v131, v70
    v_cvt_pk_bf16_f32 v64, v120, v121
    v_cvt_pk_bf16_f32 v65, v122, v123
    v_cvt_pk_bf16_f32 v66, v124, v125
    v_cvt_pk_bf16_f32 v67, v126, v127
    v_cvt_pk_bf16_f32 v68, v128, v129
    v_cvt_pk_bf16_f32 v69, v130, v131
    v_permlane32_swap_b32 v64, v66
    v_permlane32_swap_b32 v65, v67
    buffer_store_dwordx4 v[64:67], v171, s[4:7], s33 offen sc1
    s_mov_b64 exec, 0xffffffff
    buffer_store_dwordx2 v[68:69], v172, s[4:7], s34 offen sc1
    s_mov_b64 exec, -1
    s_add_u32 s33, s33, 81920
    s_add_u32 s34, s34, 81920
    s_waitcnt vmcnt(0) lgkmcnt(0)
    s_barrier
    ds_read_b32 v174, v173
    s_waitcnt lgkmcnt(0)
    v_readfirstlane_b32 s30, v174
    s_nop 3
    s_andn2_b32 s30, s30, s20
    s_cmp_lg_u32 s30, 0
    s_cbranch_scc1 L_mk_truemax
    s_cmp_lg_u32 s53, 4
    s_cbranch_scc1 L_mk_sig1_7
    v_and_b32 v253, 63, v0
    v_lshlrev_b32 v253, 3, v253
    s_lshl_b32 s36, s55, 4
    s_add_u32 s36, s36, s58
    s_lshl_b32 s36, s36, 7
    s_add_u32 s36, s36, 15974400
    s_mov_b64 exec, 0xffff
    buffer_store_dwordx2 v[254:255], v253, s[4:7], s36 offen sc1
    s_mov_b64 exec, -1
L_mk_sig1_7:
    s_barrier
    v_and_b32 v168, 63, v0
    v_lshlrev_b32 v166, 4, v168
    v_add_u32 v248, s44, v166
    v_add_u32 v249, 81920, v248
    ds_write_b128 v248, v[180:183] offset:0
    ds_write_b128 v248, v[184:187] offset:1024
    ds_write_b128 v248, v[188:191] offset:2048
    ds_write_b128 v248, v[192:195] offset:3072
    ds_write_b128 v248, v[196:199] offset:4096
    ds_write_b128 v248, v[200:203] offset:40960
    ds_write_b128 v248, v[204:207] offset:41984
    ds_write_b128 v248, v[208:211] offset:43008
    ds_write_b128 v248, v[212:215] offset:44032
    ds_write_b128 v248, v[216:219] offset:45056
    s_load_dwordx2 s[12:13], s[0:1], 72
    v_lshrrev_b32 v170, 4, v168
    v_and_b32 v171, 1, v170
    v_bfe_u32 v172, v168, 2, 2
    v_lshl_add_u32 v172, v170, 3, v172
    v_and_b32 v173, 3, v168
    v_lshlrev_b32 v173, 3, v173
    s_mul_i32 s22, s49, 10240
    s_mul_i32 s23, s50, 5120
    s_add_u32 s22, s22, s23
    s_add_u32 s22, s22, 81920
    v_add_u32 v173, s22, v173
    v_xor_b32 v174, 0, v171
    v_lshl_add_u32 v174, v174, 2, v172
    v_mul_u32_u24 v174, 160, v174
    v_add_u32 v164, v174, v173
    v_xor_b32 v174, 1, v171
    v_lshl_add_u32 v174, v174, 2, v172
    v_mul_u32_u24 v174, 160, v174
    v_add_u32 v165, v174, v173
    ds_read_b64_tr_b16 v[124:125], v164 offset:0
    ds_read_b64_tr_b16 v[126:127], v165 offset:0
    ds_read_b64_tr_b16 v[128:129], v164 offset:32
    ds_read_b64_tr_b16 v[130:131], v165 offset:32
    ds_read_b64_tr_b16 v[132:133], v164 offset:64
    ds_read_b64_tr_b16 v[134:135], v165 offset:64
    ds_read_b64_tr_b16 v[136:137], v164 offset:96
    ds_read_b64_tr_b16 v[138:139], v165 offset:96
    ds_read_b64_tr_b16 v[140:141], v164 offset:128
    ds_read_b64_tr_b16 v[142:143], v165 offset:128
    ds_read_b64_tr_b16 v[144:145], v164 offset:20480
    ds_read_b64_tr_b16 v[146:147], v165 offset:20480
    ds_read_b64_tr_b16 v[148:149], v164 offset:20512
    ds_read_b64_tr_b16 v[150:151], v165 offset:20512
    ds_read_b64_tr_b16 v[152:153], v164 offset:20544
    ds_read_b64_tr_b16 v[154:155], v165 offset:20544
    ds_read_b64_tr_b16 v[156:157], v164 offset:20576
    ds_read_b64_tr_b16 v[158:159], v165 offset:20576
    ds_read_b64_tr_b16 v[160:161], v164 offset:20608
    ds_read_b64_tr_b16 v[162:163], v165 offset:20608
    s_waitcnt lgkmcnt(0)
    ds_read_b64_tr_b16 v[180:181], v164 offset:40960
    ds_read_b64_tr_b16 v[182:183], v165 offset:40960
    ds_read_b64_tr_b16 v[184:185], v164 offset:40992
    ds_read_b64_tr_b16 v[186:187], v165 offset:40992
    ds_read_b64_tr_b16 v[188:189], v164 offset:41024
    ds_read_b64_tr_b16 v[190:191], v165 offset:41024
    ds_read_b64_tr_b16 v[192:193], v164 offset:41056
    ds_read_b64_tr_b16 v[194:195], v165 offset:41056
    ds_read_b64_tr_b16 v[196:197], v164 offset:41088
    ds_read_b64_tr_b16 v[198:199], v165 offset:41088
    ds_read_b64_tr_b16 v[200:201], v164 offset:61440
    ds_read_b64_tr_b16 v[202:203], v165 offset:61440
    ds_read_b64_tr_b16 v[204:205], v164 offset:61472
    ds_read_b64_tr_b16 v[206:207], v165 offset:61472
    ds_read_b64_tr_b16 v[208:209], v164 offset:61504
    ds_read_b64_tr_b16 v[210:211], v165 offset:61504
    ds_read_b64_tr_b16 v[212:213], v164 offset:61536
    ds_read_b64_tr_b16 v[214:215], v165 offset:61536
    ds_read_b64_tr_b16 v[216:217], v164 offset:61568
    ds_read_b64_tr_b16 v[218:219], v165 offset:61568
    v_subrev_u32 v164, 81920, v164
    v_subrev_u32 v165, 81920, v165
    s_and_b32 s13, s13, 0xffff
    s_mov_b32 s14, 2621440
    s_mov_b32 s15, 0x20000
    s_lshl_b32 s9, s55, 1
    s_bfe_u32 s36, s58, 0x10002
    s_add_u32 s9, s9, s36
    s_lshl_b32 s20, s9, 2
    s_lshl_b32 s21, s48, 1
    s_add_u32 s20, s20, s21
    s_add_u32 s27, s20, s49
    s_lshl_b32 s24, s27, 7
    s_add_u32 s24, s24, 10682368
    s_mul_i32 s26, s27, 20480
    s_add_u32 s26, s26, s51
    s_lshl_b32 s36, s50, 6
    s_add_u32 s25, s26, s36
    s_mul_i32 s20, s20, 40960
    s_mul_i32 s21, s49, 20480
    s_add_u32 s20, s20, s21
    s_lshl_b32 s21, s50, 10
    s_add_u32 s20, s20, s21
    s_add_u32 s20, s20, 10698752
    s_add_u32 s21, s20, 40960
    s_lshl_b32 s36, s49, 1
    s_add_u32 s36, s36, s50
    s_lshl_b32 s37, s48, 2
    s_add_u32 s36, s36, s37
    s_mul_i32 s36, s36, 10240
    s_mul_i32 s37, s48, 40960
    s_mul_i32 s38, s49, 5120
    s_add_u32 s37, s37, s38
    s_lshl_b32 s38, s50, 11
    s_add_u32 s38, s38, s37
    v_add_u32 v167, s36, v166
    v_add_u32 v244, s38, v166
    v_add_u32 v245, s37, v166
    v_and_b32 v169, 15, v168
    v_lshlrev_b32 v240, 3, v169
    v_mul_u32_u24 v242, 1280, v169
    v_lshl_add_u32 v243, v170, 3, v242
    v_lshl_add_u32 v242, v171, 5, v242
    v_lshrrev_b32 v170, 1, v170
    v_lshl_add_u32 v242, v170, 4, v242
    s_waitcnt lgkmcnt(0)
    s_cmp_lg_u32 s53, 4
    s_cbranch_scc1 L_mk_pd8
    v_and_b32 v250, 63, v0
    v_and_b32 v251, 15, v250
    s_lshl_b32 s36, s55, 4
    v_add_u32 v251, s36, v251
    v_lshlrev_b32 v251, 7, v251
    s_mov_b32 s36, 0
    s_mov_b32 s37, 15974400
L_mk_pl8:
    buffer_load_dwordx2 v[252:253], v251, s[4:7], s37 offen sc1
    s_waitcnt vmcnt(0)
    v_cmp_ne_u64 vcc, v[252:253], v[254:255]
    s_add_u32 s36, s36, 1
    s_nop 3
    s_cmp_eq_u64 vcc, 0
    s_cbranch_scc1 L_mk_pd8
    s_mov_b64 exec, vcc
    s_sleep 2
    s_cmp_lt_u32 s36, 100000
    s_cbranch_scc1 L_mk_pl8
L_mk_pd8:
    s_mov_b64 exec, -1
    s_barrier
    s_setprio 3
    s_add_u32 s36, s99, 0
    s_and_b32 s36, s36, 7
    s_lshl_b32 s36, s36, 11
    s_add_u32 s37, s36, s21
    s_add_u32 s36, s36, s20
    buffer_load_dwordx4 v[44:47], v166, s[4:7], s36 offen
    buffer_load_dwordx4 v[48:51], v166, s[4:7], s37 offen
    s_add_u32 s36, s99, 1
    s_and_b32 s36, s36, 7
    s_lshl_b32 s36, s36, 11
    s_add_u32 s37, s36, s21
    s_add_u32 s36, s36, s20
    buffer_load_dwordx4 v[52:55], v166, s[4:7], s36 offen
    buffer_load_dwordx4 v[56:59], v166, s[4:7], s37 offen
    ds_write_b128 v249, v[220:223] offset:0
    ds_write_b128 v249, v[224:227] offset:1024
    ds_write_b128 v249, v[228:231] offset:2048
    ds_write_b128 v249, v[232:235] offset:3072
    ds_write_b128 v249, v[236:239] offset:4096
    s_setprio 2
    s_add_u32 s36, s99, 2
    s_and_b32 s36, s36, 7
    s_lshl_b32 s36, s36, 11
    s_add_u32 s37, s36, s21
    s_add_u32 s36, s36, s20
    buffer_load_dwordx4 v[60:63], v166, s[4:7], s36 offen
    buffer_load_dwordx4 v[64:67], v166, s[4:7], s37 offen
    s_setprio 0
    s_waitcnt lgkmcnt(0)
    ds_read_b64_tr_b16 v[220:221], v164 offset:0
    ds_read_b64_tr_b16 v[222:223], v165 offset:0
    ds_read_b64_tr_b16 v[224:225], v164 offset:32
    ds_read_b64_tr_b16 v[226:227], v165 offset:32
    ds_read_b64_tr_b16 v[228:229], v164 offset:64
    ds_read_b64_tr_b16 v[230:231], v165 offset:64
    ds_read_b64_tr_b16 v[232:233], v164 offset:96
    ds_read_b64_tr_b16 v[234:235], v165 offset:96
    ds_read_b64_tr_b16 v[236:237], v164 offset:128
    ds_read_b64_tr_b16 v[238:239], v165 offset:128
    s_waitcnt vmcnt(4)
    v_mfma_f32_16x16x32_bf16 v[4:7], v[124:127], v[44:47], 0
    v_mfma_f32_16x16x32_bf16 v[24:27], v[124:127], v[48:51], 0
    v_mfma_f32_16x16x32_bf16 v[8:11], v[128:131], v[44:47], 0
    v_mfma_f32_16x16x32_bf16 v[28:31], v[128:131], v[48:51], 0
    s_add_u32 s36, s99, 3
    s_and_b32 s36, s36, 7
    s_lshl_b32 s36, s36, 11
    s_add_u32 s37, s36, s21
    s_add_u32 s36, s36, s20
    buffer_load_dwordx4 v[68:71], v166, s[4:7], s36 offen
    buffer_load_dwordx4 v[72:75], v166, s[4:7], s37 offen
    v_mfma_f32_16x16x32_bf16 v[12:15], v[132:135], v[44:47], 0
    v_mfma_f32_16x16x32_bf16 v[32:35], v[132:135], v[48:51], 0
    v_mfma_f32_16x16x32_bf16 v[16:19], v[136:139], v[44:47], 0
    v_mfma_f32_16x16x32_bf16 v[36:39], v[136:139], v[48:51], 0
    v_mfma_f32_16x16x32_bf16 v[20:23], v[140:143], v[44:47], 0
    v_mfma_f32_16x16x32_bf16 v[40:43], v[140:143], v[48:51], 0
    ds_read_b64_tr_b16 v[124:125], v164 offset:20480
    ds_read_b64_tr_b16 v[126:127], v165 offset:20480
    ds_read_b64_tr_b16 v[128:129], v164 offset:20512
    ds_read_b64_tr_b16 v[130:131], v165 offset:20512
    ds_read_b64_tr_b16 v[132:133], v164 offset:20544
    ds_read_b64_tr_b16 v[134:135], v165 offset:20544
    ds_read_b64_tr_b16 v[136:137], v164 offset:20576
    ds_read_b64_tr_b16 v[138:139], v165 offset:20576
    ds_read_b64_tr_b16 v[140:141], v164 offset:20608
    ds_read_b64_tr_b16 v[142:143], v165 offset:20608
    s_waitcnt vmcnt(4)
    v_mfma_f32_16x16x32_bf16 v[4:7], v[144:147], v[52:55], v[4:7]
    v_mfma_f32_16x16x32_bf16 v[24:27], v[144:147], v[56:59], v[24:27]
    v_mfma_f32_16x16x32_bf16 v[8:11], v[148:151], v[52:55], v[8:11]
    v_mfma_f32_16x16x32_bf16 v[28:31], v[148:151], v[56:59], v[28:31]
    s_add_u32 s36, s99, 4
    s_and_b32 s36, s36, 7
    s_lshl_b32 s36, s36, 11
    s_add_u32 s37, s36, s21
    s_add_u32 s36, s36, s20
    buffer_load_dwordx4 v[76:79], v166, s[4:7], s36 offen
    buffer_load_dwordx4 v[80:83], v166, s[4:7], s37 offen
    v_mfma_f32_16x16x32_bf16 v[12:15], v[152:155], v[52:55], v[12:15]
    v_mfma_f32_16x16x32_bf16 v[32:35], v[152:155], v[56:59], v[32:35]
    v_mfma_f32_16x16x32_bf16 v[16:19], v[156:159], v[52:55], v[16:19]
    v_mfma_f32_16x16x32_bf16 v[36:39], v[156:159], v[56:59], v[36:39]
    v_mfma_f32_16x16x32_bf16 v[20:23], v[160:163], v[52:55], v[20:23]
    v_mfma_f32_16x16x32_bf16 v[40:43], v[160:163], v[56:59], v[40:43]
    ds_read_b64_tr_b16 v[144:145], v164 offset:40960
    ds_read_b64_tr_b16 v[146:147], v165 offset:40960
    ds_read_b64_tr_b16 v[148:149], v164 offset:40992
    ds_read_b64_tr_b16 v[150:151], v165 offset:40992
    ds_read_b64_tr_b16 v[152:153], v164 offset:41024
    ds_read_b64_tr_b16 v[154:155], v165 offset:41024
    ds_read_b64_tr_b16 v[156:157], v164 offset:41056
    ds_read_b64_tr_b16 v[158:159], v165 offset:41056
    ds_read_b64_tr_b16 v[160:161], v164 offset:41088
    ds_read_b64_tr_b16 v[162:163], v165 offset:41088
    s_waitcnt vmcnt(4)
    v_mfma_f32_16x16x32_bf16 v[4:7], v[180:183], v[60:63], v[4:7]
    v_mfma_f32_16x16x32_bf16 v[24:27], v[180:183], v[64:67], v[24:27]
    v_mfma_f32_16x16x32_bf16 v[8:11], v[184:187], v[60:63], v[8:11]
    v_mfma_f32_16x16x32_bf16 v[28:31], v[184:187], v[64:67], v[28:31]
    s_add_u32 s36, s99, 5
    s_and_b32 s36, s36, 7
    s_lshl_b32 s36, s36, 11
    s_add_u32 s37, s36, s21
    s_add_u32 s36, s36, s20
    buffer_load_dwordx4 v[84:87], v166, s[4:7], s36 offen
    buffer_load_dwordx4 v[88:91], v166, s[4:7], s37 offen
    v_mfma_f32_16x16x32_bf16 v[12:15], v[188:191], v[60:63], v[12:15]
    v_mfma_f32_16x16x32_bf16 v[32:35], v[188:191], v[64:67], v[32:35]
    v_mfma_f32_16x16x32_bf16 v[16:19], v[192:195], v[60:63], v[16:19]
    v_mfma_f32_16x16x32_bf16 v[36:39], v[192:195], v[64:67], v[36:39]
    v_mfma_f32_16x16x32_bf16 v[20:23], v[196:199], v[60:63], v[20:23]
    v_mfma_f32_16x16x32_bf16 v[40:43], v[196:199], v[64:67], v[40:43]
    ds_read_b64_tr_b16 v[180:181], v164 offset:61440
    ds_read_b64_tr_b16 v[182:183], v165 offset:61440
    ds_read_b64_tr_b16 v[184:185], v164 offset:61472
    ds_read_b64_tr_b16 v[186:187], v165 offset:61472
    ds_read_b64_tr_b16 v[188:189], v164 offset:61504
    ds_read_b64_tr_b16 v[190:191], v165 offset:61504
    ds_read_b64_tr_b16 v[192:193], v164 offset:61536
    ds_read_b64_tr_b16 v[194:195], v165 offset:61536
    ds_read_b64_tr_b16 v[196:197], v164 offset:61568
    ds_read_b64_tr_b16 v[198:199], v165 offset:61568
    s_waitcnt vmcnt(4)
    v_mfma_f32_16x16x32_bf16 v[4:7], v[200:203], v[68:71], v[4:7]
    v_mfma_f32_16x16x32_bf16 v[24:27], v[200:203], v[72:75], v[24:27]
    v_mfma_f32_16x16x32_bf16 v[8:11], v[204:207], v[68:71], v[8:11]
    v_mfma_f32_16x16x32_bf16 v[28:31], v[204:207], v[72:75], v[28:31]
    s_add_u32 s36, s99, 6
    s_and_b32 s36, s36, 7
    s_lshl_b32 s36, s36, 11
    s_add_u32 s37, s36, s21
    s_add_u32 s36, s36, s20
    buffer_load_dwordx4 v[92:95], v166, s[4:7], s36 offen
    buffer_load_dwordx4 v[96:99], v166, s[4:7], s37 offen
    v_mfma_f32_16x16x32_bf16 v[12:15], v[208:211], v[68:71], v[12:15]
    v_mfma_f32_16x16x32_bf16 v[32:35], v[208:211], v[72:75], v[32:35]
    v_mfma_f32_16x16x32_bf16 v[16:19], v[212:215], v[68:71], v[16:19]
    v_mfma_f32_16x16x32_bf16 v[36:39], v[212:215], v[72:75], v[36:39]
    v_mfma_f32_16x16x32_bf16 v[20:23], v[216:219], v[68:71], v[20:23]
    v_mfma_f32_16x16x32_bf16 v[40:43], v[216:219], v[72:75], v[40:43]
    s_waitcnt vmcnt(4) lgkmcnt(0)
    s_barrier
    v_add_u32 v164, 81920, v164
    v_add_u32 v165, 81920, v165
    ds_read_b64_tr_b16 v[200:201], v164 offset:0
    ds_read_b64_tr_b16 v[202:203], v165 offset:0
    ds_read_b64_tr_b16 v[204:205], v164 offset:32
    ds_read_b64_tr_b16 v[206:207], v165 offset:32
    ds_read_b64_tr_b16 v[208:209], v164 offset:64
    ds_read_b64_tr_b16 v[210:211], v165 offset:64
    ds_read_b64_tr_b16 v[212:213], v164 offset:96
    ds_read_b64_tr_b16 v[214:215], v165 offset:96
    ds_read_b64_tr_b16 v[216:217], v164 offset:128
    ds_read_b64_tr_b16 v[218:219], v165 offset:128
    v_mfma_f32_16x16x32_bf16 v[4:7], v[220:223], v[76:79], v[4:7]
    v_mfma_f32_16x16x32_bf16 v[24:27], v[220:223], v[80:83], v[24:27]
    v_mfma_f32_16x16x32_bf16 v[8:11], v[224:227], v[76:79], v[8:11]
    v_mfma_f32_16x16x32_bf16 v[28:31], v[224:227], v[80:83], v[28:31]
    s_add_u32 s36, s99, 7
    s_and_b32 s36, s36, 7
    s_lshl_b32 s36, s36, 11
    s_add_u32 s37, s36, s21
    s_add_u32 s36, s36, s20
    buffer_load_dwordx4 v[100:103], v166, s[4:7], s36 offen
    buffer_load_dwordx4 v[104:107], v166, s[4:7], s37 offen
    v_mfma_f32_16x16x32_bf16 v[12:15], v[228:231], v[76:79], v[12:15]
    v_mfma_f32_16x16x32_bf16 v[32:35], v[228:231], v[80:83], v[32:35]
    v_mfma_f32_16x16x32_bf16 v[16:19], v[232:235], v[76:79], v[16:19]
    v_mfma_f32_16x16x32_bf16 v[36:39], v[232:235], v[80:83], v[36:39]
    v_mfma_f32_16x16x32_bf16 v[20:23], v[236:239], v[76:79], v[20:23]
    v_mfma_f32_16x16x32_bf16 v[40:43], v[236:239], v[80:83], v[40:43]
    ds_read_b64_tr_b16 v[220:221], v164 offset:20480
    ds_read_b64_tr_b16 v[222:223], v165 offset:20480
    ds_read_b64_tr_b16 v[224:225], v164 offset:20512
    ds_read_b64_tr_b16 v[226:227], v165 offset:20512
    ds_read_b64_tr_b16 v[228:229], v164 offset:20544
    ds_read_b64_tr_b16 v[230:231], v165 offset:20544
    ds_read_b64_tr_b16 v[232:233], v164 offset:20576
    ds_read_b64_tr_b16 v[234:235], v165 offset:20576
    ds_read_b64_tr_b16 v[236:237], v164 offset:20608
    ds_read_b64_tr_b16 v[238:239], v165 offset:20608
    s_waitcnt vmcnt(4)
    v_mfma_f32_16x16x32_bf16 v[4:7], v[124:127], v[84:87], v[4:7]
    v_mfma_f32_16x16x32_bf16 v[24:27], v[124:127], v[88:91], v[24:27]
    v_mfma_f32_16x16x32_bf16 v[8:11], v[128:131], v[84:87], v[8:11]
    v_mfma_f32_16x16x32_bf16 v[28:31], v[128:131], v[88:91], v[28:31]
    s_mov_b32 s36, 16384
    s_add_u32 s37, s36, s21
    s_add_u32 s36, s36, s20
    buffer_load_dwordx4 v[108:111], v166, s[4:7], s36 offen
    buffer_load_dwordx4 v[112:115], v166, s[4:7], s37 offen
    v_mfma_f32_16x16x32_bf16 v[12:15], v[132:135], v[84:87], v[12:15]
    v_mfma_f32_16x16x32_bf16 v[32:35], v[132:135], v[88:91], v[32:35]
    v_mfma_f32_16x16x32_bf16 v[16:19], v[136:139], v[84:87], v[16:19]
    v_mfma_f32_16x16x32_bf16 v[36:39], v[136:139], v[88:91], v[36:39]
    v_mfma_f32_16x16x32_bf16 v[20:23], v[140:143], v[84:87], v[20:23]
    v_mfma_f32_16x16x32_bf16 v[40:43], v[140:143], v[88:91], v[40:43]
    s_waitcnt vmcnt(4)
    v_mfma_f32_16x16x32_bf16 v[4:7], v[144:147], v[92:95], v[4:7]
    v_mfma_f32_16x16x32_bf16 v[24:27], v[144:147], v[96:99], v[24:27]
    v_mfma_f32_16x16x32_bf16 v[8:11], v[148:151], v[92:95], v[8:11]
    v_mfma_f32_16x16x32_bf16 v[28:31], v[148:151], v[96:99], v[28:31]
    s_mov_b32 s36, 18432
    s_add_u32 s37, s36, s21
    s_add_u32 s36, s36, s20
    buffer_load_dwordx4 v[116:119], v166, s[4:7], s36 offen
    buffer_load_dwordx4 v[120:123], v166, s[4:7], s37 offen
    v_mfma_f32_16x16x32_bf16 v[12:15], v[152:155], v[92:95], v[12:15]
    v_mfma_f32_16x16x32_bf16 v[32:35], v[152:155], v[96:99], v[32:35]
    v_mfma_f32_16x16x32_bf16 v[16:19], v[156:159], v[92:95], v[16:19]
    v_mfma_f32_16x16x32_bf16 v[36:39], v[156:159], v[96:99], v[36:39]
    v_mfma_f32_16x16x32_bf16 v[20:23], v[160:163], v[92:95], v[20:23]
    v_mfma_f32_16x16x32_bf16 v[40:43], v[160:163], v[96:99], v[40:43]
    s_waitcnt vmcnt(4)
    v_mfma_f32_16x16x32_bf16 v[4:7], v[180:183], v[100:103], v[4:7]
    v_mfma_f32_16x16x32_bf16 v[24:27], v[180:183], v[104:107], v[24:27]
    v_mfma_f32_16x16x32_bf16 v[8:11], v[184:187], v[100:103], v[8:11]
    v_mfma_f32_16x16x32_bf16 v[28:31], v[184:187], v[104:107], v[28:31]
    buffer_load_dwordx2 v[240:241], v240, s[4:7], s24 offen
    v_mfma_f32_16x16x32_bf16 v[12:15], v[188:191], v[100:103], v[12:15]
    v_mfma_f32_16x16x32_bf16 v[32:35], v[188:191], v[104:107], v[32:35]
    v_mfma_f32_16x16x32_bf16 v[16:19], v[192:195], v[100:103], v[16:19]
    v_mfma_f32_16x16x32_bf16 v[36:39], v[192:195], v[104:107], v[36:39]
    v_mfma_f32_16x16x32_bf16 v[20:23], v[196:199], v[100:103], v[20:23]
    v_mfma_f32_16x16x32_bf16 v[40:43], v[196:199], v[104:107], v[40:43]
    s_waitcnt vmcnt(3) lgkmcnt(10)
    v_mfma_f32_16x16x32_bf16 v[4:7], v[200:203], v[108:111], v[4:7]
    v_mfma_f32_16x16x32_bf16 v[24:27], v[200:203], v[112:115], v[24:27]
    v_mfma_f32_16x16x32_bf16 v[8:11], v[204:207], v[108:111], v[8:11]
    v_mfma_f32_16x16x32_bf16 v[28:31], v[204:207], v[112:115], v[28:31]
    v_mfma_f32_16x16x32_bf16 v[12:15], v[208:211], v[108:111], v[12:15]
    v_mfma_f32_16x16x32_bf16 v[32:35], v[208:211], v[112:115], v[32:35]
    v_mfma_f32_16x16x32_bf16 v[16:19], v[212:215], v[108:111], v[16:19]
    v_mfma_f32_16x16x32_bf16 v[36:39], v[212:215], v[112:115], v[36:39]
    v_mfma_f32_16x16x32_bf16 v[20:23], v[216:219], v[108:111], v[20:23]
    v_mfma_f32_16x16x32_bf16 v[40:43], v[216:219], v[112:115], v[40:43]
    s_waitcnt vmcnt(1) lgkmcnt(0)
    v_mfma_f32_16x16x32_bf16 v[4:7], v[220:223], v[116:119], v[4:7]
    v_mfma_f32_16x16x32_bf16 v[24:27], v[220:223], v[120:123], v[24:27]
    v_mfma_f32_16x16x32_bf16 v[8:11], v[224:227], v[116:119], v[8:11]
    v_mfma_f32_16x16x32_bf16 v[28:31], v[224:227], v[120:123], v[28:31]
    v_mfma_f32_16x16x32_bf16 v[12:15], v[228:231], v[116:119], v[12:15]
    v_mfma_f32_16x16x32_bf16 v[32:35], v[228:231], v[120:123], v[32:35]
    v_mfma_f32_16x16x32_bf16 v[16:19], v[232:235], v[116:119], v[16:19]
    v_mfma_f32_16x16x32_bf16 v[36:39], v[232:235], v[120:123], v[36:39]
    v_mfma_f32_16x16x32_bf16 v[20:23], v[236:239], v[116:119], v[20:23]
    v_mfma_f32_16x16x32_bf16 v[40:43], v[236:239], v[120:123], v[40:43]
    s_nop 3
    ds_write_b128 v167, v[4:7] offset:0
    ds_write_b128 v167, v[8:11] offset:1024
    ds_write_b128 v167, v[12:15] offset:2048
    ds_write_b128 v167, v[16:19] offset:3072
    ds_write_b128 v167, v[20:23] offset:4096
    ds_write_b128 v167, v[24:27] offset:5120
    ds_write_b128 v167, v[28:31] offset:6144
    ds_write_b128 v167, v[32:35] offset:7168
    ds_write_b128 v167, v[36:39] offset:8192
    ds_write_b128 v167, v[40:43] offset:9216
    s_waitcnt vmcnt(0) lgkmcnt(0)
    s_barrier
    ds_read_b128 v[44:47], v244 offset:0
    ds_read_b128 v[48:51], v244 offset:1024
    ds_read_b128 v[52:55], v245 offset:4096
    ds_read_b128 v[56:59], v244 offset:10240
    ds_read_b128 v[60:63], v244 offset:11264
    ds_read_b128 v[64:67], v245 offset:14336
    ds_read_b128 v[68:71], v244 offset:20480
    ds_read_b128 v[72:75], v244 offset:21504
    ds_read_b128 v[76:79], v245 offset:24576
    ds_read_b128 v[80:83], v244 offset:30720
    ds_read_b128 v[84:87], v244 offset:31744
    ds_read_b128 v[88:91], v245 offset:34816
    s_waitcnt lgkmcnt(6)
    v_add_f32 v44, v44, v56
    v_add_f32 v45, v45, v57
    v_add_f32 v46, v46, v58
    v_add_f32 v47, v47, v59
    v_add_f32 v48, v48, v60
    v_add_f32 v49, v49, v61
    v_add_f32 v50, v50, v62
    v_add_f32 v51, v51, v63
    v_add_f32 v52, v52, v64
    v_add_f32 v53, v53, v65
    v_add_f32 v54, v54, v66
    v_add_f32 v55, v55, v67
    v_cvt_pk_bf16_f32 v45, v44, v45
    v_cvt_pk_bf16_f32 v47, v46, v47
    v_cvt_pk_bf16_f32 v49, v48, v49
    v_cvt_pk_bf16_f32 v51, v50, v51
    v_cvt_pk_bf16_f32 v53, v52, v53
    v_cvt_pk_bf16_f32 v55, v54, v55
    v_lshlrev_b32 v44, 16, v45
    v_and_b32 v45, 0xffff0000, v45
    v_lshlrev_b32 v46, 16, v47
    v_and_b32 v47, 0xffff0000, v47
    v_lshlrev_b32 v48, 16, v49
    v_and_b32 v49, 0xffff0000, v49
    v_lshlrev_b32 v50, 16, v51
    v_and_b32 v51, 0xffff0000, v51
    v_lshlrev_b32 v52, 16, v53
    v_and_b32 v53, 0xffff0000, v53
    v_lshlrev_b32 v54, 16, v55
    v_and_b32 v55, 0xffff0000, v55
    v_mul_f32 v44, v240, v44
    v_mul_f32 v45, v240, v45
    v_mul_f32 v46, v240, v46
    v_mul_f32 v47, v240, v47
    v_mul_f32 v48, v240, v48
    v_mul_f32 v49, v240, v49
    v_mul_f32 v50, v240, v50
    v_mul_f32 v51, v240, v51
    v_mul_f32 v52, v240, v52
    v_mul_f32 v53, v240, v53
    v_mul_f32 v54, v240, v54
    v_mul_f32 v55, v240, v55
    v_cvt_pk_bf16_f32 v45, v44, v45
    v_cvt_pk_bf16_f32 v47, v46, v47
    v_cvt_pk_bf16_f32 v49, v48, v49
    v_cvt_pk_bf16_f32 v51, v50, v51
    v_cvt_pk_bf16_f32 v53, v52, v53
    v_cvt_pk_bf16_f32 v55, v54, v55
    v_lshlrev_b32 v44, 16, v45
    v_and_b32 v45, 0xffff0000, v45
    v_lshlrev_b32 v46, 16, v47
    v_and_b32 v47, 0xffff0000, v47
    v_lshlrev_b32 v48, 16, v49
    v_and_b32 v49, 0xffff0000, v49
    v_lshlrev_b32 v50, 16, v51
    v_and_b32 v51, 0xffff0000, v51
    v_lshlrev_b32 v52, 16, v53
    v_and_b32 v53, 0xffff0000, v53
    v_lshlrev_b32 v54, 16, v55
    v_and_b32 v55, 0xffff0000, v55
    s_waitcnt lgkmcnt(0)
    v_add_f32 v68, v68, v80
    v_add_f32 v69, v69, v81
    v_add_f32 v70, v70, v82
    v_add_f32 v71, v71, v83
    v_add_f32 v72, v72, v84
    v_add_f32 v73, v73, v85
    v_add_f32 v74, v74, v86
    v_add_f32 v75, v75, v87
    v_add_f32 v76, v76, v88
    v_add_f32 v77, v77, v89
    v_add_f32 v78, v78, v90
    v_add_f32 v79, v79, v91
    v_cvt_pk_bf16_f32 v69, v68, v69
    v_cvt_pk_bf16_f32 v71, v70, v71
    v_cvt_pk_bf16_f32 v73, v72, v73
    v_cvt_pk_bf16_f32 v75, v74, v75
    v_cvt_pk_bf16_f32 v77, v76, v77
    v_cvt_pk_bf16_f32 v79, v78, v79
    v_lshlrev_b32 v68, 16, v69
    v_and_b32 v69, 0xffff0000, v69
    v_lshlrev_b32 v70, 16, v71
    v_and_b32 v71, 0xffff0000, v71
    v_lshlrev_b32 v72, 16, v73
    v_and_b32 v73, 0xffff0000, v73
    v_lshlrev_b32 v74, 16, v75
    v_and_b32 v75, 0xffff0000, v75
    v_lshlrev_b32 v76, 16, v77
    v_and_b32 v77, 0xffff0000, v77
    v_lshlrev_b32 v78, 16, v79
    v_and_b32 v79, 0xffff0000, v79
    v_mul_f32 v68, v241, v68
    v_mul_f32 v69, v241, v69
    v_mul_f32 v70, v241, v70
    v_mul_f32 v71, v241, v71
    v_mul_f32 v72, v241, v72
    v_mul_f32 v73, v241, v73
    v_mul_f32 v74, v241, v74
    v_mul_f32 v75, v241, v75
    v_mul_f32 v76, v241, v76
    v_mul_f32 v77, v241, v77
    v_mul_f32 v78, v241, v78
    v_mul_f32 v79, v241, v79
    v_cvt_pk_bf16_f32 v69, v68, v69
    v_cvt_pk_bf16_f32 v71, v70, v71
    v_cvt_pk_bf16_f32 v73, v72, v73
    v_cvt_pk_bf16_f32 v75, v74, v75
    v_cvt_pk_bf16_f32 v77, v76, v77
    v_cvt_pk_bf16_f32 v79, v78, v79
    v_lshlrev_b32 v68, 16, v69
    v_and_b32 v69, 0xffff0000, v69
    v_lshlrev_b32 v70, 16, v71
    v_and_b32 v71, 0xffff0000, v71
    v_lshlrev_b32 v72, 16, v73
    v_and_b32 v73, 0xffff0000, v73
    v_lshlrev_b32 v74, 16, v75
    v_and_b32 v75, 0xffff0000, v75
    v_lshlrev_b32 v76, 16, v77
    v_and_b32 v77, 0xffff0000, v77
    v_lshlrev_b32 v78, 16, v79
    v_and_b32 v79, 0xffff0000, v79
    v_add_f32 v44, v44, v68
    v_add_f32 v45, v45, v69
    v_add_f32 v46, v46, v70
    v_add_f32 v47, v47, v71
    v_add_f32 v48, v48, v72
    v_add_f32 v49, v49, v73
    v_add_f32 v50, v50, v74
    v_add_f32 v51, v51, v75
    v_add_f32 v52, v52, v76
    v_add_f32 v53, v53, v77
    v_add_f32 v54, v54, v78
    v_add_f32 v55, v55, v79
    v_cvt_pk_bf16_f32 v4, v44, v45
    v_cvt_pk_bf16_f32 v5, v46, v47
    v_cvt_pk_bf16_f32 v6, v48, v49
    v_cvt_pk_bf16_f32 v7, v50, v51
    v_cvt_pk_bf16_f32 v8, v52, v53
    v_cvt_pk_bf16_f32 v9, v54, v55
    v_permlane16_swap_b32 v4, v6
    v_permlane16_swap_b32 v5, v7
    buffer_store_dwordx4 v[4:7], v242, s[12:15], s25 offen
    s_cmp_lg_u32 s50, 0
    s_cbranch_scc1 L_mk_fin
    buffer_store_dwordx2 v[8:9], v243, s[12:15], s26 offen offset:128
L_mk_fin:
L_mk_end:
    s_endpgm
L_mk_truemax:
    v_mov_b32 v104, 0xff800000
    v_mov_b32 v21, 0
    v_mov_b32 v120, 0xff800000
    v_mov_b32 v23, 0
    v_mov_b32 v136, 0xff800000
    v_mov_b32 v25, 0
    v_mov_b32 v152, 0xff800000
    v_mov_b32 v27, 0
    s_mov_b32 s12, 0
    s_mul_i32 s23, s11, 163840
    s_add_u32 s23, s23, 5242880
L_mk_mloop:
    buffer_load_dwordx4 v[28:31], v1, s[4:7], s23 offen
    buffer_load_dword v36, v2, s[4:7], s23 offen
    s_add_u32 s23, s23, 2560
    s_waitcnt vmcnt(0)
    v_mfma_f32_32x32x8_bf16 v[72:87], v[36:37], v[20:21], 0
    v_mfma_f32_32x32x16_bf16 v[72:87], v[28:31], v[4:7], v[72:87]
    s_nop 11
    v_max3_f32 v104, v72, v73, v104
    v_max3_f32 v104, v74, v75, v104
    v_max3_f32 v104, v76, v77, v104
    v_max3_f32 v104, v78, v79, v104
    v_max3_f32 v104, v80, v81, v104
    v_max3_f32 v104, v82, v83, v104
    v_max3_f32 v104, v84, v85, v104
    v_max3_f32 v104, v86, v87, v104
    v_mfma_f32_32x32x8_bf16 v[88:103], v[36:37], v[22:23], 0
    v_mfma_f32_32x32x16_bf16 v[88:103], v[28:31], v[8:11], v[88:103]
    s_nop 11
    v_max3_f32 v120, v88, v89, v120
    v_max3_f32 v120, v90, v91, v120
    v_max3_f32 v120, v92, v93, v120
    v_max3_f32 v120, v94, v95, v120
    v_max3_f32 v120, v96, v97, v120
    v_max3_f32 v120, v98, v99, v120
    v_max3_f32 v120, v100, v101, v120
    v_max3_f32 v120, v102, v103, v120
    v_mfma_f32_32x32x8_bf16 v[72:87], v[36:37], v[24:25], 0
    v_mfma_f32_32x32x16_bf16 v[72:87], v[28:31], v[12:15], v[72:87]
    s_nop 11
    v_max3_f32 v136, v72, v73, v136
    v_max3_f32 v136, v74, v75, v136
    v_max3_f32 v136, v76, v77, v136
    v_max3_f32 v136, v78, v79, v136
    v_max3_f32 v136, v80, v81, v136
    v_max3_f32 v136, v82, v83, v136
    v_max3_f32 v136, v84, v85, v136
    v_max3_f32 v136, v86, v87, v136
    v_mfma_f32_32x32x8_bf16 v[88:103], v[36:37], v[26:27], 0
    v_mfma_f32_32x32x16_bf16 v[88:103], v[28:31], v[16:19], v[88:103]
    s_nop 11
    v_max3_f32 v152, v88, v89, v152
    v_max3_f32 v152, v90, v91, v152
    v_max3_f32 v152, v92, v93, v152
    v_max3_f32 v152, v94, v95, v152
    v_max3_f32 v152, v96, v97, v152
    v_max3_f32 v152, v98, v99, v152
    v_max3_f32 v152, v100, v101, v152
    v_max3_f32 v152, v102, v103, v152
    s_add_u32 s12, s12, 1
    s_cmp_lt_u32 s12, 64
    s_cbranch_scc1 L_mk_mloop
    v_mov_b32 v170, v104
    s_nop 1
    v_permlane32_swap_b32 v104, v170
    s_nop 1
    v_max_f32 v169, v104, v170
    v_and_b32 v172, 0xffff0000, v169
    v_sub_f32 v173, v169, v172
    v_and_b32 v174, 0xffff0000, v173
    v_sub_f32 v173, v173, v174
    v_lshrrev_b32 v172, 16, v172
    v_or_b32 v172, v172, v174
    v_lshrrev_b32 v173, 16, v173
    v_xor_b32 v172, 0x80008000, v172
    v_xor_b32 v173, 0x8000, v173
    v_cndmask_b32 v21, v172, v173, s[16:17]
    v_mov_b32 v170, v120
    s_nop 1
    v_permlane32_swap_b32 v120, v170
    s_nop 1
    v_max_f32 v169, v120, v170
    v_and_b32 v172, 0xffff0000, v169
    v_sub_f32 v173, v169, v172
    v_and_b32 v174, 0xffff0000, v173
    v_sub_f32 v173, v173, v174
    v_lshrrev_b32 v172, 16, v172
    v_or_b32 v172, v172, v174
    v_lshrrev_b32 v173, 16, v173
    v_xor_b32 v172, 0x80008000, v172
    v_xor_b32 v173, 0x8000, v173
    v_cndmask_b32 v23, v172, v173, s[16:17]
    v_mov_b32 v170, v136
    s_nop 1
    v_permlane32_swap_b32 v136, v170
    s_nop 1
    v_max_f32 v169, v136, v170
    v_and_b32 v172, 0xffff0000, v169
    v_sub_f32 v173, v169, v172
    v_and_b32 v174, 0xffff0000, v173
    v_sub_f32 v173, v173, v174
    v_lshrrev_b32 v172, 16, v172
    v_or_b32 v172, v172, v174
    v_lshrrev_b32 v173, 16, v173
    v_xor_b32 v172, 0x80008000, v172
    v_xor_b32 v173, 0x8000, v173
    v_cndmask_b32 v25, v172, v173, s[16:17]
    v_mov_b32 v170, v152
    s_nop 1
    v_permlane32_swap_b32 v152, v170
    s_nop 1
    v_max_f32 v169, v152, v170
    v_and_b32 v172, 0xffff0000, v169
    v_sub_f32 v173, v169, v172
    v_and_b32 v174, 0xffff0000, v173
    v_sub_f32 v173, v173, v174
    v_lshrrev_b32 v172, 16, v172
    v_or_b32 v172, v172, v174
    v_lshrrev_b32 v173, 16, v173
    v_xor_b32 v172, 0x80008000, v172
    v_xor_b32 v173, 0x8000, v173
    v_cndmask_b32 v27, v172, v173, s[16:17]
    s_mov_b32 s20, 1
    s_mov_b32 s23, s22
    buffer_load_dwordx4 v[28:31], v1, s[4:7], s23 offen
    buffer_load_dword v36, v2, s[4:7], s23 offen
    s_mov_b64 exec, s[14:15]
    buffer_load_dwordx4 v[40:43], v3, s[4:7], s23 offen
    buffer_load_dwordx4 v[44:47], v3, s[4:7], s23 offen offset:640
    s_mov_b64 exec, -1
    s_add_u32 s23, s22, 2560
    buffer_load_dwordx4 v[32:35], v1, s[4:7], s23 offen
    buffer_load_dword v38, v2, s[4:7], s23 offen
    s_add_u32 s24, s22, 5120
    s_branch L_mk_restart
L_mk_codeend:
.section .rodata,"a"
.p2align 6
.amdhsa_kernel gated_mix__grouped_kv_mqa__mha_block__prompt_kernel
  .amdhsa_next_free_vgpr 256
  .amdhsa_next_free_sgpr 102
  .amdhsa_accum_offset 256
  .amdhsa_group_segment_fixed_size 0
  .amdhsa_kernarg_size 96
  .amdhsa_user_sgpr_count 2
  .amdhsa_user_sgpr_kernarg_segment_ptr 1
  .amdhsa_system_sgpr_workgroup_id_x 1
.end_amdhsa_kernel
```
